```python
import torch

def _softmax(x, axis=-1):
    return torch.softmax(x, dim=axis)

def _gelu(x):
    return torch.nn.functional.gelu(x, approximate='tanh')

def _silu(x):
    return torch.nn.functional.silu(x)

def _sigmoid(x):
    return torch.sigmoid(x)

def _layernorm(x, axis=-1, eps=1e-05):
    m = x.mean(dim=axis, keepdim=True)
    v = x.var(dim=axis, keepdim=True, unbiased=False)
    return (x - m) / torch.sqrt(v + eps)

def _scatter_add(tgt, idx, src, axis=0):
    return tgt.clone().index_add_(axis, idx, src)

def _segment_sum(src, seg, n):
    out = torch.zeros((n,) + src.shape[1:], dtype=src.dtype)
    return out.index_add_(0, seg, src)

def _pad(x, pw):
    flat = tuple((v for pair in reversed(pw) for v in pair))
    return torch.nn.functional.pad(x, flat)
kernel_name = 'gated_mix__memory_aug_recurrent_mem_tr__dense_activation_relu__prompt'

def setup_inputs():

    _w = lambda a: (lambda t: t.to(torch.bfloat16) if t.is_floating_point() else t)(torch.as_tensor(a))

    def _A_setup():
        B, S, Dm = (1, 2048, 1024)
        H, Dh = (32, 128)
        M, seg = (8, 32)
        seg = min(seg, S)
        S = S // seg * seg
        return {'x': _w((lambda *s: torch.randn(*s, dtype=torch.bfloat16) * 0.05)(B, S, Dm)), 'mem0': _w((lambda *s: torch.randn(*s, dtype=torch.bfloat16) * 1.6)(B, M, Dm)), 'Wq': _w((lambda *s: torch.randn(*s, dtype=torch.bfloat16) * 0.8)(Dm, H, Dh) * Dm ** (-0.5)), 'Wk': _w((lambda *s: torch.randn(*s, dtype=torch.bfloat16) * 0.8)(Dm, H, Dh) * Dm ** (-0.5)), 'Wv': _w((lambda *s: torch.randn(*s, dtype=torch.bfloat16) * 1.6)(Dm, H, Dh) * Dm ** (-0.5)), 'Wo': _w((lambda *s: torch.randn(*s, dtype=torch.bfloat16) * 1.6)(H, Dh, Dm) * (H * Dh) ** (-0.5)), 'seg_len': seg}
    _A_in = _A_setup()

    def _B_setup():
        B, S, D, Dff = (1, 2048, 1024, 3584)
        return {'x': _w((lambda *s: torch.randn(*s, dtype=torch.bfloat16) * 0.05)(B, S, D)), 'w1': _w((lambda *s: torch.randn(*s, dtype=torch.bfloat16) * 0.05)(D, Dff)), 'w2': _w((lambda *s: torch.randn(*s, dtype=torch.bfloat16) * 0.05)(Dff, D))}
    _B_in = _B_setup()
    return {'A_x': _A_in['x'], 'A_mem0': _A_in['mem0'], 'A_Wq': _A_in['Wq'], 'A_Wk': _A_in['Wk'], 'A_Wv': _A_in['Wv'], 'A_Wo': _A_in['Wo'], 'A_seg_len': _A_in['seg_len'], 'B_x': _B_in['x'], 'B_w1': _B_in['w1'], 'B_w2': _B_in['w2'], 'gate_w': _w((lambda *s: torch.randn(*s, dtype=torch.bfloat16) * 0.05)(1024) * 16.0)}

def reference(A_x, A_mem0, A_Wq, A_Wk, A_Wv, A_Wo, A_seg_len, B_x, B_w1, B_w2, gate_w):

    def _A_ref(x, mem0, Wq, Wk, Wv, Wo, seg_len):
        B, S, Dm = x.shape
        H, Dh = (Wq.shape[1], Wq.shape[2])
        M = mem0.shape[1]
        scale = Dh ** (-0.5)
        n_seg = S // seg_len
        L = M + seg_len
        idx = torch.arange(L)
        mask = (idx[:, None] < M) | (idx[:, None] >= idx[None, :])
        mem = mem0
        outs = []
        for s in range(n_seg):
            xs = x[:, s * seg_len:(s + 1) * seg_len, :].clone()
            h = torch.concatenate([mem, xs], axis=1)
            q = torch.einsum('btd,dhe->bhte', h, Wq)
            k = torch.einsum('btd,dhe->bhte', h, Wk)
            v = torch.einsum('btd,dhe->bhte', h, Wv)
            scores = torch.einsum('bhqe,bhke->bhqk', q, k) * scale
            scores = torch.where(mask[None, None], scores, -1000000000.0)
            p = _softmax(scores, axis=-1)
            o = torch.einsum('bhqk,bhke->bhqe', p, v)
            o = torch.einsum('bhte,hed->btd', o, Wo)
            mem = o[:, :M, :].clone()
            outs.append(o[:, M:, :])
        return torch.concatenate(outs, axis=1)

    def _B_ref(x, w1, w2):
        h = torch.einsum('bsd,df->bsf', x, w1)
        zero = torch.zeros_like(h)
        h = torch.maximum(h, zero)
        return torch.einsum('bsf,fd->bsd', h, w2)
    x = A_x
    g = _sigmoid((x * gate_w).sum(-1, keepdims=True))
    a = _A_ref(x, A_mem0, A_Wq, A_Wk, A_Wv, A_Wo, A_seg_len)
    b = _B_ref(x, B_w1, B_w2)
    return g * a + (1 - g) * b
```

```asm
; @launch grid=(256,1,1) block=(256,1,1) lds=163840
.amdgcn_target "amdgcn-amd-amdhsa--gfx950"
.text
.globl gated_mix__memory_aug_recurrent_mem_tr__dense_activation_relu__prompt_kernel
.p2align 8
.type gated_mix__memory_aug_recurrent_mem_tr__dense_activation_relu__prompt_kernel,@function
gated_mix__memory_aug_recurrent_mem_tr__dense_activation_relu__prompt_kernel:
  s_cmp_ge_u32 s2, 256
  s_cbranch_scc1 Lexit
  s_load_dwordx16 s[4:19], s[0:1], 0
  s_load_dwordx8 s[20:27], s[0:1], 64
  s_load_dwordx4 s[28:31], s[0:1], 96
  s_getreg_b32 s3, hwreg(HW_REG_XCC_ID, 0, 3)
  s_mov_b32 s0, s2
  s_sub_u32 s1, s3, s2
  s_and_b32 s1, s1, 7
  s_lshl_b32 s3, s3, 2
  s_lshr_b32 s3, 0x76541032, s3
  s_and_b32 s3, s3, 7
  s_andn2_b32 s2, s2, 7
  s_or_b32 s2, s2, s3
  s_waitcnt lgkmcnt(0)
  s_mov_b32 s32, s30
  s_and_b32 s33, s31, 0xffff
  s_mov_b32 s34, 268435456
  s_mov_b32 s35, 0x20000
Ldispatch:
  s_and_b32 s3, s2, 7
  s_cmp_lt_u32 s3, 2
  s_cbranch_scc1 Lchain
  s_branch Lbulk
Lexit:
  s_endpgm
Lrestart:
  s_waitcnt vmcnt(0) lgkmcnt(0)
  s_barrier
  s_mov_b64 exec, -1
  s_setprio 0
  v_mbcnt_lo_u32_b32 v0, -1, 0
  v_mbcnt_hi_u32_b32 v0, -1, v0
  s_lshl_b32 s3, s50, 6
  v_or_b32 v0, s3, v0
  s_mov_b32 s2, s0
  s_mov_b32 s1, 8
  s_branch Ldispatch
Lchain:
  s_and_b32 s48, s2, 7
  s_lshr_b32 s49, s2, 3
  v_lshrrev_b32 v1, 6, v0
  v_and_b32 v0, 63, v0
  v_readfirstlane_b32 s50, v1
  s_lshl_b32 s52, s48, 5
  s_add_u32 s52, s52, s49
  s_lshr_b32 s53, s52, 1
  s_setprio 3
  v_lshlrev_b32 v10, 4, v0
  s_mov_b32 s36, s6
  s_and_b32 s37, s7, 0xffff
  s_mov_b32 s38, 16384
  s_mov_b32 s39, 0x20000
  v_and_b32 v41, 1, v0
  v_lshlrev_b32 v41, 13, v41
  v_and_b32 v42, 62, v0
  v_add_u32 v41, v41, v42
  s_lshl_b32 s75, s49, 6
  s_add_u32 s76, s75, 4096
  buffer_load_ushort v36, v41, s[36:39], s75 offen
  buffer_load_ushort v37, v41, s[36:39], s75 offen offset:2048
  buffer_load_ushort v38, v41, s[36:39], s76 offen
  buffer_load_ushort v39, v41, s[36:39], s76 offen offset:2048
  v_lshrrev_b32 v40, 3, v0
  v_lshlrev_b32 v40, 13, v40
  v_and_b32 v41, 7, v0
  v_lshl_add_u32 v40, v41, 4, v40
  v_xor_b32 v41, 32, v40
  v_xor_b32 v42, 64, v40
  v_xor_b32 v43, 0x60, v40
  v_and_b32 v47, 32, v0
  v_lshrrev_b32 v44, 2, v0
  v_and_b32 v45, 9, v44
  v_and_b32 v46, 2, v44
  v_lshl_or_b32 v45, v46, 1, v45
  v_and_b32 v46, 4, v44
  v_lshrrev_b32 v46, 1, v46
  v_or_b32 v45, v45, v46
  v_lshlrev_b32 v45, 11, v45
  v_and_b32 v46, 3, v0
  v_lshlrev_b32 v46, 4, v46
  v_xor_b32 v46, v46, v47
  v_or_b32 v44, v45, v46
  s_lshl_b32 s64, s52, 7
  s_lshl_b32 s75, s50, 19
  s_add_u32 s64, s64, s75
  s_lshl_b32 s65, s48, 22
  s_lshl_b32 s75, s50, 18
  s_add_u32 s65, s65, s75
  s_lshl_b32 s75, s49, 6
  s_add_u32 s65, s65, s75
  s_lshl_b32 s66, s50, 13
  s_mov_b32 s36, s8
  s_and_b32 s37, s9, 0xffff
  s_mov_b32 s38, 8388608
  s_mov_b32 s39, 0x20000
  s_add_u32 m0, s66, 98304
  s_add_u32 s75, s64, 0
  buffer_load_dwordx4 v40, s[36:39], s75 offen  lds
  s_add_u32 m0, m0, 1024
  s_add_u32 s75, s75, 65536
  buffer_load_dwordx4 v40, s[36:39], s75 offen  lds
  s_add_u32 m0, m0, 1024
  s_add_u32 s75, s75, 65536
  buffer_load_dwordx4 v41, s[36:39], s75 offen  lds
  s_add_u32 m0, m0, 1024
  s_add_u32 s75, s75, 65536
  buffer_load_dwordx4 v41, s[36:39], s75 offen  lds
  s_add_u32 m0, m0, 1024
  s_add_u32 s75, s75, 65536
  buffer_load_dwordx4 v42, s[36:39], s75 offen  lds
  s_add_u32 m0, m0, 1024
  s_add_u32 s75, s75, 65536
  buffer_load_dwordx4 v42, s[36:39], s75 offen  lds
  s_add_u32 m0, m0, 1024
  s_add_u32 s75, s75, 65536
  buffer_load_dwordx4 v43, s[36:39], s75 offen  lds
  s_add_u32 m0, m0, 1024
  s_add_u32 s75, s75, 65536
  buffer_load_dwordx4 v43, s[36:39], s75 offen  lds
  s_add_u32 m0, s66, 131072
  s_add_u32 s75, s64, 2097152
  buffer_load_dwordx4 v40, s[36:39], s75 offen  lds
  s_add_u32 m0, m0, 1024
  s_add_u32 s75, s75, 65536
  buffer_load_dwordx4 v40, s[36:39], s75 offen  lds
  s_add_u32 m0, m0, 1024
  s_add_u32 s75, s75, 65536
  buffer_load_dwordx4 v41, s[36:39], s75 offen  lds
  s_add_u32 m0, m0, 1024
  s_add_u32 s75, s75, 65536
  buffer_load_dwordx4 v41, s[36:39], s75 offen  lds
  s_add_u32 m0, m0, 1024
  s_add_u32 s75, s75, 65536
  buffer_load_dwordx4 v42, s[36:39], s75 offen  lds
  s_add_u32 m0, m0, 1024
  s_add_u32 s75, s75, 65536
  buffer_load_dwordx4 v42, s[36:39], s75 offen  lds
  s_add_u32 m0, m0, 1024
  s_add_u32 s75, s75, 65536
  buffer_load_dwordx4 v43, s[36:39], s75 offen  lds
  s_add_u32 m0, m0, 1024
  s_add_u32 s75, s75, 65536
  buffer_load_dwordx4 v43, s[36:39], s75 offen  lds
  s_add_u32 m0, s66, 0
  s_add_u32 s75, s64, 4194304
  buffer_load_dwordx4 v40, s[36:39], s75 offen  lds
  s_add_u32 m0, m0, 1024
  s_add_u32 s75, s75, 65536
  buffer_load_dwordx4 v40, s[36:39], s75 offen  lds
  s_add_u32 m0, m0, 1024
  s_add_u32 s75, s75, 65536
  buffer_load_dwordx4 v41, s[36:39], s75 offen  lds
  s_add_u32 m0, m0, 1024
  s_add_u32 s75, s75, 65536
  buffer_load_dwordx4 v41, s[36:39], s75 offen  lds
  s_add_u32 m0, m0, 1024
  s_add_u32 s75, s75, 65536
  buffer_load_dwordx4 v42, s[36:39], s75 offen  lds
  s_add_u32 m0, m0, 1024
  s_add_u32 s75, s75, 65536
  buffer_load_dwordx4 v42, s[36:39], s75 offen  lds
  s_add_u32 m0, m0, 1024
  s_add_u32 s75, s75, 65536
  buffer_load_dwordx4 v43, s[36:39], s75 offen  lds
  s_add_u32 m0, m0, 1024
  s_add_u32 s75, s75, 65536
  buffer_load_dwordx4 v43, s[36:39], s75 offen  lds
  s_add_u32 m0, s66, 32768
  s_add_u32 s75, s64, 6291456
  buffer_load_dwordx4 v40, s[36:39], s75 offen  lds
  s_add_u32 m0, m0, 1024
  s_add_u32 s75, s75, 65536
  buffer_load_dwordx4 v40, s[36:39], s75 offen  lds
  s_add_u32 m0, m0, 1024
  s_add_u32 s75, s75, 65536
  buffer_load_dwordx4 v41, s[36:39], s75 offen  lds
  s_add_u32 m0, m0, 1024
  s_add_u32 s75, s75, 65536
  buffer_load_dwordx4 v41, s[36:39], s75 offen  lds
  s_add_u32 m0, m0, 1024
  s_add_u32 s75, s75, 65536
  buffer_load_dwordx4 v42, s[36:39], s75 offen  lds
  s_add_u32 m0, m0, 1024
  s_add_u32 s75, s75, 65536
  buffer_load_dwordx4 v42, s[36:39], s75 offen  lds
  s_add_u32 m0, m0, 1024
  s_add_u32 s75, s75, 65536
  buffer_load_dwordx4 v43, s[36:39], s75 offen  lds
  s_add_u32 m0, m0, 1024
  s_add_u32 s75, s75, 65536
  buffer_load_dwordx4 v43, s[36:39], s75 offen  lds
  s_mov_b32 s69, 131072
  s_mov_b32 s70, 0x00ff00ff
  s_mov_b32 s71, 0x00ff00ff
  s_mov_b32 s72, 0xff00ff00
  s_mov_b32 s73, 0xff00ff00
  s_mov_b32 s74, 0x3e0293ee
  s_mov_b32 s54, -1
  s_mov_b32 s55, 0
  v_mov_b32 v60, -1
  v_mov_b32 v61, -1
  v_mov_b32 v62, -1
  v_mov_b32 v63, -1
  v_mov_b32 v32, 0
  v_mov_b32 v33, 0
  v_mov_b32 v34, 0
  v_mov_b32 v35, 0
  s_lshl_b32 s75, s48, 14
  s_lshl_b32 s76, s49, 9
  s_add_u32 s40, s75, s76
  s_add_u32 s41, s40, 98959360
  s_and_b32 s75, s49, 15
  s_lshl_b32 s40, s75, 9
  s_lshr_b32 s75, s49, 4
  s_lshl_b32 s75, s75, 14
  s_add_u32 s40, s40, s75
  s_lshl_b32 s75, s48, 21
  s_add_u32 s40, s40, s75
  s_add_u32 s40, s40, 117440512
  v_lshrrev_b32 v58, 5, v0
  v_lshlrev_b32 v58, 13, v58
  v_and_b32 v59, 31, v0
  v_lshl_add_u32 v58, v59, 4, v58
  s_add_u32 s75, s50, 1
  s_lshl_b32 s75, s75, 15
  s_add_u32 s75, s75, s40
  buffer_store_dwordx4 v[60:63], v58, s[32:35], s75 offen sc1
  s_lshl_b32 s56, s52, 11
  s_add_u32 s56, s56, 98566144
  s_xor_b32 s57, s56, 2048
  s_lshr_b32 s75, s50, 1
  s_lshl_b32 s75, s75, 17
  s_and_b32 s76, s50, 1
  s_lshl_b32 s76, s76, 10
  s_add_u32 s75, s75, s76
  s_add_u32 s75, s75, s56
  buffer_store_dwordx4 v[60:63], v10, s[32:35], s75 offen sc1
  s_lshl_b32 s58, s48, 15
  s_add_u32 s58, s58, 98828288
  s_lshl_b32 s75, s50, 13
  s_add_u32 s59, s58, s75
  s_add_u32 s60, s59, 4096
  s_lshl_b32 s75, s49, 10
  s_add_u32 s61, s58, s75
  s_and_b32 s75, s50, 1
  s_lshl_b32 s75, s75, 16
  s_add_u32 s75, s75, s61
  buffer_store_dwordx4 v[60:63], v10, s[32:35], s75 offen sc1
  s_xor_b32 s61, s61, 65536
  s_lshl_b32 s68, s52, 7
  s_add_u32 s76, s68, 99045376
  s_add_u32 s68, s68, 142606336
  s_lshl_b32 s67, s53, 7
  s_add_u32 s67, s67, 142622720
  s_mov_b32 s75, 0
  s_cmp_eq_u32 s50, 1
  s_cselect_b32 s76, s68, s76
  s_cselect_b32 s75, 0x2000, s75
  s_cmp_eq_u32 s50, 2
  s_cselect_b32 s76, s67, s76
  s_cselect_b32 s75, 0x2000, s75
  s_add_u32 s75, s75, s76
  s_mov_b64 exec, 0xff
  buffer_store_dwordx4 v[32:35], v10, s[32:35], s76 offen sc1
  buffer_store_dwordx4 v[32:35], v10, s[32:35], s75 offen sc1
  s_mov_b64 exec, -1
  v_lshlrev_b32 v59, 3, v0
  s_xor_b32 s75, s41, 32768
  buffer_store_dwordx2 v[60:61], v59, s[32:35], s75 offen sc1
  buffer_store_dwordx2 v[32:33], v59, s[32:35], s40 offen sc1
  s_add_u32 s75, s40, 8192
  buffer_store_dwordx2 v[32:33], v59, s[32:35], s75 offen sc1
  s_waitcnt vmcnt(40)
  v_lshl_or_b32 v36, v37, 16, v36
  v_lshl_or_b32 v37, v39, 16, v38
  v_min_u32 v36, -2, v36
  buffer_store_dwordx2 v[36:37], v59, s[32:35], s41 offen sc1
  v_bfe_u32 v45, v0, 4, 1
  v_bfe_u32 v46, v0, 5, 1
  v_bfe_u32 v47, v0, 2, 1
  v_bfe_u32 v49, v0, 3, 1
  v_lshlrev_b32 v48, 5, v45
  v_lshl_add_u32 v48, v46, 2, v48
  v_add_u32 v48, v48, v47
  v_lshl_add_u32 v48, v49, 4, v48
  v_lshlrev_b32 v48, 7, v48
  v_lshl_add_u32 v50, v45, 1, v49
  v_xor_b32 v50, s50, v50
  v_lshl_add_u32 v48, v50, 5, v48
  v_and_b32 v50, 3, v0
  v_lshl_add_u32 v48, v50, 3, v48
  v_lshl_add_u32 v51, v45, 1, v47
  v_lshl_add_u32 v51, v49, 3, v51
  v_lshl_add_u32 v51, v46, 4, v51
  v_lshlrev_b32 v51, 6, v51
  v_lshl_add_u32 v51, v49, 5, v51
  v_lshl_add_u32 v51, v50, 3, v51
  s_lshl_b32 s75, s50, 15
  v_add_u32 v51, s75, v51
  v_xor_b32 v52, 32, v51
  v_add_u32 v13, s75, v10
  s_add_u32 s75, s49, 0
  s_and_b32 s75, s75, 3
  s_lshl_b32 s44, s75, 10
  s_add_u32 s44, s44, 96468992
  s_lshl_b32 s75, s75, 13
  v_add_u32 v64, s75, v48
  s_add_u32 s75, s49, 1
  s_and_b32 s75, s75, 3
  s_lshl_b32 s45, s75, 10
  s_add_u32 s45, s45, 96468992
  s_lshl_b32 s75, s75, 13
  v_add_u32 v65, s75, v48
  s_add_u32 s75, s49, 2
  s_and_b32 s75, s75, 3
  s_lshl_b32 s46, s75, 10
  s_add_u32 s46, s46, 96468992
  s_lshl_b32 s75, s75, 13
  v_add_u32 v66, s75, v48
  s_add_u32 s75, s49, 3
  s_and_b32 s75, s75, 3
  s_lshl_b32 s47, s75, 10
  s_add_u32 s47, s47, 96468992
  s_lshl_b32 s75, s75, 13
  v_add_u32 v67, s75, v48
  s_waitcnt vmcnt(33)
  s_barrier
  s_mov_b32 s36, s10
  s_and_b32 s37, s11, 0xffff
  s_mov_b32 s38, 8388608
  s_mov_b32 s39, 0x20000
  s_add_u32 m0, s66, 65536
  s_add_u32 s75, s64, 0
  buffer_load_dwordx4 v40, s[36:39], s75 offen  lds
  s_add_u32 m0, m0, 1024
  s_add_u32 s75, s75, 65536
  buffer_load_dwordx4 v40, s[36:39], s75 offen  lds
  s_add_u32 m0, m0, 1024
  s_add_u32 s75, s75, 65536
  buffer_load_dwordx4 v41, s[36:39], s75 offen  lds
  s_add_u32 m0, m0, 1024
  s_add_u32 s75, s75, 65536
  buffer_load_dwordx4 v41, s[36:39], s75 offen  lds
  s_add_u32 m0, m0, 1024
  s_add_u32 s75, s75, 65536
  buffer_load_dwordx4 v42, s[36:39], s75 offen  lds
  s_add_u32 m0, m0, 1024
  s_add_u32 s75, s75, 65536
  buffer_load_dwordx4 v42, s[36:39], s75 offen  lds
  s_add_u32 m0, m0, 1024
  s_add_u32 s75, s75, 65536
  buffer_load_dwordx4 v43, s[36:39], s75 offen  lds
  s_add_u32 m0, m0, 1024
  s_add_u32 s75, s75, 65536
  buffer_load_dwordx4 v43, s[36:39], s75 offen  lds
  v_add_u32 v68, 98304, v64
  v_add_u32 v69, 98304, v65
  v_add_u32 v70, 98304, v66
  v_add_u32 v71, 98304, v67
  s_sub_u32 s75, 0, s50
  s_and_b32 s75, s75, 3
  s_cmp_eq_u32 s75, 1
  s_cbranch_scc1 Lwb_3
  s_cmp_eq_u32 s75, 2
  s_cbranch_scc1 Lwb_4
  s_cmp_eq_u32 s75, 3
  s_cbranch_scc1 Lwb_5
Lwb_2:
  ds_read_b64_tr_b16 a[0:1], v68 offset:0
  ds_read_b64_tr_b16 a[2:3], v68 offset:256
  ds_read_b64_tr_b16 a[4:5], v68 offset:1024
  ds_read_b64_tr_b16 a[6:7], v68 offset:1280
  ds_read_b64_tr_b16 a[8:9], v69 offset:0
  ds_read_b64_tr_b16 a[10:11], v69 offset:256
  ds_read_b64_tr_b16 a[12:13], v69 offset:1024
  ds_read_b64_tr_b16 a[14:15], v69 offset:1280
  s_waitcnt lgkmcnt(4)
  ds_read_b64_tr_b16 a[16:17], v70 offset:0
  ds_read_b64_tr_b16 a[18:19], v70 offset:256
  ds_read_b64_tr_b16 a[20:21], v70 offset:1024
  ds_read_b64_tr_b16 a[22:23], v70 offset:1280
  ds_read_b64_tr_b16 a[24:25], v71 offset:0
  ds_read_b64_tr_b16 a[26:27], v71 offset:256
  ds_read_b64_tr_b16 a[28:29], v71 offset:1024
  ds_read_b64_tr_b16 a[30:31], v71 offset:1280
  s_branch Lwd_1
Lwb_3:
  ds_read_b64_tr_b16 a[32:33], v68 offset:0
  ds_read_b64_tr_b16 a[34:35], v68 offset:256
  ds_read_b64_tr_b16 a[36:37], v68 offset:1024
  ds_read_b64_tr_b16 a[38:39], v68 offset:1280
  ds_read_b64_tr_b16 a[40:41], v69 offset:0
  ds_read_b64_tr_b16 a[42:43], v69 offset:256
  ds_read_b64_tr_b16 a[44:45], v69 offset:1024
  ds_read_b64_tr_b16 a[46:47], v69 offset:1280
  s_waitcnt lgkmcnt(4)
  ds_read_b64_tr_b16 a[48:49], v70 offset:0
  ds_read_b64_tr_b16 a[50:51], v70 offset:256
  ds_read_b64_tr_b16 a[52:53], v70 offset:1024
  ds_read_b64_tr_b16 a[54:55], v70 offset:1280
  ds_read_b64_tr_b16 a[56:57], v71 offset:0
  ds_read_b64_tr_b16 a[58:59], v71 offset:256
  ds_read_b64_tr_b16 a[60:61], v71 offset:1024
  ds_read_b64_tr_b16 a[62:63], v71 offset:1280
  s_branch Lwd_1
Lwb_4:
  ds_read_b64_tr_b16 a[64:65], v68 offset:0
  ds_read_b64_tr_b16 a[66:67], v68 offset:256
  ds_read_b64_tr_b16 a[68:69], v68 offset:1024
  ds_read_b64_tr_b16 a[70:71], v68 offset:1280
  ds_read_b64_tr_b16 a[72:73], v69 offset:0
  ds_read_b64_tr_b16 a[74:75], v69 offset:256
  ds_read_b64_tr_b16 a[76:77], v69 offset:1024
  ds_read_b64_tr_b16 a[78:79], v69 offset:1280
  s_waitcnt lgkmcnt(4)
  ds_read_b64_tr_b16 a[80:81], v70 offset:0
  ds_read_b64_tr_b16 a[82:83], v70 offset:256
  ds_read_b64_tr_b16 a[84:85], v70 offset:1024
  ds_read_b64_tr_b16 a[86:87], v70 offset:1280
  ds_read_b64_tr_b16 a[88:89], v71 offset:0
  ds_read_b64_tr_b16 a[90:91], v71 offset:256
  ds_read_b64_tr_b16 a[92:93], v71 offset:1024
  ds_read_b64_tr_b16 a[94:95], v71 offset:1280
  s_branch Lwd_1
Lwb_5:
  ds_read_b64_tr_b16 a[96:97], v68 offset:0
  ds_read_b64_tr_b16 a[98:99], v68 offset:256
  ds_read_b64_tr_b16 a[100:101], v68 offset:1024
  ds_read_b64_tr_b16 a[102:103], v68 offset:1280
  ds_read_b64_tr_b16 a[104:105], v69 offset:0
  ds_read_b64_tr_b16 a[106:107], v69 offset:256
  ds_read_b64_tr_b16 a[108:109], v69 offset:1024
  ds_read_b64_tr_b16 a[110:111], v69 offset:1280
  s_waitcnt lgkmcnt(4)
  ds_read_b64_tr_b16 a[112:113], v70 offset:0
  ds_read_b64_tr_b16 a[114:115], v70 offset:256
  ds_read_b64_tr_b16 a[116:117], v70 offset:1024
  ds_read_b64_tr_b16 a[118:119], v70 offset:1280
  ds_read_b64_tr_b16 a[120:121], v71 offset:0
  ds_read_b64_tr_b16 a[122:123], v71 offset:256
  ds_read_b64_tr_b16 a[124:125], v71 offset:1024
  ds_read_b64_tr_b16 a[126:127], v71 offset:1280
Lwd_1:
  s_waitcnt lgkmcnt(0)
  s_waitcnt vmcnt(33)
  s_barrier
  s_add_u32 m0, s66, 98304
  s_add_u32 s75, s64, 2097152
  buffer_load_dwordx4 v40, s[36:39], s75 offen  lds
  s_add_u32 m0, m0, 1024
  s_add_u32 s75, s75, 65536
  buffer_load_dwordx4 v40, s[36:39], s75 offen  lds
  s_add_u32 m0, m0, 1024
  s_add_u32 s75, s75, 65536
  buffer_load_dwordx4 v41, s[36:39], s75 offen  lds
  s_add_u32 m0, m0, 1024
  s_add_u32 s75, s75, 65536
  buffer_load_dwordx4 v41, s[36:39], s75 offen  lds
  s_add_u32 m0, m0, 1024
  s_add_u32 s75, s75, 65536
  buffer_load_dwordx4 v42, s[36:39], s75 offen  lds
  s_add_u32 m0, m0, 1024
  s_add_u32 s75, s75, 65536
  buffer_load_dwordx4 v42, s[36:39], s75 offen  lds
  s_add_u32 m0, m0, 1024
  s_add_u32 s75, s75, 65536
  buffer_load_dwordx4 v43, s[36:39], s75 offen  lds
  s_add_u32 m0, m0, 1024
  s_add_u32 s75, s75, 65536
  buffer_load_dwordx4 v43, s[36:39], s75 offen  lds
  v_add_u32 v68, 131072, v64
  v_add_u32 v69, 131072, v65
  v_add_u32 v70, 131072, v66
  v_add_u32 v71, 131072, v67
  s_sub_u32 s75, 1, s50
  s_and_b32 s75, s75, 3
  s_cmp_eq_u32 s75, 1
  s_cbranch_scc1 Lwb_8
  s_cmp_eq_u32 s75, 2
  s_cbranch_scc1 Lwb_9
  s_cmp_eq_u32 s75, 3
  s_cbranch_scc1 Lwb_10
Lwb_7:
  ds_read_b64_tr_b16 a[0:1], v68 offset:0
  ds_read_b64_tr_b16 a[2:3], v68 offset:256
  ds_read_b64_tr_b16 a[4:5], v68 offset:1024
  ds_read_b64_tr_b16 a[6:7], v68 offset:1280
  ds_read_b64_tr_b16 a[8:9], v69 offset:0
  ds_read_b64_tr_b16 a[10:11], v69 offset:256
  ds_read_b64_tr_b16 a[12:13], v69 offset:1024
  ds_read_b64_tr_b16 a[14:15], v69 offset:1280
  s_waitcnt lgkmcnt(4)
  ds_read_b64_tr_b16 a[16:17], v70 offset:0
  ds_read_b64_tr_b16 a[18:19], v70 offset:256
  ds_read_b64_tr_b16 a[20:21], v70 offset:1024
  ds_read_b64_tr_b16 a[22:23], v70 offset:1280
  ds_read_b64_tr_b16 a[24:25], v71 offset:0
  ds_read_b64_tr_b16 a[26:27], v71 offset:256
  ds_read_b64_tr_b16 a[28:29], v71 offset:1024
  ds_read_b64_tr_b16 a[30:31], v71 offset:1280
  s_branch Lwd_6
Lwb_8:
  ds_read_b64_tr_b16 a[32:33], v68 offset:0
  ds_read_b64_tr_b16 a[34:35], v68 offset:256
  ds_read_b64_tr_b16 a[36:37], v68 offset:1024
  ds_read_b64_tr_b16 a[38:39], v68 offset:1280
  ds_read_b64_tr_b16 a[40:41], v69 offset:0
  ds_read_b64_tr_b16 a[42:43], v69 offset:256
  ds_read_b64_tr_b16 a[44:45], v69 offset:1024
  ds_read_b64_tr_b16 a[46:47], v69 offset:1280
  s_waitcnt lgkmcnt(4)
  ds_read_b64_tr_b16 a[48:49], v70 offset:0
  ds_read_b64_tr_b16 a[50:51], v70 offset:256
  ds_read_b64_tr_b16 a[52:53], v70 offset:1024
  ds_read_b64_tr_b16 a[54:55], v70 offset:1280
  ds_read_b64_tr_b16 a[56:57], v71 offset:0
  ds_read_b64_tr_b16 a[58:59], v71 offset:256
  ds_read_b64_tr_b16 a[60:61], v71 offset:1024
  ds_read_b64_tr_b16 a[62:63], v71 offset:1280
  s_branch Lwd_6
Lwb_9:
  ds_read_b64_tr_b16 a[64:65], v68 offset:0
  ds_read_b64_tr_b16 a[66:67], v68 offset:256
  ds_read_b64_tr_b16 a[68:69], v68 offset:1024
  ds_read_b64_tr_b16 a[70:71], v68 offset:1280
  ds_read_b64_tr_b16 a[72:73], v69 offset:0
  ds_read_b64_tr_b16 a[74:75], v69 offset:256
  ds_read_b64_tr_b16 a[76:77], v69 offset:1024
  ds_read_b64_tr_b16 a[78:79], v69 offset:1280
  s_waitcnt lgkmcnt(4)
  ds_read_b64_tr_b16 a[80:81], v70 offset:0
  ds_read_b64_tr_b16 a[82:83], v70 offset:256
  ds_read_b64_tr_b16 a[84:85], v70 offset:1024
  ds_read_b64_tr_b16 a[86:87], v70 offset:1280
  ds_read_b64_tr_b16 a[88:89], v71 offset:0
  ds_read_b64_tr_b16 a[90:91], v71 offset:256
  ds_read_b64_tr_b16 a[92:93], v71 offset:1024
  ds_read_b64_tr_b16 a[94:95], v71 offset:1280
  s_branch Lwd_6
Lwb_10:
  ds_read_b64_tr_b16 a[96:97], v68 offset:0
  ds_read_b64_tr_b16 a[98:99], v68 offset:256
  ds_read_b64_tr_b16 a[100:101], v68 offset:1024
  ds_read_b64_tr_b16 a[102:103], v68 offset:1280
  ds_read_b64_tr_b16 a[104:105], v69 offset:0
  ds_read_b64_tr_b16 a[106:107], v69 offset:256
  ds_read_b64_tr_b16 a[108:109], v69 offset:1024
  ds_read_b64_tr_b16 a[110:111], v69 offset:1280
  s_waitcnt lgkmcnt(4)
  ds_read_b64_tr_b16 a[112:113], v70 offset:0
  ds_read_b64_tr_b16 a[114:115], v70 offset:256
  ds_read_b64_tr_b16 a[116:117], v70 offset:1024
  ds_read_b64_tr_b16 a[118:119], v70 offset:1280
  ds_read_b64_tr_b16 a[120:121], v71 offset:0
  ds_read_b64_tr_b16 a[122:123], v71 offset:256
  ds_read_b64_tr_b16 a[124:125], v71 offset:1024
  ds_read_b64_tr_b16 a[126:127], v71 offset:1280
Lwd_6:
  s_waitcnt lgkmcnt(0)
  s_waitcnt vmcnt(33)
  s_barrier
  s_add_u32 m0, s66, 131072
  s_add_u32 s75, s64, 4194304
  buffer_load_dwordx4 v40, s[36:39], s75 offen  lds
  s_add_u32 m0, m0, 1024
  s_add_u32 s75, s75, 65536
  buffer_load_dwordx4 v40, s[36:39], s75 offen  lds
  s_add_u32 m0, m0, 1024
  s_add_u32 s75, s75, 65536
  buffer_load_dwordx4 v41, s[36:39], s75 offen  lds
  s_add_u32 m0, m0, 1024
  s_add_u32 s75, s75, 65536
  buffer_load_dwordx4 v41, s[36:39], s75 offen  lds
  s_add_u32 m0, m0, 1024
  s_add_u32 s75, s75, 65536
  buffer_load_dwordx4 v42, s[36:39], s75 offen  lds
  s_add_u32 m0, m0, 1024
  s_add_u32 s75, s75, 65536
  buffer_load_dwordx4 v42, s[36:39], s75 offen  lds
  s_add_u32 m0, m0, 1024
  s_add_u32 s75, s75, 65536
  buffer_load_dwordx4 v43, s[36:39], s75 offen  lds
  s_add_u32 m0, m0, 1024
  s_add_u32 s75, s75, 65536
  buffer_load_dwordx4 v43, s[36:39], s75 offen  lds
  v_add_u32 v68, 0, v64
  v_add_u32 v69, 0, v65
  v_add_u32 v70, 0, v66
  v_add_u32 v71, 0, v67
  s_sub_u32 s75, 2, s50
  s_and_b32 s75, s75, 3
  s_cmp_eq_u32 s75, 1
  s_cbranch_scc1 Lwb_13
  s_cmp_eq_u32 s75, 2
  s_cbranch_scc1 Lwb_14
  s_cmp_eq_u32 s75, 3
  s_cbranch_scc1 Lwb_15
Lwb_12:
  ds_read_b64_tr_b16 a[0:1], v68 offset:0
  ds_read_b64_tr_b16 a[2:3], v68 offset:256
  ds_read_b64_tr_b16 a[4:5], v68 offset:1024
  ds_read_b64_tr_b16 a[6:7], v68 offset:1280
  ds_read_b64_tr_b16 a[8:9], v69 offset:0
  ds_read_b64_tr_b16 a[10:11], v69 offset:256
  ds_read_b64_tr_b16 a[12:13], v69 offset:1024
  ds_read_b64_tr_b16 a[14:15], v69 offset:1280
  s_waitcnt lgkmcnt(4)
  ds_read_b64_tr_b16 a[16:17], v70 offset:0
  ds_read_b64_tr_b16 a[18:19], v70 offset:256
  ds_read_b64_tr_b16 a[20:21], v70 offset:1024
  ds_read_b64_tr_b16 a[22:23], v70 offset:1280
  ds_read_b64_tr_b16 a[24:25], v71 offset:0
  ds_read_b64_tr_b16 a[26:27], v71 offset:256
  ds_read_b64_tr_b16 a[28:29], v71 offset:1024
  ds_read_b64_tr_b16 a[30:31], v71 offset:1280
  s_branch Lwd_11
Lwb_13:
  ds_read_b64_tr_b16 a[32:33], v68 offset:0
  ds_read_b64_tr_b16 a[34:35], v68 offset:256
  ds_read_b64_tr_b16 a[36:37], v68 offset:1024
  ds_read_b64_tr_b16 a[38:39], v68 offset:1280
  ds_read_b64_tr_b16 a[40:41], v69 offset:0
  ds_read_b64_tr_b16 a[42:43], v69 offset:256
  ds_read_b64_tr_b16 a[44:45], v69 offset:1024
  ds_read_b64_tr_b16 a[46:47], v69 offset:1280
  s_waitcnt lgkmcnt(4)
  ds_read_b64_tr_b16 a[48:49], v70 offset:0
  ds_read_b64_tr_b16 a[50:51], v70 offset:256
  ds_read_b64_tr_b16 a[52:53], v70 offset:1024
  ds_read_b64_tr_b16 a[54:55], v70 offset:1280
  ds_read_b64_tr_b16 a[56:57], v71 offset:0
  ds_read_b64_tr_b16 a[58:59], v71 offset:256
  ds_read_b64_tr_b16 a[60:61], v71 offset:1024
  ds_read_b64_tr_b16 a[62:63], v71 offset:1280
  s_branch Lwd_11
Lwb_14:
  ds_read_b64_tr_b16 a[64:65], v68 offset:0
  ds_read_b64_tr_b16 a[66:67], v68 offset:256
  ds_read_b64_tr_b16 a[68:69], v68 offset:1024
  ds_read_b64_tr_b16 a[70:71], v68 offset:1280
  ds_read_b64_tr_b16 a[72:73], v69 offset:0
  ds_read_b64_tr_b16 a[74:75], v69 offset:256
  ds_read_b64_tr_b16 a[76:77], v69 offset:1024
  ds_read_b64_tr_b16 a[78:79], v69 offset:1280
  s_waitcnt lgkmcnt(4)
  ds_read_b64_tr_b16 a[80:81], v70 offset:0
  ds_read_b64_tr_b16 a[82:83], v70 offset:256
  ds_read_b64_tr_b16 a[84:85], v70 offset:1024
  ds_read_b64_tr_b16 a[86:87], v70 offset:1280
  ds_read_b64_tr_b16 a[88:89], v71 offset:0
  ds_read_b64_tr_b16 a[90:91], v71 offset:256
  ds_read_b64_tr_b16 a[92:93], v71 offset:1024
  ds_read_b64_tr_b16 a[94:95], v71 offset:1280
  s_branch Lwd_11
Lwb_15:
  ds_read_b64_tr_b16 a[96:97], v68 offset:0
  ds_read_b64_tr_b16 a[98:99], v68 offset:256
  ds_read_b64_tr_b16 a[100:101], v68 offset:1024
  ds_read_b64_tr_b16 a[102:103], v68 offset:1280
  ds_read_b64_tr_b16 a[104:105], v69 offset:0
  ds_read_b64_tr_b16 a[106:107], v69 offset:256
  ds_read_b64_tr_b16 a[108:109], v69 offset:1024
  ds_read_b64_tr_b16 a[110:111], v69 offset:1280
  s_waitcnt lgkmcnt(4)
  ds_read_b64_tr_b16 a[112:113], v70 offset:0
  ds_read_b64_tr_b16 a[114:115], v70 offset:256
  ds_read_b64_tr_b16 a[116:117], v70 offset:1024
  ds_read_b64_tr_b16 a[118:119], v70 offset:1280
  ds_read_b64_tr_b16 a[120:121], v71 offset:0
  ds_read_b64_tr_b16 a[122:123], v71 offset:256
  ds_read_b64_tr_b16 a[124:125], v71 offset:1024
  ds_read_b64_tr_b16 a[126:127], v71 offset:1280
Lwd_11:
  s_waitcnt lgkmcnt(0)
  s_waitcnt vmcnt(33)
  s_barrier
  s_add_u32 m0, s66, 0
  s_add_u32 s75, s64, 6291456
  buffer_load_dwordx4 v40, s[36:39], s75 offen  lds
  s_add_u32 m0, m0, 1024
  s_add_u32 s75, s75, 65536
  buffer_load_dwordx4 v40, s[36:39], s75 offen  lds
  s_add_u32 m0, m0, 1024
  s_add_u32 s75, s75, 65536
  buffer_load_dwordx4 v41, s[36:39], s75 offen  lds
  s_add_u32 m0, m0, 1024
  s_add_u32 s75, s75, 65536
  buffer_load_dwordx4 v41, s[36:39], s75 offen  lds
  s_add_u32 m0, m0, 1024
  s_add_u32 s75, s75, 65536
  buffer_load_dwordx4 v42, s[36:39], s75 offen  lds
  s_add_u32 m0, m0, 1024
  s_add_u32 s75, s75, 65536
  buffer_load_dwordx4 v42, s[36:39], s75 offen  lds
  s_add_u32 m0, m0, 1024
  s_add_u32 s75, s75, 65536
  buffer_load_dwordx4 v43, s[36:39], s75 offen  lds
  s_add_u32 m0, m0, 1024
  s_add_u32 s75, s75, 65536
  buffer_load_dwordx4 v43, s[36:39], s75 offen  lds
  v_add_u32 v68, 32768, v64
  v_add_u32 v69, 32768, v65
  v_add_u32 v70, 32768, v66
  v_add_u32 v71, 32768, v67
  s_sub_u32 s75, 3, s50
  s_and_b32 s75, s75, 3
  s_cmp_eq_u32 s75, 1
  s_cbranch_scc1 Lwb_18
  s_cmp_eq_u32 s75, 2
  s_cbranch_scc1 Lwb_19
  s_cmp_eq_u32 s75, 3
  s_cbranch_scc1 Lwb_20
Lwb_17:
  ds_read_b64_tr_b16 a[0:1], v68 offset:0
  ds_read_b64_tr_b16 a[2:3], v68 offset:256
  ds_read_b64_tr_b16 a[4:5], v68 offset:1024
  ds_read_b64_tr_b16 a[6:7], v68 offset:1280
  ds_read_b64_tr_b16 a[8:9], v69 offset:0
  ds_read_b64_tr_b16 a[10:11], v69 offset:256
  ds_read_b64_tr_b16 a[12:13], v69 offset:1024
  ds_read_b64_tr_b16 a[14:15], v69 offset:1280
  s_waitcnt lgkmcnt(4)
  ds_read_b64_tr_b16 a[16:17], v70 offset:0
  ds_read_b64_tr_b16 a[18:19], v70 offset:256
  ds_read_b64_tr_b16 a[20:21], v70 offset:1024
  ds_read_b64_tr_b16 a[22:23], v70 offset:1280
  ds_read_b64_tr_b16 a[24:25], v71 offset:0
  ds_read_b64_tr_b16 a[26:27], v71 offset:256
  ds_read_b64_tr_b16 a[28:29], v71 offset:1024
  ds_read_b64_tr_b16 a[30:31], v71 offset:1280
  s_branch Lwd_16
Lwb_18:
  ds_read_b64_tr_b16 a[32:33], v68 offset:0
  ds_read_b64_tr_b16 a[34:35], v68 offset:256
  ds_read_b64_tr_b16 a[36:37], v68 offset:1024
  ds_read_b64_tr_b16 a[38:39], v68 offset:1280
  ds_read_b64_tr_b16 a[40:41], v69 offset:0
  ds_read_b64_tr_b16 a[42:43], v69 offset:256
  ds_read_b64_tr_b16 a[44:45], v69 offset:1024
  ds_read_b64_tr_b16 a[46:47], v69 offset:1280
  s_waitcnt lgkmcnt(4)
  ds_read_b64_tr_b16 a[48:49], v70 offset:0
  ds_read_b64_tr_b16 a[50:51], v70 offset:256
  ds_read_b64_tr_b16 a[52:53], v70 offset:1024
  ds_read_b64_tr_b16 a[54:55], v70 offset:1280
  ds_read_b64_tr_b16 a[56:57], v71 offset:0
  ds_read_b64_tr_b16 a[58:59], v71 offset:256
  ds_read_b64_tr_b16 a[60:61], v71 offset:1024
  ds_read_b64_tr_b16 a[62:63], v71 offset:1280
  s_branch Lwd_16
Lwb_19:
  ds_read_b64_tr_b16 a[64:65], v68 offset:0
  ds_read_b64_tr_b16 a[66:67], v68 offset:256
  ds_read_b64_tr_b16 a[68:69], v68 offset:1024
  ds_read_b64_tr_b16 a[70:71], v68 offset:1280
  ds_read_b64_tr_b16 a[72:73], v69 offset:0
  ds_read_b64_tr_b16 a[74:75], v69 offset:256
  ds_read_b64_tr_b16 a[76:77], v69 offset:1024
  ds_read_b64_tr_b16 a[78:79], v69 offset:1280
  s_waitcnt lgkmcnt(4)
  ds_read_b64_tr_b16 a[80:81], v70 offset:0
  ds_read_b64_tr_b16 a[82:83], v70 offset:256
  ds_read_b64_tr_b16 a[84:85], v70 offset:1024
  ds_read_b64_tr_b16 a[86:87], v70 offset:1280
  ds_read_b64_tr_b16 a[88:89], v71 offset:0
  ds_read_b64_tr_b16 a[90:91], v71 offset:256
  ds_read_b64_tr_b16 a[92:93], v71 offset:1024
  ds_read_b64_tr_b16 a[94:95], v71 offset:1280
  s_branch Lwd_16
Lwb_20:
  ds_read_b64_tr_b16 a[96:97], v68 offset:0
  ds_read_b64_tr_b16 a[98:99], v68 offset:256
  ds_read_b64_tr_b16 a[100:101], v68 offset:1024
  ds_read_b64_tr_b16 a[102:103], v68 offset:1280
  ds_read_b64_tr_b16 a[104:105], v69 offset:0
  ds_read_b64_tr_b16 a[106:107], v69 offset:256
  ds_read_b64_tr_b16 a[108:109], v69 offset:1024
  ds_read_b64_tr_b16 a[110:111], v69 offset:1280
  s_waitcnt lgkmcnt(4)
  ds_read_b64_tr_b16 a[112:113], v70 offset:0
  ds_read_b64_tr_b16 a[114:115], v70 offset:256
  ds_read_b64_tr_b16 a[116:117], v70 offset:1024
  ds_read_b64_tr_b16 a[118:119], v70 offset:1280
  ds_read_b64_tr_b16 a[120:121], v71 offset:0
  ds_read_b64_tr_b16 a[122:123], v71 offset:256
  ds_read_b64_tr_b16 a[124:125], v71 offset:1024
  ds_read_b64_tr_b16 a[126:127], v71 offset:1280
Lwd_16:
  s_waitcnt lgkmcnt(0)
  s_waitcnt vmcnt(24)
  s_barrier
  s_cmp_lg_u32 s50, 0
  s_cbranch_scc1 Lch_arr
  s_and_b32 s75, s1, 3
  s_lshl_b32 s75, s75, 4
  s_lshl_b64 s[76:77], 1, s75
  s_lshr_b32 s75, s1, 2
  s_lshl_b32 s75, s75, 3
  v_mov_b32 v54, s76
  v_mov_b32 v55, s77
  v_mov_b32 v56, s75
  s_mov_b64 exec, 1
  global_atomic_add_x2 v56, v[54:55], s[28:29] sc1
  s_mov_b64 exec, -1
Lch_arr:
  s_mov_b32 s36, s12
  s_and_b32 s37, s13, 0xffff
  s_mov_b32 s38, 8388608
  s_mov_b32 s39, 0x20000
  s_add_u32 m0, s66, 32768
  s_add_u32 s75, s64, 0
  buffer_load_dwordx4 v40, s[36:39], s75 offen  lds
  s_add_u32 m0, m0, 1024
  s_add_u32 s75, s75, 65536
  buffer_load_dwordx4 v40, s[36:39], s75 offen  lds
  s_add_u32 m0, m0, 1024
  s_add_u32 s75, s75, 65536
  buffer_load_dwordx4 v41, s[36:39], s75 offen  lds
  s_add_u32 m0, m0, 1024
  s_add_u32 s75, s75, 65536
  buffer_load_dwordx4 v41, s[36:39], s75 offen  lds
  s_add_u32 m0, m0, 1024
  s_add_u32 s75, s75, 65536
  buffer_load_dwordx4 v42, s[36:39], s75 offen  lds
  s_add_u32 m0, m0, 1024
  s_add_u32 s75, s75, 65536
  buffer_load_dwordx4 v42, s[36:39], s75 offen  lds
  s_add_u32 m0, m0, 1024
  s_add_u32 s75, s75, 65536
  buffer_load_dwordx4 v43, s[36:39], s75 offen  lds
  s_add_u32 m0, m0, 1024
  s_add_u32 s75, s75, 65536
  buffer_load_dwordx4 v43, s[36:39], s75 offen  lds
  v_add_u32 v68, 65536, v64
  v_add_u32 v69, 65536, v65
  v_add_u32 v70, 65536, v66
  v_add_u32 v71, 65536, v67
  s_sub_u32 s75, 0, s50
  s_and_b32 s75, s75, 3
  s_cmp_eq_u32 s75, 1
  s_cbranch_scc1 Lwb_23
  s_cmp_eq_u32 s75, 2
  s_cbranch_scc1 Lwb_24
  s_cmp_eq_u32 s75, 3
  s_cbranch_scc1 Lwb_25
Lwb_22:
  ds_read_b64_tr_b16 a[128:129], v68 offset:0
  ds_read_b64_tr_b16 a[130:131], v68 offset:256
  ds_read_b64_tr_b16 a[132:133], v68 offset:1024
  ds_read_b64_tr_b16 a[134:135], v68 offset:1280
  ds_read_b64_tr_b16 a[136:137], v69 offset:0
  ds_read_b64_tr_b16 a[138:139], v69 offset:256
  ds_read_b64_tr_b16 a[140:141], v69 offset:1024
  ds_read_b64_tr_b16 a[142:143], v69 offset:1280
  s_waitcnt lgkmcnt(4)
  ds_read_b64_tr_b16 a[144:145], v70 offset:0
  ds_read_b64_tr_b16 a[146:147], v70 offset:256
  ds_read_b64_tr_b16 a[148:149], v70 offset:1024
  ds_read_b64_tr_b16 a[150:151], v70 offset:1280
  ds_read_b64_tr_b16 a[152:153], v71 offset:0
  ds_read_b64_tr_b16 a[154:155], v71 offset:256
  ds_read_b64_tr_b16 a[156:157], v71 offset:1024
  ds_read_b64_tr_b16 a[158:159], v71 offset:1280
  s_branch Lwd_21
Lwb_23:
  ds_read_b64_tr_b16 a[160:161], v68 offset:0
  ds_read_b64_tr_b16 a[162:163], v68 offset:256
  ds_read_b64_tr_b16 a[164:165], v68 offset:1024
  ds_read_b64_tr_b16 a[166:167], v68 offset:1280
  ds_read_b64_tr_b16 a[168:169], v69 offset:0
  ds_read_b64_tr_b16 a[170:171], v69 offset:256
  ds_read_b64_tr_b16 a[172:173], v69 offset:1024
  ds_read_b64_tr_b16 a[174:175], v69 offset:1280
  s_waitcnt lgkmcnt(4)
  ds_read_b64_tr_b16 a[176:177], v70 offset:0
  ds_read_b64_tr_b16 a[178:179], v70 offset:256
  ds_read_b64_tr_b16 a[180:181], v70 offset:1024
  ds_read_b64_tr_b16 a[182:183], v70 offset:1280
  ds_read_b64_tr_b16 a[184:185], v71 offset:0
  ds_read_b64_tr_b16 a[186:187], v71 offset:256
  ds_read_b64_tr_b16 a[188:189], v71 offset:1024
  ds_read_b64_tr_b16 a[190:191], v71 offset:1280
  s_branch Lwd_21
Lwb_24:
  ds_read_b64_tr_b16 a[192:193], v68 offset:0
  ds_read_b64_tr_b16 a[194:195], v68 offset:256
  ds_read_b64_tr_b16 a[196:197], v68 offset:1024
  ds_read_b64_tr_b16 a[198:199], v68 offset:1280
  ds_read_b64_tr_b16 a[200:201], v69 offset:0
  ds_read_b64_tr_b16 a[202:203], v69 offset:256
  ds_read_b64_tr_b16 a[204:205], v69 offset:1024
  ds_read_b64_tr_b16 a[206:207], v69 offset:1280
  s_waitcnt lgkmcnt(4)
  ds_read_b64_tr_b16 a[208:209], v70 offset:0
  ds_read_b64_tr_b16 a[210:211], v70 offset:256
  ds_read_b64_tr_b16 a[212:213], v70 offset:1024
  ds_read_b64_tr_b16 a[214:215], v70 offset:1280
  ds_read_b64_tr_b16 a[216:217], v71 offset:0
  ds_read_b64_tr_b16 a[218:219], v71 offset:256
  ds_read_b64_tr_b16 a[220:221], v71 offset:1024
  ds_read_b64_tr_b16 a[222:223], v71 offset:1280
  s_branch Lwd_21
Lwb_25:
  ds_read_b64_tr_b16 a[224:225], v68 offset:0
  ds_read_b64_tr_b16 a[226:227], v68 offset:256
  ds_read_b64_tr_b16 a[228:229], v68 offset:1024
  ds_read_b64_tr_b16 a[230:231], v68 offset:1280
  ds_read_b64_tr_b16 a[232:233], v69 offset:0
  ds_read_b64_tr_b16 a[234:235], v69 offset:256
  ds_read_b64_tr_b16 a[236:237], v69 offset:1024
  ds_read_b64_tr_b16 a[238:239], v69 offset:1280
  s_waitcnt lgkmcnt(4)
  ds_read_b64_tr_b16 a[240:241], v70 offset:0
  ds_read_b64_tr_b16 a[242:243], v70 offset:256
  ds_read_b64_tr_b16 a[244:245], v70 offset:1024
  ds_read_b64_tr_b16 a[246:247], v70 offset:1280
  ds_read_b64_tr_b16 a[248:249], v71 offset:0
  ds_read_b64_tr_b16 a[250:251], v71 offset:256
  ds_read_b64_tr_b16 a[252:253], v71 offset:1024
  ds_read_b64_tr_b16 a[254:255], v71 offset:1280
Lwd_21:
  s_waitcnt lgkmcnt(0)
  s_waitcnt vmcnt(24)
  s_barrier
  s_add_u32 m0, s66, 65536
  s_add_u32 s75, s64, 2097152
  buffer_load_dwordx4 v40, s[36:39], s75 offen  lds
  s_add_u32 m0, m0, 1024
  s_add_u32 s75, s75, 65536
  buffer_load_dwordx4 v40, s[36:39], s75 offen  lds
  s_add_u32 m0, m0, 1024
  s_add_u32 s75, s75, 65536
  buffer_load_dwordx4 v41, s[36:39], s75 offen  lds
  s_add_u32 m0, m0, 1024
  s_add_u32 s75, s75, 65536
  buffer_load_dwordx4 v41, s[36:39], s75 offen  lds
  s_add_u32 m0, m0, 1024
  s_add_u32 s75, s75, 65536
  buffer_load_dwordx4 v42, s[36:39], s75 offen  lds
  s_add_u32 m0, m0, 1024
  s_add_u32 s75, s75, 65536
  buffer_load_dwordx4 v42, s[36:39], s75 offen  lds
  s_add_u32 m0, m0, 1024
  s_add_u32 s75, s75, 65536
  buffer_load_dwordx4 v43, s[36:39], s75 offen  lds
  s_add_u32 m0, m0, 1024
  s_add_u32 s75, s75, 65536
  buffer_load_dwordx4 v43, s[36:39], s75 offen  lds
  v_add_u32 v68, 98304, v64
  v_add_u32 v69, 98304, v65
  v_add_u32 v70, 98304, v66
  v_add_u32 v71, 98304, v67
  s_sub_u32 s75, 1, s50
  s_and_b32 s75, s75, 3
  s_cmp_eq_u32 s75, 1
  s_cbranch_scc1 Lwb_28
  s_cmp_eq_u32 s75, 2
  s_cbranch_scc1 Lwb_29
  s_cmp_eq_u32 s75, 3
  s_cbranch_scc1 Lwb_30
Lwb_27:
  ds_read_b64_tr_b16 a[128:129], v68 offset:0
  ds_read_b64_tr_b16 a[130:131], v68 offset:256
  ds_read_b64_tr_b16 a[132:133], v68 offset:1024
  ds_read_b64_tr_b16 a[134:135], v68 offset:1280
  ds_read_b64_tr_b16 a[136:137], v69 offset:0
  ds_read_b64_tr_b16 a[138:139], v69 offset:256
  ds_read_b64_tr_b16 a[140:141], v69 offset:1024
  ds_read_b64_tr_b16 a[142:143], v69 offset:1280
  s_waitcnt lgkmcnt(4)
  ds_read_b64_tr_b16 a[144:145], v70 offset:0
  ds_read_b64_tr_b16 a[146:147], v70 offset:256
  ds_read_b64_tr_b16 a[148:149], v70 offset:1024
  ds_read_b64_tr_b16 a[150:151], v70 offset:1280
  ds_read_b64_tr_b16 a[152:153], v71 offset:0
  ds_read_b64_tr_b16 a[154:155], v71 offset:256
  ds_read_b64_tr_b16 a[156:157], v71 offset:1024
  ds_read_b64_tr_b16 a[158:159], v71 offset:1280
  s_branch Lwd_26
Lwb_28:
  ds_read_b64_tr_b16 a[160:161], v68 offset:0
  ds_read_b64_tr_b16 a[162:163], v68 offset:256
  ds_read_b64_tr_b16 a[164:165], v68 offset:1024
  ds_read_b64_tr_b16 a[166:167], v68 offset:1280
  ds_read_b64_tr_b16 a[168:169], v69 offset:0
  ds_read_b64_tr_b16 a[170:171], v69 offset:256
  ds_read_b64_tr_b16 a[172:173], v69 offset:1024
  ds_read_b64_tr_b16 a[174:175], v69 offset:1280
  s_waitcnt lgkmcnt(4)
  ds_read_b64_tr_b16 a[176:177], v70 offset:0
  ds_read_b64_tr_b16 a[178:179], v70 offset:256
  ds_read_b64_tr_b16 a[180:181], v70 offset:1024
  ds_read_b64_tr_b16 a[182:183], v70 offset:1280
  ds_read_b64_tr_b16 a[184:185], v71 offset:0
  ds_read_b64_tr_b16 a[186:187], v71 offset:256
  ds_read_b64_tr_b16 a[188:189], v71 offset:1024
  ds_read_b64_tr_b16 a[190:191], v71 offset:1280
  s_branch Lwd_26
Lwb_29:
  ds_read_b64_tr_b16 a[192:193], v68 offset:0
  ds_read_b64_tr_b16 a[194:195], v68 offset:256
  ds_read_b64_tr_b16 a[196:197], v68 offset:1024
  ds_read_b64_tr_b16 a[198:199], v68 offset:1280
  ds_read_b64_tr_b16 a[200:201], v69 offset:0
  ds_read_b64_tr_b16 a[202:203], v69 offset:256
  ds_read_b64_tr_b16 a[204:205], v69 offset:1024
  ds_read_b64_tr_b16 a[206:207], v69 offset:1280
  s_waitcnt lgkmcnt(4)
  ds_read_b64_tr_b16 a[208:209], v70 offset:0
  ds_read_b64_tr_b16 a[210:211], v70 offset:256
  ds_read_b64_tr_b16 a[212:213], v70 offset:1024
  ds_read_b64_tr_b16 a[214:215], v70 offset:1280
  ds_read_b64_tr_b16 a[216:217], v71 offset:0
  ds_read_b64_tr_b16 a[218:219], v71 offset:256
  ds_read_b64_tr_b16 a[220:221], v71 offset:1024
  ds_read_b64_tr_b16 a[222:223], v71 offset:1280
  s_branch Lwd_26
Lwb_30:
  ds_read_b64_tr_b16 a[224:225], v68 offset:0
  ds_read_b64_tr_b16 a[226:227], v68 offset:256
  ds_read_b64_tr_b16 a[228:229], v68 offset:1024
  ds_read_b64_tr_b16 a[230:231], v68 offset:1280
  ds_read_b64_tr_b16 a[232:233], v69 offset:0
  ds_read_b64_tr_b16 a[234:235], v69 offset:256
  ds_read_b64_tr_b16 a[236:237], v69 offset:1024
  ds_read_b64_tr_b16 a[238:239], v69 offset:1280
  s_waitcnt lgkmcnt(4)
  ds_read_b64_tr_b16 a[240:241], v70 offset:0
  ds_read_b64_tr_b16 a[242:243], v70 offset:256
  ds_read_b64_tr_b16 a[244:245], v70 offset:1024
  ds_read_b64_tr_b16 a[246:247], v70 offset:1280
  ds_read_b64_tr_b16 a[248:249], v71 offset:0
  ds_read_b64_tr_b16 a[250:251], v71 offset:256
  ds_read_b64_tr_b16 a[252:253], v71 offset:1024
  ds_read_b64_tr_b16 a[254:255], v71 offset:1280
Lwd_26:
  s_waitcnt lgkmcnt(0)
  s_waitcnt vmcnt(24)
  s_barrier
  s_add_u32 m0, s66, 98304
  s_add_u32 s75, s64, 4194304
  buffer_load_dwordx4 v40, s[36:39], s75 offen  lds
  s_add_u32 m0, m0, 1024
  s_add_u32 s75, s75, 65536
  buffer_load_dwordx4 v40, s[36:39], s75 offen  lds
  s_add_u32 m0, m0, 1024
  s_add_u32 s75, s75, 65536
  buffer_load_dwordx4 v41, s[36:39], s75 offen  lds
  s_add_u32 m0, m0, 1024
  s_add_u32 s75, s75, 65536
  buffer_load_dwordx4 v41, s[36:39], s75 offen  lds
  s_add_u32 m0, m0, 1024
  s_add_u32 s75, s75, 65536
  buffer_load_dwordx4 v42, s[36:39], s75 offen  lds
  s_add_u32 m0, m0, 1024
  s_add_u32 s75, s75, 65536
  buffer_load_dwordx4 v42, s[36:39], s75 offen  lds
  s_add_u32 m0, m0, 1024
  s_add_u32 s75, s75, 65536
  buffer_load_dwordx4 v43, s[36:39], s75 offen  lds
  s_add_u32 m0, m0, 1024
  s_add_u32 s75, s75, 65536
  buffer_load_dwordx4 v43, s[36:39], s75 offen  lds
  v_add_u32 v68, 131072, v64
  v_add_u32 v69, 131072, v65
  v_add_u32 v70, 131072, v66
  v_add_u32 v71, 131072, v67
  s_sub_u32 s75, 2, s50
  s_and_b32 s75, s75, 3
  s_cmp_eq_u32 s75, 1
  s_cbranch_scc1 Lwb_33
  s_cmp_eq_u32 s75, 2
  s_cbranch_scc1 Lwb_34
  s_cmp_eq_u32 s75, 3
  s_cbranch_scc1 Lwb_35
Lwb_32:
  ds_read_b64_tr_b16 a[128:129], v68 offset:0
  ds_read_b64_tr_b16 a[130:131], v68 offset:256
  ds_read_b64_tr_b16 a[132:133], v68 offset:1024
  ds_read_b64_tr_b16 a[134:135], v68 offset:1280
  ds_read_b64_tr_b16 a[136:137], v69 offset:0
  ds_read_b64_tr_b16 a[138:139], v69 offset:256
  ds_read_b64_tr_b16 a[140:141], v69 offset:1024
  ds_read_b64_tr_b16 a[142:143], v69 offset:1280
  s_waitcnt lgkmcnt(4)
  ds_read_b64_tr_b16 a[144:145], v70 offset:0
  ds_read_b64_tr_b16 a[146:147], v70 offset:256
  ds_read_b64_tr_b16 a[148:149], v70 offset:1024
  ds_read_b64_tr_b16 a[150:151], v70 offset:1280
  ds_read_b64_tr_b16 a[152:153], v71 offset:0
  ds_read_b64_tr_b16 a[154:155], v71 offset:256
  ds_read_b64_tr_b16 a[156:157], v71 offset:1024
  ds_read_b64_tr_b16 a[158:159], v71 offset:1280
  s_branch Lwd_31
Lwb_33:
  ds_read_b64_tr_b16 a[160:161], v68 offset:0
  ds_read_b64_tr_b16 a[162:163], v68 offset:256
  ds_read_b64_tr_b16 a[164:165], v68 offset:1024
  ds_read_b64_tr_b16 a[166:167], v68 offset:1280
  ds_read_b64_tr_b16 a[168:169], v69 offset:0
  ds_read_b64_tr_b16 a[170:171], v69 offset:256
  ds_read_b64_tr_b16 a[172:173], v69 offset:1024
  ds_read_b64_tr_b16 a[174:175], v69 offset:1280
  s_waitcnt lgkmcnt(4)
  ds_read_b64_tr_b16 a[176:177], v70 offset:0
  ds_read_b64_tr_b16 a[178:179], v70 offset:256
  ds_read_b64_tr_b16 a[180:181], v70 offset:1024
  ds_read_b64_tr_b16 a[182:183], v70 offset:1280
  ds_read_b64_tr_b16 a[184:185], v71 offset:0
  ds_read_b64_tr_b16 a[186:187], v71 offset:256
  ds_read_b64_tr_b16 a[188:189], v71 offset:1024
  ds_read_b64_tr_b16 a[190:191], v71 offset:1280
  s_branch Lwd_31
Lwb_34:
  ds_read_b64_tr_b16 a[192:193], v68 offset:0
  ds_read_b64_tr_b16 a[194:195], v68 offset:256
  ds_read_b64_tr_b16 a[196:197], v68 offset:1024
  ds_read_b64_tr_b16 a[198:199], v68 offset:1280
  ds_read_b64_tr_b16 a[200:201], v69 offset:0
  ds_read_b64_tr_b16 a[202:203], v69 offset:256
  ds_read_b64_tr_b16 a[204:205], v69 offset:1024
  ds_read_b64_tr_b16 a[206:207], v69 offset:1280
  s_waitcnt lgkmcnt(4)
  ds_read_b64_tr_b16 a[208:209], v70 offset:0
  ds_read_b64_tr_b16 a[210:211], v70 offset:256
  ds_read_b64_tr_b16 a[212:213], v70 offset:1024
  ds_read_b64_tr_b16 a[214:215], v70 offset:1280
  ds_read_b64_tr_b16 a[216:217], v71 offset:0
  ds_read_b64_tr_b16 a[218:219], v71 offset:256
  ds_read_b64_tr_b16 a[220:221], v71 offset:1024
  ds_read_b64_tr_b16 a[222:223], v71 offset:1280
  s_branch Lwd_31
Lwb_35:
  ds_read_b64_tr_b16 a[224:225], v68 offset:0
  ds_read_b64_tr_b16 a[226:227], v68 offset:256
  ds_read_b64_tr_b16 a[228:229], v68 offset:1024
  ds_read_b64_tr_b16 a[230:231], v68 offset:1280
  ds_read_b64_tr_b16 a[232:233], v69 offset:0
  ds_read_b64_tr_b16 a[234:235], v69 offset:256
  ds_read_b64_tr_b16 a[236:237], v69 offset:1024
  ds_read_b64_tr_b16 a[238:239], v69 offset:1280
  s_waitcnt lgkmcnt(4)
  ds_read_b64_tr_b16 a[240:241], v70 offset:0
  ds_read_b64_tr_b16 a[242:243], v70 offset:256
  ds_read_b64_tr_b16 a[244:245], v70 offset:1024
  ds_read_b64_tr_b16 a[246:247], v70 offset:1280
  ds_read_b64_tr_b16 a[248:249], v71 offset:0
  ds_read_b64_tr_b16 a[250:251], v71 offset:256
  ds_read_b64_tr_b16 a[252:253], v71 offset:1024
  ds_read_b64_tr_b16 a[254:255], v71 offset:1280
Lwd_31:
  s_waitcnt lgkmcnt(0)
  s_waitcnt vmcnt(24)
  s_barrier
  s_add_u32 m0, s66, 131072
  s_add_u32 s75, s64, 6291456
  buffer_load_dwordx4 v40, s[36:39], s75 offen  lds
  s_add_u32 m0, m0, 1024
  s_add_u32 s75, s75, 65536
  buffer_load_dwordx4 v40, s[36:39], s75 offen  lds
  s_add_u32 m0, m0, 1024
  s_add_u32 s75, s75, 65536
  buffer_load_dwordx4 v41, s[36:39], s75 offen  lds
  s_add_u32 m0, m0, 1024
  s_add_u32 s75, s75, 65536
  buffer_load_dwordx4 v41, s[36:39], s75 offen  lds
  s_add_u32 m0, m0, 1024
  s_add_u32 s75, s75, 65536
  buffer_load_dwordx4 v42, s[36:39], s75 offen  lds
  s_add_u32 m0, m0, 1024
  s_add_u32 s75, s75, 65536
  buffer_load_dwordx4 v42, s[36:39], s75 offen  lds
  s_add_u32 m0, m0, 1024
  s_add_u32 s75, s75, 65536
  buffer_load_dwordx4 v43, s[36:39], s75 offen  lds
  s_add_u32 m0, m0, 1024
  s_add_u32 s75, s75, 65536
  buffer_load_dwordx4 v43, s[36:39], s75 offen  lds
  v_add_u32 v68, 0, v64
  v_add_u32 v69, 0, v65
  v_add_u32 v70, 0, v66
  v_add_u32 v71, 0, v67
  s_sub_u32 s75, 3, s50
  s_and_b32 s75, s75, 3
  s_cmp_eq_u32 s75, 1
  s_cbranch_scc1 Lwb_38
  s_cmp_eq_u32 s75, 2
  s_cbranch_scc1 Lwb_39
  s_cmp_eq_u32 s75, 3
  s_cbranch_scc1 Lwb_40
Lwb_37:
  ds_read_b64_tr_b16 a[128:129], v68 offset:0
  ds_read_b64_tr_b16 a[130:131], v68 offset:256
  ds_read_b64_tr_b16 a[132:133], v68 offset:1024
  ds_read_b64_tr_b16 a[134:135], v68 offset:1280
  ds_read_b64_tr_b16 a[136:137], v69 offset:0
  ds_read_b64_tr_b16 a[138:139], v69 offset:256
  ds_read_b64_tr_b16 a[140:141], v69 offset:1024
  ds_read_b64_tr_b16 a[142:143], v69 offset:1280
  s_waitcnt lgkmcnt(4)
  ds_read_b64_tr_b16 a[144:145], v70 offset:0
  ds_read_b64_tr_b16 a[146:147], v70 offset:256
  ds_read_b64_tr_b16 a[148:149], v70 offset:1024
  ds_read_b64_tr_b16 a[150:151], v70 offset:1280
  ds_read_b64_tr_b16 a[152:153], v71 offset:0
  ds_read_b64_tr_b16 a[154:155], v71 offset:256
  ds_read_b64_tr_b16 a[156:157], v71 offset:1024
  ds_read_b64_tr_b16 a[158:159], v71 offset:1280
  s_branch Lwd_36
Lwb_38:
  ds_read_b64_tr_b16 a[160:161], v68 offset:0
  ds_read_b64_tr_b16 a[162:163], v68 offset:256
  ds_read_b64_tr_b16 a[164:165], v68 offset:1024
  ds_read_b64_tr_b16 a[166:167], v68 offset:1280
  ds_read_b64_tr_b16 a[168:169], v69 offset:0
  ds_read_b64_tr_b16 a[170:171], v69 offset:256
  ds_read_b64_tr_b16 a[172:173], v69 offset:1024
  ds_read_b64_tr_b16 a[174:175], v69 offset:1280
  s_waitcnt lgkmcnt(4)
  ds_read_b64_tr_b16 a[176:177], v70 offset:0
  ds_read_b64_tr_b16 a[178:179], v70 offset:256
  ds_read_b64_tr_b16 a[180:181], v70 offset:1024
  ds_read_b64_tr_b16 a[182:183], v70 offset:1280
  ds_read_b64_tr_b16 a[184:185], v71 offset:0
  ds_read_b64_tr_b16 a[186:187], v71 offset:256
  ds_read_b64_tr_b16 a[188:189], v71 offset:1024
  ds_read_b64_tr_b16 a[190:191], v71 offset:1280
  s_branch Lwd_36
Lwb_39:
  ds_read_b64_tr_b16 a[192:193], v68 offset:0
  ds_read_b64_tr_b16 a[194:195], v68 offset:256
  ds_read_b64_tr_b16 a[196:197], v68 offset:1024
  ds_read_b64_tr_b16 a[198:199], v68 offset:1280
  ds_read_b64_tr_b16 a[200:201], v69 offset:0
  ds_read_b64_tr_b16 a[202:203], v69 offset:256
  ds_read_b64_tr_b16 a[204:205], v69 offset:1024
  ds_read_b64_tr_b16 a[206:207], v69 offset:1280
  s_waitcnt lgkmcnt(4)
  ds_read_b64_tr_b16 a[208:209], v70 offset:0
  ds_read_b64_tr_b16 a[210:211], v70 offset:256
  ds_read_b64_tr_b16 a[212:213], v70 offset:1024
  ds_read_b64_tr_b16 a[214:215], v70 offset:1280
  ds_read_b64_tr_b16 a[216:217], v71 offset:0
  ds_read_b64_tr_b16 a[218:219], v71 offset:256
  ds_read_b64_tr_b16 a[220:221], v71 offset:1024
  ds_read_b64_tr_b16 a[222:223], v71 offset:1280
  s_branch Lwd_36
Lwb_40:
  ds_read_b64_tr_b16 a[224:225], v68 offset:0
  ds_read_b64_tr_b16 a[226:227], v68 offset:256
  ds_read_b64_tr_b16 a[228:229], v68 offset:1024
  ds_read_b64_tr_b16 a[230:231], v68 offset:1280
  ds_read_b64_tr_b16 a[232:233], v69 offset:0
  ds_read_b64_tr_b16 a[234:235], v69 offset:256
  ds_read_b64_tr_b16 a[236:237], v69 offset:1024
  ds_read_b64_tr_b16 a[238:239], v69 offset:1280
  s_waitcnt lgkmcnt(4)
  ds_read_b64_tr_b16 a[240:241], v70 offset:0
  ds_read_b64_tr_b16 a[242:243], v70 offset:256
  ds_read_b64_tr_b16 a[244:245], v70 offset:1024
  ds_read_b64_tr_b16 a[246:247], v70 offset:1280
  ds_read_b64_tr_b16 a[248:249], v71 offset:0
  ds_read_b64_tr_b16 a[250:251], v71 offset:256
  ds_read_b64_tr_b16 a[252:253], v71 offset:1024
  ds_read_b64_tr_b16 a[254:255], v71 offset:1280
Lwd_36:
  s_waitcnt lgkmcnt(0)
  s_waitcnt vmcnt(24)
  s_barrier
  s_mov_b32 s36, s14
  s_and_b32 s37, s15, 0xffff
  s_mov_b32 s38, 8388608
  s_mov_b32 s39, 0x20000
  s_add_u32 m0, s66, 0
  s_add_u32 s75, s65, 0
  buffer_load_dwordx4 v44, s[36:39], s75 offen  lds
  s_add_u32 m0, m0, 1024
  s_add_u32 s75, s75, 32768
  buffer_load_dwordx4 v44, s[36:39], s75 offen  lds
  s_add_u32 m0, m0, 1024
  s_add_u32 s75, s75, 32768
  buffer_load_dwordx4 v44, s[36:39], s75 offen  lds
  s_add_u32 m0, m0, 1024
  s_add_u32 s75, s75, 32768
  buffer_load_dwordx4 v44, s[36:39], s75 offen  lds
  s_add_u32 m0, m0, 1024
  s_add_u32 s75, s75, 32768
  buffer_load_dwordx4 v44, s[36:39], s75 offen  lds
  s_add_u32 m0, m0, 1024
  s_add_u32 s75, s75, 32768
  buffer_load_dwordx4 v44, s[36:39], s75 offen  lds
  s_add_u32 m0, m0, 1024
  s_add_u32 s75, s75, 32768
  buffer_load_dwordx4 v44, s[36:39], s75 offen  lds
  s_add_u32 m0, m0, 1024
  s_add_u32 s75, s75, 32768
  buffer_load_dwordx4 v44, s[36:39], s75 offen  lds
  v_add_u32 v68, 32768, v64
  v_add_u32 v69, 32768, v65
  v_add_u32 v70, 32768, v66
  v_add_u32 v71, 32768, v67
  s_sub_u32 s75, 0, s50
  s_and_b32 s75, s75, 3
  s_cmp_eq_u32 s75, 1
  s_cbranch_scc1 Lwb_43
  s_cmp_eq_u32 s75, 2
  s_cbranch_scc1 Lwb_44
  s_cmp_eq_u32 s75, 3
  s_cbranch_scc1 Lwb_45
Lwb_42:
  ds_read_b64_tr_b16 v[128:129], v68 offset:0
  ds_read_b64_tr_b16 v[130:131], v68 offset:256
  ds_read_b64_tr_b16 v[132:133], v68 offset:1024
  ds_read_b64_tr_b16 v[134:135], v68 offset:1280
  ds_read_b64_tr_b16 v[136:137], v69 offset:0
  ds_read_b64_tr_b16 v[138:139], v69 offset:256
  ds_read_b64_tr_b16 v[140:141], v69 offset:1024
  ds_read_b64_tr_b16 v[142:143], v69 offset:1280
  s_waitcnt lgkmcnt(4)
  ds_read_b64_tr_b16 v[144:145], v70 offset:0
  ds_read_b64_tr_b16 v[146:147], v70 offset:256
  ds_read_b64_tr_b16 v[148:149], v70 offset:1024
  ds_read_b64_tr_b16 v[150:151], v70 offset:1280
  ds_read_b64_tr_b16 v[152:153], v71 offset:0
  ds_read_b64_tr_b16 v[154:155], v71 offset:256
  ds_read_b64_tr_b16 v[156:157], v71 offset:1024
  ds_read_b64_tr_b16 v[158:159], v71 offset:1280
  s_branch Lwd_41
Lwb_43:
  ds_read_b64_tr_b16 v[160:161], v68 offset:0
  ds_read_b64_tr_b16 v[162:163], v68 offset:256
  ds_read_b64_tr_b16 v[164:165], v68 offset:1024
  ds_read_b64_tr_b16 v[166:167], v68 offset:1280
  ds_read_b64_tr_b16 v[168:169], v69 offset:0
  ds_read_b64_tr_b16 v[170:171], v69 offset:256
  ds_read_b64_tr_b16 v[172:173], v69 offset:1024
  ds_read_b64_tr_b16 v[174:175], v69 offset:1280
  s_waitcnt lgkmcnt(4)
  ds_read_b64_tr_b16 v[176:177], v70 offset:0
  ds_read_b64_tr_b16 v[178:179], v70 offset:256
  ds_read_b64_tr_b16 v[180:181], v70 offset:1024
  ds_read_b64_tr_b16 v[182:183], v70 offset:1280
  ds_read_b64_tr_b16 v[184:185], v71 offset:0
  ds_read_b64_tr_b16 v[186:187], v71 offset:256
  ds_read_b64_tr_b16 v[188:189], v71 offset:1024
  ds_read_b64_tr_b16 v[190:191], v71 offset:1280
  s_branch Lwd_41
Lwb_44:
  ds_read_b64_tr_b16 v[192:193], v68 offset:0
  ds_read_b64_tr_b16 v[194:195], v68 offset:256
  ds_read_b64_tr_b16 v[196:197], v68 offset:1024
  ds_read_b64_tr_b16 v[198:199], v68 offset:1280
  ds_read_b64_tr_b16 v[200:201], v69 offset:0
  ds_read_b64_tr_b16 v[202:203], v69 offset:256
  ds_read_b64_tr_b16 v[204:205], v69 offset:1024
  ds_read_b64_tr_b16 v[206:207], v69 offset:1280
  s_waitcnt lgkmcnt(4)
  ds_read_b64_tr_b16 v[208:209], v70 offset:0
  ds_read_b64_tr_b16 v[210:211], v70 offset:256
  ds_read_b64_tr_b16 v[212:213], v70 offset:1024
  ds_read_b64_tr_b16 v[214:215], v70 offset:1280
  ds_read_b64_tr_b16 v[216:217], v71 offset:0
  ds_read_b64_tr_b16 v[218:219], v71 offset:256
  ds_read_b64_tr_b16 v[220:221], v71 offset:1024
  ds_read_b64_tr_b16 v[222:223], v71 offset:1280
  s_branch Lwd_41
Lwb_45:
  ds_read_b64_tr_b16 v[224:225], v68 offset:0
  ds_read_b64_tr_b16 v[226:227], v68 offset:256
  ds_read_b64_tr_b16 v[228:229], v68 offset:1024
  ds_read_b64_tr_b16 v[230:231], v68 offset:1280
  ds_read_b64_tr_b16 v[232:233], v69 offset:0
  ds_read_b64_tr_b16 v[234:235], v69 offset:256
  ds_read_b64_tr_b16 v[236:237], v69 offset:1024
  ds_read_b64_tr_b16 v[238:239], v69 offset:1280
  s_waitcnt lgkmcnt(4)
  ds_read_b64_tr_b16 v[240:241], v70 offset:0
  ds_read_b64_tr_b16 v[242:243], v70 offset:256
  ds_read_b64_tr_b16 v[244:245], v70 offset:1024
  ds_read_b64_tr_b16 v[246:247], v70 offset:1280
  ds_read_b64_tr_b16 v[248:249], v71 offset:0
  ds_read_b64_tr_b16 v[250:251], v71 offset:256
  ds_read_b64_tr_b16 v[252:253], v71 offset:1024
  ds_read_b64_tr_b16 v[254:255], v71 offset:1280
Lwd_41:
  s_waitcnt lgkmcnt(0)
  s_waitcnt vmcnt(24)
  s_barrier
  s_add_u32 m0, s66, 32768
  s_add_u32 s75, s65, 1048576
  buffer_load_dwordx4 v44, s[36:39], s75 offen  lds
  s_add_u32 m0, m0, 1024
  s_add_u32 s75, s75, 32768
  buffer_load_dwordx4 v44, s[36:39], s75 offen  lds
  s_add_u32 m0, m0, 1024
  s_add_u32 s75, s75, 32768
  buffer_load_dwordx4 v44, s[36:39], s75 offen  lds
  s_add_u32 m0, m0, 1024
  s_add_u32 s75, s75, 32768
  buffer_load_dwordx4 v44, s[36:39], s75 offen  lds
  s_add_u32 m0, m0, 1024
  s_add_u32 s75, s75, 32768
  buffer_load_dwordx4 v44, s[36:39], s75 offen  lds
  s_add_u32 m0, m0, 1024
  s_add_u32 s75, s75, 32768
  buffer_load_dwordx4 v44, s[36:39], s75 offen  lds
  s_add_u32 m0, m0, 1024
  s_add_u32 s75, s75, 32768
  buffer_load_dwordx4 v44, s[36:39], s75 offen  lds
  s_add_u32 m0, m0, 1024
  s_add_u32 s75, s75, 32768
  buffer_load_dwordx4 v44, s[36:39], s75 offen  lds
  v_add_u32 v68, 65536, v64
  v_add_u32 v69, 65536, v65
  v_add_u32 v70, 65536, v66
  v_add_u32 v71, 65536, v67
  s_sub_u32 s75, 1, s50
  s_and_b32 s75, s75, 3
  s_cmp_eq_u32 s75, 1
  s_cbranch_scc1 Lwb_48
  s_cmp_eq_u32 s75, 2
  s_cbranch_scc1 Lwb_49
  s_cmp_eq_u32 s75, 3
  s_cbranch_scc1 Lwb_50
Lwb_47:
  ds_read_b64_tr_b16 v[128:129], v68 offset:0
  ds_read_b64_tr_b16 v[130:131], v68 offset:256
  ds_read_b64_tr_b16 v[132:133], v68 offset:1024
  ds_read_b64_tr_b16 v[134:135], v68 offset:1280
  ds_read_b64_tr_b16 v[136:137], v69 offset:0
  ds_read_b64_tr_b16 v[138:139], v69 offset:256
  ds_read_b64_tr_b16 v[140:141], v69 offset:1024
  ds_read_b64_tr_b16 v[142:143], v69 offset:1280
  s_waitcnt lgkmcnt(4)
  ds_read_b64_tr_b16 v[144:145], v70 offset:0
  ds_read_b64_tr_b16 v[146:147], v70 offset:256
  ds_read_b64_tr_b16 v[148:149], v70 offset:1024
  ds_read_b64_tr_b16 v[150:151], v70 offset:1280
  ds_read_b64_tr_b16 v[152:153], v71 offset:0
  ds_read_b64_tr_b16 v[154:155], v71 offset:256
  ds_read_b64_tr_b16 v[156:157], v71 offset:1024
  ds_read_b64_tr_b16 v[158:159], v71 offset:1280
  s_branch Lwd_46
Lwb_48:
  ds_read_b64_tr_b16 v[160:161], v68 offset:0
  ds_read_b64_tr_b16 v[162:163], v68 offset:256
  ds_read_b64_tr_b16 v[164:165], v68 offset:1024
  ds_read_b64_tr_b16 v[166:167], v68 offset:1280
  ds_read_b64_tr_b16 v[168:169], v69 offset:0
  ds_read_b64_tr_b16 v[170:171], v69 offset:256
  ds_read_b64_tr_b16 v[172:173], v69 offset:1024
  ds_read_b64_tr_b16 v[174:175], v69 offset:1280
  s_waitcnt lgkmcnt(4)
  ds_read_b64_tr_b16 v[176:177], v70 offset:0
  ds_read_b64_tr_b16 v[178:179], v70 offset:256
  ds_read_b64_tr_b16 v[180:181], v70 offset:1024
  ds_read_b64_tr_b16 v[182:183], v70 offset:1280
  ds_read_b64_tr_b16 v[184:185], v71 offset:0
  ds_read_b64_tr_b16 v[186:187], v71 offset:256
  ds_read_b64_tr_b16 v[188:189], v71 offset:1024
  ds_read_b64_tr_b16 v[190:191], v71 offset:1280
  s_branch Lwd_46
Lwb_49:
  ds_read_b64_tr_b16 v[192:193], v68 offset:0
  ds_read_b64_tr_b16 v[194:195], v68 offset:256
  ds_read_b64_tr_b16 v[196:197], v68 offset:1024
  ds_read_b64_tr_b16 v[198:199], v68 offset:1280
  ds_read_b64_tr_b16 v[200:201], v69 offset:0
  ds_read_b64_tr_b16 v[202:203], v69 offset:256
  ds_read_b64_tr_b16 v[204:205], v69 offset:1024
  ds_read_b64_tr_b16 v[206:207], v69 offset:1280
  s_waitcnt lgkmcnt(4)
  ds_read_b64_tr_b16 v[208:209], v70 offset:0
  ds_read_b64_tr_b16 v[210:211], v70 offset:256
  ds_read_b64_tr_b16 v[212:213], v70 offset:1024
  ds_read_b64_tr_b16 v[214:215], v70 offset:1280
  ds_read_b64_tr_b16 v[216:217], v71 offset:0
  ds_read_b64_tr_b16 v[218:219], v71 offset:256
  ds_read_b64_tr_b16 v[220:221], v71 offset:1024
  ds_read_b64_tr_b16 v[222:223], v71 offset:1280
  s_branch Lwd_46
Lwb_50:
  ds_read_b64_tr_b16 v[224:225], v68 offset:0
  ds_read_b64_tr_b16 v[226:227], v68 offset:256
  ds_read_b64_tr_b16 v[228:229], v68 offset:1024
  ds_read_b64_tr_b16 v[230:231], v68 offset:1280
  ds_read_b64_tr_b16 v[232:233], v69 offset:0
  ds_read_b64_tr_b16 v[234:235], v69 offset:256
  ds_read_b64_tr_b16 v[236:237], v69 offset:1024
  ds_read_b64_tr_b16 v[238:239], v69 offset:1280
  s_waitcnt lgkmcnt(4)
  ds_read_b64_tr_b16 v[240:241], v70 offset:0
  ds_read_b64_tr_b16 v[242:243], v70 offset:256
  ds_read_b64_tr_b16 v[244:245], v70 offset:1024
  ds_read_b64_tr_b16 v[246:247], v70 offset:1280
  ds_read_b64_tr_b16 v[248:249], v71 offset:0
  ds_read_b64_tr_b16 v[250:251], v71 offset:256
  ds_read_b64_tr_b16 v[252:253], v71 offset:1024
  ds_read_b64_tr_b16 v[254:255], v71 offset:1280
Lwd_46:
  s_waitcnt lgkmcnt(0)
  s_waitcnt vmcnt(24)
  s_barrier
  s_add_u32 m0, s66, 65536
  s_add_u32 s75, s65, 2097152
  buffer_load_dwordx4 v44, s[36:39], s75 offen  lds
  s_add_u32 m0, m0, 1024
  s_add_u32 s75, s75, 32768
  buffer_load_dwordx4 v44, s[36:39], s75 offen  lds
  s_add_u32 m0, m0, 1024
  s_add_u32 s75, s75, 32768
  buffer_load_dwordx4 v44, s[36:39], s75 offen  lds
  s_add_u32 m0, m0, 1024
  s_add_u32 s75, s75, 32768
  buffer_load_dwordx4 v44, s[36:39], s75 offen  lds
  s_add_u32 m0, m0, 1024
  s_add_u32 s75, s75, 32768
  buffer_load_dwordx4 v44, s[36:39], s75 offen  lds
  s_add_u32 m0, m0, 1024
  s_add_u32 s75, s75, 32768
  buffer_load_dwordx4 v44, s[36:39], s75 offen  lds
  s_add_u32 m0, m0, 1024
  s_add_u32 s75, s75, 32768
  buffer_load_dwordx4 v44, s[36:39], s75 offen  lds
  s_add_u32 m0, m0, 1024
  s_add_u32 s75, s75, 32768
  buffer_load_dwordx4 v44, s[36:39], s75 offen  lds
  v_add_u32 v68, 98304, v64
  v_add_u32 v69, 98304, v65
  v_add_u32 v70, 98304, v66
  v_add_u32 v71, 98304, v67
  s_sub_u32 s75, 2, s50
  s_and_b32 s75, s75, 3
  s_cmp_eq_u32 s75, 1
  s_cbranch_scc1 Lwb_53
  s_cmp_eq_u32 s75, 2
  s_cbranch_scc1 Lwb_54
  s_cmp_eq_u32 s75, 3
  s_cbranch_scc1 Lwb_55
Lwb_52:
  ds_read_b64_tr_b16 v[128:129], v68 offset:0
  ds_read_b64_tr_b16 v[130:131], v68 offset:256
  ds_read_b64_tr_b16 v[132:133], v68 offset:1024
  ds_read_b64_tr_b16 v[134:135], v68 offset:1280
  ds_read_b64_tr_b16 v[136:137], v69 offset:0
  ds_read_b64_tr_b16 v[138:139], v69 offset:256
  ds_read_b64_tr_b16 v[140:141], v69 offset:1024
  ds_read_b64_tr_b16 v[142:143], v69 offset:1280
  s_waitcnt lgkmcnt(4)
  ds_read_b64_tr_b16 v[144:145], v70 offset:0
  ds_read_b64_tr_b16 v[146:147], v70 offset:256
  ds_read_b64_tr_b16 v[148:149], v70 offset:1024
  ds_read_b64_tr_b16 v[150:151], v70 offset:1280
  ds_read_b64_tr_b16 v[152:153], v71 offset:0
  ds_read_b64_tr_b16 v[154:155], v71 offset:256
  ds_read_b64_tr_b16 v[156:157], v71 offset:1024
  ds_read_b64_tr_b16 v[158:159], v71 offset:1280
  s_branch Lwd_51
Lwb_53:
  ds_read_b64_tr_b16 v[160:161], v68 offset:0
  ds_read_b64_tr_b16 v[162:163], v68 offset:256
  ds_read_b64_tr_b16 v[164:165], v68 offset:1024
  ds_read_b64_tr_b16 v[166:167], v68 offset:1280
  ds_read_b64_tr_b16 v[168:169], v69 offset:0
  ds_read_b64_tr_b16 v[170:171], v69 offset:256
  ds_read_b64_tr_b16 v[172:173], v69 offset:1024
  ds_read_b64_tr_b16 v[174:175], v69 offset:1280
  s_waitcnt lgkmcnt(4)
  ds_read_b64_tr_b16 v[176:177], v70 offset:0
  ds_read_b64_tr_b16 v[178:179], v70 offset:256
  ds_read_b64_tr_b16 v[180:181], v70 offset:1024
  ds_read_b64_tr_b16 v[182:183], v70 offset:1280
  ds_read_b64_tr_b16 v[184:185], v71 offset:0
  ds_read_b64_tr_b16 v[186:187], v71 offset:256
  ds_read_b64_tr_b16 v[188:189], v71 offset:1024
  ds_read_b64_tr_b16 v[190:191], v71 offset:1280
  s_branch Lwd_51
Lwb_54:
  ds_read_b64_tr_b16 v[192:193], v68 offset:0
  ds_read_b64_tr_b16 v[194:195], v68 offset:256
  ds_read_b64_tr_b16 v[196:197], v68 offset:1024
  ds_read_b64_tr_b16 v[198:199], v68 offset:1280
  ds_read_b64_tr_b16 v[200:201], v69 offset:0
  ds_read_b64_tr_b16 v[202:203], v69 offset:256
  ds_read_b64_tr_b16 v[204:205], v69 offset:1024
  ds_read_b64_tr_b16 v[206:207], v69 offset:1280
  s_waitcnt lgkmcnt(4)
  ds_read_b64_tr_b16 v[208:209], v70 offset:0
  ds_read_b64_tr_b16 v[210:211], v70 offset:256
  ds_read_b64_tr_b16 v[212:213], v70 offset:1024
  ds_read_b64_tr_b16 v[214:215], v70 offset:1280
  ds_read_b64_tr_b16 v[216:217], v71 offset:0
  ds_read_b64_tr_b16 v[218:219], v71 offset:256
  ds_read_b64_tr_b16 v[220:221], v71 offset:1024
  ds_read_b64_tr_b16 v[222:223], v71 offset:1280
  s_branch Lwd_51
Lwb_55:
  ds_read_b64_tr_b16 v[224:225], v68 offset:0
  ds_read_b64_tr_b16 v[226:227], v68 offset:256
  ds_read_b64_tr_b16 v[228:229], v68 offset:1024
  ds_read_b64_tr_b16 v[230:231], v68 offset:1280
  ds_read_b64_tr_b16 v[232:233], v69 offset:0
  ds_read_b64_tr_b16 v[234:235], v69 offset:256
  ds_read_b64_tr_b16 v[236:237], v69 offset:1024
  ds_read_b64_tr_b16 v[238:239], v69 offset:1280
  s_waitcnt lgkmcnt(4)
  ds_read_b64_tr_b16 v[240:241], v70 offset:0
  ds_read_b64_tr_b16 v[242:243], v70 offset:256
  ds_read_b64_tr_b16 v[244:245], v70 offset:1024
  ds_read_b64_tr_b16 v[246:247], v70 offset:1280
  ds_read_b64_tr_b16 v[248:249], v71 offset:0
  ds_read_b64_tr_b16 v[250:251], v71 offset:256
  ds_read_b64_tr_b16 v[252:253], v71 offset:1024
  ds_read_b64_tr_b16 v[254:255], v71 offset:1280
Lwd_51:
  s_waitcnt lgkmcnt(0)
  s_waitcnt vmcnt(24)
  s_barrier
  s_add_u32 m0, s66, 98304
  s_add_u32 s75, s65, 3145728
  buffer_load_dwordx4 v44, s[36:39], s75 offen  lds
  s_add_u32 m0, m0, 1024
  s_add_u32 s75, s75, 32768
  buffer_load_dwordx4 v44, s[36:39], s75 offen  lds
  s_add_u32 m0, m0, 1024
  s_add_u32 s75, s75, 32768
  buffer_load_dwordx4 v44, s[36:39], s75 offen  lds
  s_add_u32 m0, m0, 1024
  s_add_u32 s75, s75, 32768
  buffer_load_dwordx4 v44, s[36:39], s75 offen  lds
  s_add_u32 m0, m0, 1024
  s_add_u32 s75, s75, 32768
  buffer_load_dwordx4 v44, s[36:39], s75 offen  lds
  s_add_u32 m0, m0, 1024
  s_add_u32 s75, s75, 32768
  buffer_load_dwordx4 v44, s[36:39], s75 offen  lds
  s_add_u32 m0, m0, 1024
  s_add_u32 s75, s75, 32768
  buffer_load_dwordx4 v44, s[36:39], s75 offen  lds
  s_add_u32 m0, m0, 1024
  s_add_u32 s75, s75, 32768
  buffer_load_dwordx4 v44, s[36:39], s75 offen  lds
  v_add_u32 v68, 131072, v64
  v_add_u32 v69, 131072, v65
  v_add_u32 v70, 131072, v66
  v_add_u32 v71, 131072, v67
  s_sub_u32 s75, 3, s50
  s_and_b32 s75, s75, 3
  s_cmp_eq_u32 s75, 1
  s_cbranch_scc1 Lwb_58
  s_cmp_eq_u32 s75, 2
  s_cbranch_scc1 Lwb_59
  s_cmp_eq_u32 s75, 3
  s_cbranch_scc1 Lwb_60
Lwb_57:
  ds_read_b64_tr_b16 v[128:129], v68 offset:0
  ds_read_b64_tr_b16 v[130:131], v68 offset:256
  ds_read_b64_tr_b16 v[132:133], v68 offset:1024
  ds_read_b64_tr_b16 v[134:135], v68 offset:1280
  ds_read_b64_tr_b16 v[136:137], v69 offset:0
  ds_read_b64_tr_b16 v[138:139], v69 offset:256
  ds_read_b64_tr_b16 v[140:141], v69 offset:1024
  ds_read_b64_tr_b16 v[142:143], v69 offset:1280
  s_waitcnt lgkmcnt(4)
  ds_read_b64_tr_b16 v[144:145], v70 offset:0
  ds_read_b64_tr_b16 v[146:147], v70 offset:256
  ds_read_b64_tr_b16 v[148:149], v70 offset:1024
  ds_read_b64_tr_b16 v[150:151], v70 offset:1280
  ds_read_b64_tr_b16 v[152:153], v71 offset:0
  ds_read_b64_tr_b16 v[154:155], v71 offset:256
  ds_read_b64_tr_b16 v[156:157], v71 offset:1024
  ds_read_b64_tr_b16 v[158:159], v71 offset:1280
  s_branch Lwd_56
Lwb_58:
  ds_read_b64_tr_b16 v[160:161], v68 offset:0
  ds_read_b64_tr_b16 v[162:163], v68 offset:256
  ds_read_b64_tr_b16 v[164:165], v68 offset:1024
  ds_read_b64_tr_b16 v[166:167], v68 offset:1280
  ds_read_b64_tr_b16 v[168:169], v69 offset:0
  ds_read_b64_tr_b16 v[170:171], v69 offset:256
  ds_read_b64_tr_b16 v[172:173], v69 offset:1024
  ds_read_b64_tr_b16 v[174:175], v69 offset:1280
  s_waitcnt lgkmcnt(4)
  ds_read_b64_tr_b16 v[176:177], v70 offset:0
  ds_read_b64_tr_b16 v[178:179], v70 offset:256
  ds_read_b64_tr_b16 v[180:181], v70 offset:1024
  ds_read_b64_tr_b16 v[182:183], v70 offset:1280
  ds_read_b64_tr_b16 v[184:185], v71 offset:0
  ds_read_b64_tr_b16 v[186:187], v71 offset:256
  ds_read_b64_tr_b16 v[188:189], v71 offset:1024
  ds_read_b64_tr_b16 v[190:191], v71 offset:1280
  s_branch Lwd_56
Lwb_59:
  ds_read_b64_tr_b16 v[192:193], v68 offset:0
  ds_read_b64_tr_b16 v[194:195], v68 offset:256
  ds_read_b64_tr_b16 v[196:197], v68 offset:1024
  ds_read_b64_tr_b16 v[198:199], v68 offset:1280
  ds_read_b64_tr_b16 v[200:201], v69 offset:0
  ds_read_b64_tr_b16 v[202:203], v69 offset:256
  ds_read_b64_tr_b16 v[204:205], v69 offset:1024
  ds_read_b64_tr_b16 v[206:207], v69 offset:1280
  s_waitcnt lgkmcnt(4)
  ds_read_b64_tr_b16 v[208:209], v70 offset:0
  ds_read_b64_tr_b16 v[210:211], v70 offset:256
  ds_read_b64_tr_b16 v[212:213], v70 offset:1024
  ds_read_b64_tr_b16 v[214:215], v70 offset:1280
  ds_read_b64_tr_b16 v[216:217], v71 offset:0
  ds_read_b64_tr_b16 v[218:219], v71 offset:256
  ds_read_b64_tr_b16 v[220:221], v71 offset:1024
  ds_read_b64_tr_b16 v[222:223], v71 offset:1280
  s_branch Lwd_56
Lwb_60:
  ds_read_b64_tr_b16 v[224:225], v68 offset:0
  ds_read_b64_tr_b16 v[226:227], v68 offset:256
  ds_read_b64_tr_b16 v[228:229], v68 offset:1024
  ds_read_b64_tr_b16 v[230:231], v68 offset:1280
  ds_read_b64_tr_b16 v[232:233], v69 offset:0
  ds_read_b64_tr_b16 v[234:235], v69 offset:256
  ds_read_b64_tr_b16 v[236:237], v69 offset:1024
  ds_read_b64_tr_b16 v[238:239], v69 offset:1280
  s_waitcnt lgkmcnt(4)
  ds_read_b64_tr_b16 v[240:241], v70 offset:0
  ds_read_b64_tr_b16 v[242:243], v70 offset:256
  ds_read_b64_tr_b16 v[244:245], v70 offset:1024
  ds_read_b64_tr_b16 v[246:247], v70 offset:1280
  ds_read_b64_tr_b16 v[248:249], v71 offset:0
  ds_read_b64_tr_b16 v[250:251], v71 offset:256
  ds_read_b64_tr_b16 v[252:253], v71 offset:1024
  ds_read_b64_tr_b16 v[254:255], v71 offset:1280
Lwd_56:
  s_waitcnt lgkmcnt(0)
  v_bfe_u32 v40, v0, 4, 1
  v_lshrrev_b32 v41, 5, v0
  v_and_b32 v42, 15, v0
  v_lshrrev_b32 v43, 4, v0
  v_and_b32 v44, 7, v0
  v_lshl_add_u32 v45, v41, 4, v42
  v_lshlrev_b32 v45, 4, v45
  v_lshl_add_u32 v6, v40, 3, v45
  v_and_b32 v45, 31, v0
  v_lshlrev_b32 v1, 4, v45
  s_lshl_b32 s75, s48, 14
  s_lshl_b32 s76, s50, 12
  s_add_u32 s75, s75, s76
  s_add_u32 s75, s75, 2490368
  s_mov_b32 exec_hi, 0
  v_add_u32 v1, s75, v1
  s_mov_b32 exec_hi, -1
  s_xor_b32 s75, s48, 1
  s_lshl_b32 s75, s75, 21
  s_and_b32 s76, s50, 1
  s_lshl_b32 s76, s76, 12
  s_add_u32 s75, s75, s76
  s_lshr_b32 s76, s50, 1
  s_lshl_b32 s76, s76, 14
  s_add_u32 s75, s75, s76
  s_add_u32 s75, s75, 20971520
  s_mov_b32 exec_lo, 0
  v_add_u32 v1, s75, v1
  s_mov_b32 exec_lo, -1
  v_and_b32 v47, 1, v0
  v_lshlrev_b32 v47, 4, v47
  v_mov_b32 v45, 0x3f80
  v_lshlrev_b32 v45, v47, v45
  v_bfe_u32 v46, v0, 3, 1
  v_cmp_eq_u32 vcc, v46, v40
  v_bfe_u32 v47, v0, 1, 2
  s_nop 0
  v_cndmask_b32 v45, 0, v45, vcc
  s_mov_b32 exec_lo, 0
  v_mov_b32 v45, 0
  s_mov_b32 exec_lo, -1
  v_cmp_eq_u32 vcc, 0, v47
  s_nop 1
  v_cndmask_b32 v20, 0, v45, vcc
  v_cmp_eq_u32 vcc, 1, v47
  s_nop 1
  v_cndmask_b32 v21, 0, v45, vcc
  v_cmp_eq_u32 vcc, 2, v47
  s_nop 1
  v_cndmask_b32 v22, 0, v45, vcc
  v_cmp_eq_u32 vcc, 3, v47
  s_nop 1
  v_cndmask_b32 v23, 0, v45, vcc
  s_add_u32 s75, s50, 0
  s_and_b32 s75, s75, 3
  s_lshl_b32 s75, s75, 12
  s_add_u32 s75, s75, 131072
  v_add_u32 v2, s75, v10
  s_add_u32 s75, s50, 1
  s_and_b32 s75, s75, 3
  s_lshl_b32 s75, s75, 12
  s_add_u32 s75, s75, 131072
  v_add_u32 v3, s75, v10
  s_add_u32 s75, s50, 2
  s_and_b32 s75, s75, 3
  s_lshl_b32 s75, s75, 12
  s_add_u32 s75, s75, 131072
  v_add_u32 v4, s75, v10
  s_add_u32 s75, s50, 3
  s_and_b32 s75, s75, 3
  s_lshl_b32 s75, s75, 12
  s_add_u32 s75, s75, 131072
  v_add_u32 v5, s75, v10
  v_mul_u32_u24 v45, 576, v43
  v_lshl_add_u32 v45, v42, 3, v45
  s_lshl_b32 s75, s50, 7
  s_add_u32 s75, s75, 155648
  v_add_u32 v7, s75, v45
  v_and_b32 v45, 3, v0
  v_mul_u32_u24 v45, 576, v45
  v_lshrrev_b32 v46, 2, v0
  v_lshl_add_u32 v45, v46, 3, v45
  v_add_u32 v8, 155648, v45
  v_add_u32 v9, 151552, v10
  v_lshl_add_u32 v45, v43, 3, v44
  v_lshlrev_b32 v11, 4, v45
  v_and_b32 v45, 8, v0
  v_add_u32 v14, v45, v11
  v_lshlrev_b32 v45, 7, v41
  v_lshl_add_u32 v45, v44, 4, v45
  v_lshl_add_u32 v45, v40, 3, v45
  s_lshl_b32 s75, s49, 10
  s_lshl_b32 s76, s50, 8
  s_add_u32 s75, s75, s76
  v_add_u32 v12, s75, v45
  v_mov_b32 v15, 0x4444
  v_mov_b32 v45, 0xeeee
  v_bfe_u32 v46, v0, 3, 1
  v_cmp_eq_u32 vcc, 1, v46
  s_mov_b32 s51, -1
  s_lshr_b32 s42, s52, 2
  v_cndmask_b32 v15, v15, v45, vcc
  s_lshl_b32 s42, s42, 14
  s_and_b32 s75, s52, 3
  s_lshl_b32 s75, s75, 11
  s_add_u32 s42, s42, s75
  s_add_u32 s42, s42, 125566976
  s_lshl_b32 s62, s53, 13
  s_and_b32 s75, s49, 1
  s_lshl_b32 s76, s75, 12
  s_add_u32 s63, s62, s76
  s_lshl_b32 s76, s50, 10
  s_add_u32 s63, s63, s76
  s_add_u32 s63, s63, 16777216
  s_add_u32 s66, s76, 147456
  s_lshl_b32 s75, s75, 11
  s_add_u32 s62, s62, s75
  s_lshr_b32 s75, s50, 1
  s_lshl_b32 s75, s75, 12
  s_add_u32 s62, s62, s75
  s_and_b32 s75, s50, 1
  s_lshl_b32 s75, s75, 10
  s_add_u32 s62, s62, s75
  s_add_u32 s62, s62, 0
  s_xor_b32 s56, s56, 131072
  s_xor_b32 s58, s58, 65536
  s_xor_b32 s59, s59, 65536
  s_xor_b32 s60, s60, 65536
  v_and_b32 v17, 3, v0
  v_lshlrev_b32 v17, 2, v17
  s_branch Lhop_0
Lhop_back:
  s_getpc_b64 s[76:77]
Lcpf:
  s_lshl_b32 s75, s50, 11
  s_add_u32 s75, s75, Lfast_join-Lcpf
  s_add_u32 s76, s76, s75
  s_addc_u32 s77, s77, 0
  global_load_dwordx4 v[96:99], v10, s[76:77]
  global_load_dwordx4 v[96:99], v10, s[76:77] offset:1024
  s_waitcnt vmcnt(26)
  s_barrier
  s_lshl_b32 s75, s50, 15
  s_lshl_b32 s76, s50, 13
  s_sub_u32 s75, s76, s75
  s_add_u32 s75, s75, 0
  v_add_u32 v53, s75, v51
  v_add_u32 v54, s75, v52
  v_add_u32 v55, s75, v13
  ds_read_b64_tr_b16 v[64:65], v53 offset:0
  ds_read_b64_tr_b16 v[66:67], v53 offset:256
  ds_read_b64_tr_b16 v[68:69], v53 offset:2048
  ds_read_b64_tr_b16 v[70:71], v53 offset:2304
  ds_read_b64_tr_b16 v[72:73], v54 offset:0
  ds_read_b64_tr_b16 v[74:75], v54 offset:256
  ds_read_b64_tr_b16 v[76:77], v54 offset:2048
  ds_read_b64_tr_b16 v[78:79], v54 offset:2304
  s_waitcnt lgkmcnt(4)
  ds_read_b64_tr_b16 v[80:81], v53 offset:4096
  ds_read_b64_tr_b16 v[82:83], v53 offset:4352
  ds_read_b64_tr_b16 v[84:85], v53 offset:6144
  ds_read_b64_tr_b16 v[86:87], v53 offset:6400
  ds_read_b64_tr_b16 v[88:89], v54 offset:4096
  ds_read_b64_tr_b16 v[90:91], v54 offset:4352
  ds_read_b64_tr_b16 v[92:93], v54 offset:6144
  ds_read_b64_tr_b16 v[94:95], v54 offset:6400
  s_waitcnt lgkmcnt(8)
  ds_write_b128 v55, v[64:67] offset:0
  ds_write_b128 v55, v[68:71] offset:1024
  ds_write_b128 v55, v[72:75] offset:2048
  ds_write_b128 v55, v[76:79] offset:3072
  s_waitcnt lgkmcnt(4)
  ds_write_b128 v55, v[80:83] offset:4096
  ds_write_b128 v55, v[84:87] offset:5120
  ds_write_b128 v55, v[88:91] offset:6144
  ds_write_b128 v55, v[92:95] offset:7168
  s_waitcnt lgkmcnt(0)
  s_waitcnt vmcnt(18)
  s_barrier
  s_lshl_b32 s75, s50, 15
  s_lshl_b32 s76, s50, 13
  s_sub_u32 s75, s76, s75
  s_add_u32 s75, s75, 32768
  v_add_u32 v53, s75, v51
  v_add_u32 v54, s75, v52
  v_add_u32 v55, s75, v13
  ds_read_b64_tr_b16 v[64:65], v53 offset:0
  ds_read_b64_tr_b16 v[66:67], v53 offset:256
  ds_read_b64_tr_b16 v[68:69], v53 offset:2048
  ds_read_b64_tr_b16 v[70:71], v53 offset:2304
  ds_read_b64_tr_b16 v[72:73], v54 offset:0
  ds_read_b64_tr_b16 v[74:75], v54 offset:256
  ds_read_b64_tr_b16 v[76:77], v54 offset:2048
  ds_read_b64_tr_b16 v[78:79], v54 offset:2304
  s_waitcnt lgkmcnt(4)
  ds_read_b64_tr_b16 v[80:81], v53 offset:4096
  ds_read_b64_tr_b16 v[82:83], v53 offset:4352
  ds_read_b64_tr_b16 v[84:85], v53 offset:6144
  ds_read_b64_tr_b16 v[86:87], v53 offset:6400
  ds_read_b64_tr_b16 v[88:89], v54 offset:4096
  ds_read_b64_tr_b16 v[90:91], v54 offset:4352
  ds_read_b64_tr_b16 v[92:93], v54 offset:6144
  ds_read_b64_tr_b16 v[94:95], v54 offset:6400
  s_waitcnt lgkmcnt(8)
  ds_write_b128 v55, v[64:67] offset:0
  ds_write_b128 v55, v[68:71] offset:1024
  ds_write_b128 v55, v[72:75] offset:2048
  ds_write_b128 v55, v[76:79] offset:3072
  s_waitcnt lgkmcnt(4)
  ds_write_b128 v55, v[80:83] offset:4096
  ds_write_b128 v55, v[84:87] offset:5120
  ds_write_b128 v55, v[88:91] offset:6144
  ds_write_b128 v55, v[92:95] offset:7168
  s_waitcnt lgkmcnt(0)
  s_waitcnt vmcnt(10)
  s_barrier
  s_lshl_b32 s75, s50, 15
  s_lshl_b32 s76, s50, 13
  s_sub_u32 s75, s76, s75
  s_add_u32 s75, s75, 65536
  v_add_u32 v53, s75, v51
  v_add_u32 v54, s75, v52
  v_add_u32 v55, s75, v13
  ds_read_b64_tr_b16 v[64:65], v53 offset:0
  ds_read_b64_tr_b16 v[66:67], v53 offset:256
  ds_read_b64_tr_b16 v[68:69], v53 offset:2048
  ds_read_b64_tr_b16 v[70:71], v53 offset:2304
  ds_read_b64_tr_b16 v[72:73], v54 offset:0
  ds_read_b64_tr_b16 v[74:75], v54 offset:256
  ds_read_b64_tr_b16 v[76:77], v54 offset:2048
  ds_read_b64_tr_b16 v[78:79], v54 offset:2304
  s_waitcnt lgkmcnt(4)
  ds_read_b64_tr_b16 v[80:81], v53 offset:4096
  ds_read_b64_tr_b16 v[82:83], v53 offset:4352
  ds_read_b64_tr_b16 v[84:85], v53 offset:6144
  ds_read_b64_tr_b16 v[86:87], v53 offset:6400
  ds_read_b64_tr_b16 v[88:89], v54 offset:4096
  ds_read_b64_tr_b16 v[90:91], v54 offset:4352
  ds_read_b64_tr_b16 v[92:93], v54 offset:6144
  ds_read_b64_tr_b16 v[94:95], v54 offset:6400
  s_waitcnt lgkmcnt(8)
  ds_write_b128 v55, v[64:67] offset:0
  ds_write_b128 v55, v[68:71] offset:1024
  ds_write_b128 v55, v[72:75] offset:2048
  ds_write_b128 v55, v[76:79] offset:3072
  s_waitcnt lgkmcnt(4)
  ds_write_b128 v55, v[80:83] offset:4096
  ds_write_b128 v55, v[84:87] offset:5120
  ds_write_b128 v55, v[88:91] offset:6144
  ds_write_b128 v55, v[92:95] offset:7168
  s_waitcnt lgkmcnt(0)
  s_waitcnt vmcnt(0)
  s_barrier
  v_mov_b32 v48, 0
  global_load_dwordx4 v[40:43], v48, s[28:29] sc1
  global_load_dwordx4 v[44:47], v48, s[28:29] offset:16 sc1
  buffer_load_dword v16, v17, s[32:35], s67 offen sc1
  s_lshl_b32 s75, s50, 15
  s_lshl_b32 s76, s50, 13
  s_sub_u32 s75, s76, s75
  s_add_u32 s75, s75, 98304
  v_add_u32 v53, s75, v51
  v_add_u32 v54, s75, v52
  v_add_u32 v55, s75, v13
  ds_read_b64_tr_b16 v[64:65], v53 offset:0
  ds_read_b64_tr_b16 v[66:67], v53 offset:256
  ds_read_b64_tr_b16 v[68:69], v53 offset:2048
  ds_read_b64_tr_b16 v[70:71], v53 offset:2304
  ds_read_b64_tr_b16 v[72:73], v54 offset:0
  ds_read_b64_tr_b16 v[74:75], v54 offset:256
  ds_read_b64_tr_b16 v[76:77], v54 offset:2048
  ds_read_b64_tr_b16 v[78:79], v54 offset:2304
  s_waitcnt lgkmcnt(4)
  ds_read_b64_tr_b16 v[80:81], v53 offset:4096
  ds_read_b64_tr_b16 v[82:83], v53 offset:4352
  ds_read_b64_tr_b16 v[84:85], v53 offset:6144
  ds_read_b64_tr_b16 v[86:87], v53 offset:6400
  ds_read_b64_tr_b16 v[88:89], v54 offset:4096
  ds_read_b64_tr_b16 v[90:91], v54 offset:4352
  ds_read_b64_tr_b16 v[92:93], v54 offset:6144
  ds_read_b64_tr_b16 v[94:95], v54 offset:6400
  s_waitcnt lgkmcnt(8)
  ds_write_b128 v55, v[64:67] offset:0
  ds_write_b128 v55, v[68:71] offset:1024
  ds_write_b128 v55, v[72:75] offset:2048
  ds_write_b128 v55, v[76:79] offset:3072
  s_waitcnt lgkmcnt(4)
  ds_write_b128 v55, v[80:83] offset:4096
  ds_write_b128 v55, v[84:87] offset:5120
  ds_write_b128 v55, v[88:91] offset:6144
  ds_write_b128 v55, v[92:95] offset:7168
  s_waitcnt lgkmcnt(0)
  s_branch Lrole_61_c
Lrole_61:
  global_load_dwordx4 v[40:43], v48, s[28:29] sc1
  global_load_dwordx4 v[44:47], v48, s[28:29] offset:16 sc1
Lrole_61_c:
  s_waitcnt vmcnt(0)
  s_cmp_eq_u32 s1, 8
  s_cbranch_scc1 Lrole_62
  v_pk_add_u16 v49, v40, v41
  v_pk_add_u16 v49, v49, v42
  v_pk_add_u16 v49, v49, v43
  v_sad_u16 v49, v49, 0, 0
  v_cmp_ne_u32 vcc, 0x100, v49
  s_cbranch_vccnz Lrole_61_w
  v_bcnt_u32_b32 v49, v40, 0
  v_bcnt_u32_b32 v49, v41, v49
  v_bcnt_u32_b32 v49, v42, v49
  v_bcnt_u32_b32 v49, v43, v49
  v_cmp_ne_u32 vcc, 1, v49
  s_cbranch_vccnz Lrestart
  v_readfirstlane_b32 s75, v46
  s_cmp_ge_u32 s75, 0x1000
  s_cbranch_scc1 Lrole_63
Lrole_61_w:
  s_sub_u32 s69, s69, 1
  s_cbranch_scc0 Lrole_61
  s_endpgm
Lrole_62:
  s_mov_b32 s75, 0
  v_cmp_eq_u32 vcc, 64, v44
  s_cbranch_vccz Lrole_61_w
Lrole_63:
  s_and_b32 s75, s75, 0xff
  s_cmp_gt_u32 s75, 8
  s_cselect_b32 s75, 1, 0
  s_lshl_b32 s43, s75, 13
  s_add_u32 s68, s68, s43
  s_lshl_b32 s76, s50, 2
  s_add_u32 s68, s68, s51
  s_add_u32 s68, s68, 1
  s_add_u32 s67, s67, s43
  s_lshl_b32 s75, s48, 13
  s_xor_b32 s75, s75, s43
  s_add_u32 s40, s40, s75
  s_xor_b32 s75, s75, 0x2000
  s_mov_b32 exec_lo, 0
  v_add_u32 v1, s75, v1
  s_mov_b32 exec_lo, -1
  v_mov_b32 v40, 0
  v_readlane_b32 s75, v1, 0
  v_readlane_b32 s76, v1, 32
  s_nop 1
  s_add_u32 s80, s44, s75
  s_add_u32 s44, s44, s76
  s_add_u32 s81, s45, s75
  s_add_u32 s45, s45, s76
  s_add_u32 s82, s46, s75
  s_add_u32 s46, s46, s76
  s_add_u32 s83, s47, s75
  s_add_u32 s47, s47, s76
  v_cmp_ne_u32 vcc, 1, v16
  s_cbranch_vccz Lch_f0_ok
Lch_f0:
  buffer_load_dword v16, v17, s[32:35], s67 offen sc1
  s_waitcnt vmcnt(0)
  v_cmp_ne_u32 vcc, 1, v16
  s_cbranch_vccz Lch_f0_ok
  s_sub_u32 s69, s69, 1
  s_cbranch_scc0 Lch_f0
  s_endpgm
Lch_f0_ok:
  s_mov_b32 m0, s66
  s_nop 0
  buffer_load_dwordx4 v10, s[32:35], s62 offen sc1 lds
  buffer_load_dwordx4 v[24:27], v10, s[32:35], s63 offen sc1
  s_waitcnt vmcnt(0)
  s_cmp_eq_u32 s1, 8
  s_cbranch_scc1 Lslow_enter
  s_branch Lfast_enter
  .p2align 6
  s_nop 0
Lfast_join:
  s_waitcnt vmcnt(3)
Lfast_join2:
  s_barrier
Lfast_step:
  buffer_load_dwordx4 v[32:35], v10, s[32:35], s80 offen sc1
  buffer_load_dwordx4 v[36:39], v10, s[32:35], s81 offen sc1
  buffer_load_dwordx4 v[40:43], v10, s[32:35], s82 offen sc1
  buffer_load_dwordx4 v[44:47], v10, s[32:35], s83 offen sc1
  s_cmp_lg_u32 s50, 0
  s_cbranch_scc1 Lfast_nw_67
  s_waitcnt vmcnt(6)
Lfast_nw_67:
  s_barrier
  buffer_load_dwordx4 v[48:51], v10, s[32:35], s44 offen sc1
  buffer_load_dwordx4 v[52:55], v10, s[32:35], s45 offen sc1
  s_barrier
  buffer_load_dwordx4 v[56:59], v10, s[32:35], s46 offen sc1
  buffer_load_dwordx4 v[60:63], v10, s[32:35], s47 offen sc1
  s_add_u32 s51, s51, 1
  s_nop 0
  s_add_u32 s40, s40, 32768
  s_xor_b32 s41, s41, 32768
  s_xor_b32 s56, s56, 131072
  s_xor_b32 s58, s58, 65536
  s_xor_b32 s59, s59, 65536
  s_xor_b32 s60, s60, 65536
  s_add_u32 s42, s42, 262144
  s_lshr_b32 s75, s42, 8
  s_and_b32 s75, s75, 0x2000
  s_xor_b32 s75, s75, s43
  s_add_u32 s64, s42, s75
  s_lshl_b32 s75, s50, 8
  s_add_u32 s65, s64, s75
  s_add_u32 s65, s65, 768
  s_and_b32 s75, s50, 1
  s_lshl_b32 s75, s75, 9
  s_add_u32 s64, s64, s75
  s_xor_b32 s66, s66, 4096
  v_xor_b32 v9, 4096, v9
  s_cmp_lt_u32 s51, 63
  s_cselect_b32 s75, 262144, 0
  s_add_u32 s62, s62, s75
  s_add_u32 s63, s63, s75
  s_mov_b32 m0, s66
  s_waitcnt vmcnt(8)
  v_cmp_ne_u32 vcc, 1, v16
  s_cbranch_vccnz Lfast_fb_64
Lfast_fo_65:
  s_waitcnt vmcnt(6)
Lfast_chk_68:
  v_max3_u32 v0, v32, v34, v36
  v_max_u32 v0, v0, v38
  v_cmp_eq_u32 vcc, -1, v0
  v_mfma_f32_16x16x32_bf16 v[88:91], v[32:35], v[20:23], 0
  v_mfma_f32_16x16x32_bf16 v[92:95], v[32:35], v[120:123], 0
  v_mfma_f32_16x16x32_bf16 v[96:99], v[36:39], v[20:23], 0
  v_mfma_f32_16x16x32_bf16 v[100:103], v[36:39], v[120:123], 0
  s_cbranch_vccnz Lfast_bad_69
  s_waitcnt vmcnt(4)
Lfast_chk_70:
  v_max3_u32 v0, v40, v42, v44
  v_max_u32 v0, v0, v46
  v_cmp_eq_u32 vcc, -1, v0
  v_mfma_f32_16x16x32_bf16 v[104:107], v[40:43], v[20:23], 0
  v_mfma_f32_16x16x32_bf16 v[108:111], v[40:43], v[120:123], 0
  v_mfma_f32_16x16x32_bf16 v[112:115], v[44:47], v[20:23], 0
  v_mfma_f32_16x16x32_bf16 v[116:119], v[44:47], v[120:123], 0
  s_cbranch_vccnz Lfast_bad_71
Lfast_chk_72:
  s_waitcnt vmcnt(3)
  v_mfma_f32_16x16x32_bf16 v[64:67], v[48:51], v[20:23], v[88:91]
  v_mfma_f32_16x16x32_bf16 v[68:71], v[48:51], v[120:123], v[92:95]
  s_waitcnt vmcnt(2)
  v_mfma_f32_16x16x32_bf16 v[32:35], v[52:55], v[20:23], v[96:99]
  v_mfma_f32_16x16x32_bf16 v[36:39], v[52:55], v[120:123], v[100:103]
  v_max3_u32 v0, v48, v50, v52
  v_max_u32 v0, v0, v54
  v_cmp_eq_u32_e64 vcc, -1, v0
  v_cvt_pk_bf16_f32 v72, v64, v65
  v_cvt_pk_bf16_f32 v73, v66, v67
  v_cvt_pk_bf16_f32 v74, v68, v69
  v_cvt_pk_bf16_f32 v75, v70, v71
  ds_write_b128 v2, v[72:75] offset:0
  s_cbranch_vccnz Lfast_bad_73
Lfast_chk_74:
  s_waitcnt vmcnt(1)
  v_mfma_f32_16x16x32_bf16 v[40:43], v[56:59], v[20:23], v[104:107]
  v_mfma_f32_16x16x32_bf16 v[44:47], v[56:59], v[120:123], v[108:111]
  v_cvt_pk_bf16_f32 v76, v32, v33
  v_cvt_pk_bf16_f32 v77, v34, v35
  v_cvt_pk_bf16_f32 v78, v36, v37
  v_cvt_pk_bf16_f32 v79, v38, v39
  ds_write_b128 v2, v[76:79] offset:1024
  s_waitcnt vmcnt(0)
  v_mfma_f32_16x16x32_bf16 v[64:67], v[60:63], v[20:23], v[112:115]
  v_mfma_f32_16x16x32_bf16 v[68:71], v[60:63], v[120:123], v[116:119]
  v_max3_u32 v0, v56, v58, v60
  v_max_u32 v0, v0, v62
  v_cmp_eq_u32_e64 vcc, -1, v0
  v_cvt_pk_bf16_f32 v80, v40, v41
  v_cvt_pk_bf16_f32 v81, v42, v43
  v_cvt_pk_bf16_f32 v82, v44, v45
  v_cvt_pk_bf16_f32 v83, v46, v47
  ds_write_b128 v2, v[80:83] offset:2048
  s_cbranch_vccnz Lfast_bad_75
  s_nop 0
  v_cvt_pk_bf16_f32 v84, v64, v65
  v_cvt_pk_bf16_f32 v85, v66, v67
  v_cvt_pk_bf16_f32 v86, v68, v69
  v_cvt_pk_bf16_f32 v87, v70, v71
  ds_write_b128 v2, v[84:87] offset:3072
  v_mov_b32 v120, 0
  v_mov_b32 v121, 0
  v_mov_b32 v122, 0
  v_mov_b32 v123, 0
  v_mov_b32 v100, 0
  v_mov_b32 v101, 0
  v_mov_b32 v102, 0
  v_mov_b32 v103, 0
  v_smfmac_f32_16x16x64_bf16 v[120:123], v[72:75], a[0:7], v15
  v_smfmac_f32_16x16x64_bf16 v[124:127], v[72:75], a[128:135], v15
  v_smfmac_f32_16x16x64_bf16 v[120:123], v[76:79], a[8:15], v15
  v_smfmac_f32_16x16x64_bf16 v[124:127], v[76:79], a[136:143], v15
  s_waitcnt lgkmcnt(0)
  s_barrier
  ds_read_b128 v[32:35], v3 offset:0
  ds_read_b128 v[36:39], v3 offset:1024
  ds_read_b128 v[40:43], v3 offset:2048
  ds_read_b128 v[44:47], v3 offset:3072
  ds_read_b128 v[48:51], v4 offset:0
  ds_read_b128 v[52:55], v4 offset:1024
  ds_read_b128 v[56:59], v4 offset:2048
  ds_read_b128 v[60:63], v4 offset:3072
  v_smfmac_f32_16x16x64_bf16 v[120:123], v[80:83], a[16:23], v15
  v_smfmac_f32_16x16x64_bf16 v[124:127], v[80:83], a[144:151], v15
  buffer_load_dwordx4 v10, s[32:35], s62 offen sc1 lds
  v_smfmac_f32_16x16x64_bf16 v[120:123], v[84:87], a[24:31], v15
  v_smfmac_f32_16x16x64_bf16 v[124:127], v[84:87], a[152:159], v15
  buffer_load_dwordx4 v[24:27], v10, s[32:35], s63 offen sc1
  s_waitcnt lgkmcnt(7)
  v_smfmac_f32_16x16x64_bf16 v[120:123], v[32:35], a[32:39], v15
  v_smfmac_f32_16x16x64_bf16 v[124:127], v[32:35], a[160:167], v15
  ds_read_b128 v[32:35], v5 offset:0
  s_waitcnt lgkmcnt(7)
  v_smfmac_f32_16x16x64_bf16 v[120:123], v[36:39], a[40:47], v15
  v_smfmac_f32_16x16x64_bf16 v[124:127], v[36:39], a[168:175], v15
  ds_read_b128 v[36:39], v5 offset:1024
  s_waitcnt lgkmcnt(7)
  v_smfmac_f32_16x16x64_bf16 v[120:123], v[40:43], a[48:55], v15
  v_smfmac_f32_16x16x64_bf16 v[124:127], v[40:43], a[176:183], v15
  ds_read_b128 v[40:43], v5 offset:2048
  s_waitcnt lgkmcnt(7)
  v_smfmac_f32_16x16x64_bf16 v[120:123], v[44:47], a[56:63], v15
  v_smfmac_f32_16x16x64_bf16 v[124:127], v[44:47], a[184:191], v15
  ds_read_b128 v[44:47], v5 offset:3072
  s_waitcnt lgkmcnt(7)
  v_smfmac_f32_16x16x64_bf16 v[120:123], v[48:51], a[64:71], v15
  v_smfmac_f32_16x16x64_bf16 v[124:127], v[48:51], a[192:199], v15
  ds_read_b128 v[104:107], v9 offset:0
  s_waitcnt lgkmcnt(7)
  v_smfmac_f32_16x16x64_bf16 v[120:123], v[52:55], a[72:79], v15
  v_smfmac_f32_16x16x64_bf16 v[124:127], v[52:55], a[200:207], v15
  ds_read_b128 v[108:111], v9 offset:1024
  s_waitcnt lgkmcnt(7)
  v_smfmac_f32_16x16x64_bf16 v[120:123], v[56:59], a[80:87], v15
  v_smfmac_f32_16x16x64_bf16 v[124:127], v[56:59], a[208:215], v15
  ds_read_b128 v[112:115], v9 offset:2048
  s_waitcnt lgkmcnt(7)
  v_smfmac_f32_16x16x64_bf16 v[120:123], v[60:63], a[88:95], v15
  v_smfmac_f32_16x16x64_bf16 v[124:127], v[60:63], a[216:223], v15
  ds_read_b128 v[116:119], v9 offset:3072
  s_waitcnt lgkmcnt(7)
  v_smfmac_f32_16x16x64_bf16 v[120:123], v[32:35], a[96:103], v15
  v_smfmac_f32_16x16x64_bf16 v[124:127], v[32:35], a[224:231], v15
  s_waitcnt lgkmcnt(6)
  v_smfmac_f32_16x16x64_bf16 v[120:123], v[36:39], a[104:111], v15
  v_smfmac_f32_16x16x64_bf16 v[124:127], v[36:39], a[232:239], v15
  s_waitcnt lgkmcnt(5)
  v_smfmac_f32_16x16x64_bf16 v[120:123], v[40:43], a[112:119], v15
  v_smfmac_f32_16x16x64_bf16 v[124:127], v[40:43], a[240:247], v15
  s_waitcnt lgkmcnt(4)
  v_smfmac_f32_16x16x64_bf16 v[120:123], v[44:47], a[120:127], v15
  v_smfmac_f32_16x16x64_bf16 v[124:127], v[44:47], a[248:255], v15
  s_cmp_eq_u32 s51, 63
  s_nop 6
  v_permlane32_swap_b32 v120, v124
  v_permlane32_swap_b32 v121, v125
  v_permlane32_swap_b32 v122, v126
  v_permlane32_swap_b32 v123, v127
  v_pk_add_f32 v[120:121], v[120:121], v[124:125]
  v_pk_add_f32 v[122:123], v[122:123], v[126:127]
  v_cvt_pk_bf16_f32 v120, v120, v121
  v_cvt_pk_bf16_f32 v121, v122, v123
  ds_write_b64 v7, v[120:121]
  s_cbranch_scc1 Lfast_last
  s_cmp_eq_u32 s50, 1
  s_cbranch_scc1 Lfast_p1_76
  s_cmp_eq_u32 s50, 2
  s_cbranch_scc1 Lfast_p2_77
  s_waitcnt lgkmcnt(0)
  s_barrier
  ds_read_b64_tr_b16 v[120:121], v8 offset:0
  ds_read_b64_tr_b16 v[122:123], v8 offset:128
  ds_read_b64_tr_b16 v[124:125], v8 offset:256
  ds_read_b64_tr_b16 v[126:127], v8 offset:384
  s_waitcnt lgkmcnt(2)
  v_mfma_f32_16x16x32_bf16 v[88:91], v[104:107], v[120:123], 0
  s_waitcnt lgkmcnt(0)
  v_mfma_f32_16x16x32_bf16 v[88:91], v[108:111], v[124:127], v[88:91]
  v_mfma_f32_16x16x32_bf16 v[92:95], v[112:115], v[120:123], 0
  v_mfma_f32_16x16x32_bf16 v[96:99], v[120:123], v[120:123], 0
  s_mov_b64 exec, s[70:71]
  v_min_u32 v88, -2, v88
  buffer_store_dwordx4 v[88:91], v10, s[32:35], s56 offen offset:0
  s_mov_b64 exec, -1
  v_mfma_f32_16x16x32_bf16 v[92:95], v[116:119], v[124:127], v[92:95]
  v_mfma_f32_16x16x32_bf16 v[96:99], v[124:127], v[124:127], v[96:99]
Lfast_pd_78:
  ds_read_b128 v[104:107], v3 offset:0
  ds_read_b128 v[108:111], v3 offset:1024
  ds_read_b128 v[112:115], v3 offset:2048
  ds_read_b128 v[116:119], v3 offset:3072
  v_smfmac_f32_16x16x64_bf16 v[100:103], v[32:35], v[224:231], v15
  v_smfmac_f32_16x16x64_bf16 v[100:103], v[36:39], v[232:239], v15
  v_smfmac_f32_16x16x64_bf16 v[100:103], v[40:43], v[240:247], v15
  v_mov_b32_dpp v88, v92 row_ror:8 row_mask:0xf bank_mask:0xc
  v_mov_b32_dpp v89, v93 row_ror:8 row_mask:0xf bank_mask:0xc
  v_smfmac_f32_16x16x64_bf16 v[100:103], v[44:47], v[248:255], v15
  v_mov_b32_dpp v90, v94 row_ror:8 row_mask:0xf bank_mask:0xc
  v_mov_b32_dpp v91, v95 row_ror:8 row_mask:0xf bank_mask:0xc
  v_smfmac_f32_16x16x64_bf16 v[100:103], v[48:51], v[192:199], v15
  v_mov_b32_dpp v96, v98 row_ror:8 row_mask:0xf bank_mask:0xc
  v_mov_b32_dpp v97, v99 row_ror:8 row_mask:0xf bank_mask:0xc
  v_smfmac_f32_16x16x64_bf16 v[100:103], v[52:55], v[200:207], v15
  v_mov_b32 v68, 0xff800000
  v_mov_b32 v40, 0x3f803f80
  v_smfmac_f32_16x16x64_bf16 v[100:103], v[56:59], v[208:215], v15
  v_cndmask_b32 v96, v96, v68, s[54:55]
  v_cndmask_b32 v97, v97, v68, s[54:55]
  v_smfmac_f32_16x16x64_bf16 v[100:103], v[60:63], v[216:223], v15
  v_mov_b32 v41, 0x3f803f80
  v_mov_b32 v42, 0x3f803f80
  v_smfmac_f32_16x16x64_bf16 v[100:103], v[72:75], v[128:135], v15
  buffer_load_dwordx4 v[32:35], v10, s[32:35], s57 offen sc1
  buffer_load_dwordx2 v[36:37], v14, s[32:35], s57 offen offset:1024 sc1
  v_smfmac_f32_16x16x64_bf16 v[100:103], v[76:79], v[136:143], v15
  v_smfmac_f32_16x16x64_bf16 v[100:103], v[80:83], v[144:151], v15
  v_mov_b32 v43, 0x3f803f80
  v_smfmac_f32_16x16x64_bf16 v[100:103], v[84:87], v[152:159], v15
  s_waitcnt lgkmcnt(0)
  v_smfmac_f32_16x16x64_bf16 v[100:103], v[104:107], v[160:167], v15
  v_smfmac_f32_16x16x64_bf16 v[100:103], v[108:111], v[168:175], v15
  buffer_load_dwordx4 v[48:51], v10, s[32:35], s57 offen sc1
  buffer_load_dwordx2 v[52:53], v14, s[32:35], s57 offen offset:1024 sc1
  v_smfmac_f32_16x16x64_bf16 v[100:103], v[112:115], v[176:183], v15
  v_smfmac_f32_16x16x64_bf16 v[100:103], v[116:119], v[184:191], v15
  s_nop 7
  v_mov_b32 v64, v100
  v_mov_b32 v65, v101
  v_mov_b32 v66, v102
  v_mov_b32 v67, v103
  s_nop 0
  v_permlane32_swap_b32 v100, v64
  v_permlane32_swap_b32 v101, v65
  v_permlane32_swap_b32 v102, v66
  v_permlane32_swap_b32_e64 v103, v67
  v_pk_add_f32 v[64:65], v[64:65], v[100:101]
  v_pk_add_f32 v[66:67], v[66:67], v[102:103]
  v_cvt_pk_bf16_f32 v18, v64, v65
  v_cvt_pk_bf16_f32 v19, v66, v67
  s_waitcnt vmcnt(2)
  v_max_u32 v0, v32, v36
  v_cmp_eq_u32 vcc, -1, v0
  s_cbranch_vccnz Lfast_sb_80
  v_pk_add_f32 v[88:89], v[88:89], v[32:33]
  v_pk_add_f32 v[90:91], v[90:91], v[34:35]
  v_pk_add_f32 v[96:97], v[96:97], v[36:37]
Lfast_sok_82:
  v_max3_f32 v38, v88, v89, v90
  v_max3_f32 v39, v91, v96, v97
  v_max_f32 v38, v38, v39
  s_nop 1
  v_max_f32_dpp v38, v38, v38 row_ror:8 row_mask:0xf bank_mask:0xf
  v_mov_b32 v39, v38
  s_nop 1
  v_permlane32_swap_b32 v38, v39
  v_max_f32 v38, v38, v39
  v_mov_b32 v39, v38
  s_nop 1
  v_permlane16_swap_b32 v38, v39
  v_max_f32 v38, v38, v39
  v_mul_f32_e64 v38, s74, v38
  v_fma_f32 v88, v88, s74, -v38
  v_fma_f32 v89, v89, s74, -v38
  v_exp_f32 v88, v88
  v_exp_f32 v89, v89
  v_fma_f32 v90, v90, s74, -v38
  v_fma_f32 v91, v91, s74, -v38
  v_exp_f32 v90, v90
  v_exp_f32 v91, v91
  v_cvt_pk_bf16_f32 v64, v88, v89
  v_fma_f32 v96, v96, s74, -v38
  v_cvt_pk_bf16_f32 v65, v90, v91
  v_fma_f32 v97, v97, s74, -v38
  v_exp_f32_e64 v96, v96
  v_mov_b32_dpp v66, v64 row_ror:8 row_mask:0xf bank_mask:0xf
  v_mov_b32_dpp v67, v65 row_ror:8 row_mask:0xf bank_mask:0xf
  v_exp_f32 v97, v97
  s_nop 0
  v_mfma_f32_16x16x32_bf16 v[120:123], v[40:43], v[64:67], 0
  v_cvt_pk_bf16_f32 v68, v96, v97
  v_mfma_f32_16x16x32_bf16 v[124:127], v[28:31], v[64:67], 0
  s_nop 0
  v_mov_b32_dpp v69, v68 row_ror:8 row_mask:0xf bank_mask:0xf
  s_nop 1
  v_mfma_f32_16x16x16_bf16 v[120:123], v[40:41], v[68:69], v[120:123]
  v_mfma_f32_16x16x16_bf16 v[124:127], v[18:19], v[68:69], v[124:127]
  s_mov_b64 exec, s[70:71]
  s_nop 3
  v_rcp_f32 v0, v120
  s_nop 1
  v_pk_mul_f32 v[124:125], v[124:125], v[0:1] op_sel_hi:[1,0]
  v_pk_mul_f32 v[126:127], v[126:127], v[0:1] op_sel_hi:[1,0]
  v_cvt_pk_bf16_f32 v120, v124, v125
  v_cvt_pk_bf16_f32 v121, v126, v127
  v_min_u32 v120, -2, v120
  buffer_store_dwordx2 v[120:121], v12, s[32:35], s58 offen
  s_mov_b64 exec, -1
  s_cmp_eq_u32 s50, 3
  s_cbranch_scc0 Lfast_w3e_79
  v_mov_b32 v124, -1
  v_mov_b32 v125, -1
  v_mov_b32 v126, -1
  v_mov_b32 v127, -1
  buffer_store_dwordx4 v[124:127], v10, s[32:35], s61 offen
Lfast_w3e_79:
  ds_read_b128 v[72:75], v13 offset:0
  ds_read_b128 v[76:79], v13 offset:1024
  ds_read_b128 v[80:83], v13 offset:2048
  ds_read_b128 v[84:87], v13 offset:3072
  ds_read_b128 v[104:107], v13 offset:4096
  ds_read_b128 v[108:111], v13 offset:5120
  ds_read_b128 v[112:115], v13 offset:6144
  ds_read_b128 v[116:119], v13 offset:7168
  ds_read_b128 v[88:91], v13 offset:8192
  ds_read_b128 v[92:95], v13 offset:9216
  ds_read_b128 v[96:99], v13 offset:10240
  ds_read_b128 v[100:103], v13 offset:11264
  v_mov_b32 v64, 0
  v_mov_b32 v65, 0
  v_mov_b32 v66, 0
  v_mov_b32 v67, 0
  v_mov_b32 v68, 0
  v_mov_b32 v69, 0
  v_mov_b32 v70, 0
  v_mov_b32 v71, 0
  s_xor_b32 s57, s57, 131072
  s_xor_b32 s61, s61, 65536
  s_xor_b32 s80, s80, 0x8000
  s_add_u32 s44, s44, 0x8000
  s_xor_b32 s81, s81, 0x8000
  s_add_u32 s45, s45, 0x8000
  s_xor_b32 s82, s82, 0x8000
  s_add_u32 s46, s46, 0x8000
  s_xor_b32 s83, s83, 0x8000
  s_add_u32 s47, s47, 0x8000
  s_lshl_b32 s75, s50, 10
  v_add_u32_e64 v122, s75, v9
  s_waitcnt vmcnt(0)
  buffer_load_dwordx4 v[32:35], v10, s[32:35], s59 offen offset:0 sc1
  buffer_load_dwordx4 v[36:39], v10, s[32:35], s59 offen offset:1024 sc1
  s_barrier
  buffer_load_dwordx4 v[40:43], v10, s[32:35], s59 offen offset:2048 sc1
  buffer_load_dwordx4 v[44:47], v10, s[32:35], s59 offen offset:3072 sc1
Lfast_chk_83:
  s_waitcnt vmcnt(2)
  v_max3_u32 v0, v32, v34, v36
  v_max_u32 v0, v0, v38
  v_cmp_eq_u32 vcc, -1, v0
  buffer_load_dwordx4 v[48:51], v10, s[32:35], s60 offen offset:0 sc1
  buffer_load_dwordx4 v[52:55], v10, s[32:35], s60 offen offset:1024 sc1
  s_cbranch_vccnz Lfast_bad_84
  s_waitcnt lgkmcnt(8)
  v_smfmac_f32_16x16x64_bf16 v[64:67], v[32:35], v[72:79], v15
  ds_read_b128 v[72:75], v13 offset:12288
  ds_read_b128 v[76:79], v13 offset:13312
  v_smfmac_f32_16x16x64_bf16 v[68:71], v[32:35], v[80:87], v15
  ds_read_b128 v[80:83], v13 offset:14336
  ds_read_b128 v[84:87], v13 offset:15360
  s_waitcnt lgkmcnt(8)
  v_smfmac_f32_16x16x64_bf16 v[64:67], v[36:39], v[104:111], v15
  ds_read_b128 v[104:107], v13 offset:16384
  ds_read_b128 v[108:111], v13 offset:17408
  v_smfmac_f32_16x16x64_bf16 v[68:71], v[36:39], v[112:119], v15
  ds_read_b128 v[112:115], v13 offset:18432
  ds_read_b128 v[116:119], v13 offset:19456
Lfast_chk_85:
  s_waitcnt vmcnt(2)
  v_max3_u32 v0, v40, v42, v44
  v_max_u32 v0, v0, v46
  v_cmp_eq_u32 vcc, -1, v0
  buffer_load_dwordx4 v[56:59], v10, s[32:35], s60 offen offset:2048 sc1
  buffer_load_dwordx4 v[60:63], v10, s[32:35], s60 offen offset:3072 sc1
  s_cbranch_vccnz Lfast_bad_86
  s_waitcnt lgkmcnt(8)
  v_smfmac_f32_16x16x64_bf16 v[64:67], v[40:43], v[88:95], v15
  ds_read_b128 v[88:91], v13 offset:20480
  ds_read_b128 v[92:95], v13 offset:21504
  v_smfmac_f32_16x16x64_bf16 v[68:71], v[40:43], v[96:103], v15
  ds_read_b128 v[96:99], v13 offset:22528
  ds_read_b128 v[100:103], v13 offset:23552
  s_waitcnt lgkmcnt(8)
  v_smfmac_f32_16x16x64_bf16 v[64:67], v[44:47], v[72:79], v15
  ds_read_b128 v[72:75], v13 offset:24576
  ds_read_b128 v[76:79], v13 offset:25600
  v_smfmac_f32_16x16x64_bf16 v[68:71], v[44:47], v[80:87], v15
  ds_read_b128 v[80:83], v13 offset:26624
  ds_read_b128 v[84:87], v13 offset:27648
Lfast_chk_87:
  s_waitcnt vmcnt(2)
  v_max3_u32 v0, v48, v50, v52
  v_max_u32 v0, v0, v54
  v_cmp_eq_u32 vcc, -1, v0
  s_cbranch_vccnz Lfast_bad_88
  s_waitcnt lgkmcnt(8)
  v_smfmac_f32_16x16x64_bf16 v[64:67], v[48:51], v[104:111], v15
  ds_read_b128 v[104:107], v13 offset:28672
  ds_read_b128 v[108:111], v13 offset:29696
  v_smfmac_f32_16x16x64_bf16 v[68:71], v[48:51], v[112:119], v15
  ds_read_b128 v[112:115], v13 offset:30720
  ds_read_b128 v[116:119], v13 offset:31744
  s_waitcnt lgkmcnt(8)
  v_smfmac_f32_16x16x64_bf16 v[64:67], v[52:55], v[88:95], v15
  v_smfmac_f32_16x16x64_bf16 v[68:71], v[52:55], v[96:103], v15
Lfast_chk_89:
  s_waitcnt vmcnt(0)
  v_max3_u32 v0, v56, v58, v60
  v_max_u32 v0, v0, v62
  v_cmp_eq_u32 vcc, -1, v0
  s_cbranch_vccnz Lfast_bad_90
  s_waitcnt lgkmcnt(4)
  v_smfmac_f32_16x16x64_bf16 v[64:67], v[56:59], v[72:79], v15
  v_smfmac_f32_16x16x64_bf16 v[68:71], v[56:59], v[80:87], v15
  s_waitcnt lgkmcnt(0)
  v_smfmac_f32_16x16x64_bf16 v[64:67], v[60:63], v[104:111], v15
  v_smfmac_f32_16x16x64_bf16 v[68:71], v[60:63], v[112:119], v15
  s_cmp_lg_u32 s50, 0
  s_nop 6
  v_permlane32_swap_b32 v64, v68
  v_permlane32_swap_b32 v65, v69
  v_permlane32_swap_b32 v66, v70
  v_permlane32_swap_b32_e64 v67, v71
  v_pk_add_f32 v[64:65], v[64:65], v[68:69]
  v_pk_add_f32 v[66:67], v[66:67], v[70:71]
  ds_write_b128 v122, v[64:67]
  s_waitcnt lgkmcnt(0)
  s_barrier
  s_cbranch_scc1 Lfast_oth_91
  ds_read_b128 v[36:39], v9 offset:1024
  ds_read_b128 v[40:43], v9 offset:2048
  ds_read_b128 v[44:47], v9 offset:3072
  s_waitcnt lgkmcnt(2)
  v_pk_add_f32 v[64:65], v[64:65], v[36:37]
  v_pk_add_f32 v[66:67], v[66:67], v[38:39]
  s_waitcnt lgkmcnt(1)
  v_pk_add_f32 v[64:65], v[64:65], v[40:41]
  v_pk_add_f32 v[66:67], v[66:67], v[42:43]
  s_waitcnt lgkmcnt(0)
  v_pk_add_f32 v[64:65], v[64:65], v[44:45]
  v_pk_add_f32 v[66:67], v[66:67], v[46:47]
  v_cvt_pk_bf16_f32 v64, v64, v65
  v_cvt_pk_bf16_f32 v65, v66, v67
  v_min_u32_e64 v64, -2, v64
  buffer_store_dwordx2 v[64:65], v6, s[32:35], s41 offen
  buffer_store_dwordx2 v[64:65], v6, s[32:35], s40 offen sc1
  s_add_u32 s75, s51, 2
  s_min_u32 s75, s75, 63
  s_and_b32 s75, s75, 0x38
  s_lshl_b32 s75, s75, 1
  s_andn2_b32 s67, s67, 0x70
  s_or_b32 s67, s67, s75
  buffer_load_dword v16, v17, s[32:35], s67 offen sc1
  s_cmp_lt_u32 s50, 2
  s_cbranch_scc1 Lfast_km_93
  s_and_b32 s75, s50, 1
  s_lshl_b32 s75, s75, 8
  v_add_u32 v0, s75, v8
  ds_read_b64_tr_b16 v[88:89], v0
  ds_read_b64_tr_b16 v[90:91], v0 offset:128
  s_waitcnt lgkmcnt(0)
  s_mov_b64 exec, s[72:73]
  buffer_store_dwordx4 v[88:91], v11, s[32:35], s64 offen sc1
Lfast_km_93:
  s_mov_b32 exec_lo, 0
  s_mov_b32 exec_hi, -1
  v_lshrrev_b32 v0, 1, v10
  buffer_store_dwordx2 v[18:19], v0, s[32:35], s65 offen sc1
  s_mov_b64 exec, -1
  v_mov_b32 v120, 0
  v_mov_b32 v121, 0
  v_mov_b32 v122, 0
  v_mov_b32 v123, 0
  v_mov_b32 v124, 0
  v_mov_b32 v125, 0
  v_mov_b32 v126, 0
  v_mov_b32 v127, 0
  v_mov_b32 v64, v20
  v_mov_b32 v28, v24
  v_mov_b32 v65, v21
  v_mov_b32 v29, v25
  v_mov_b32 v66, v22
  v_mov_b32 v30, v26
  v_mov_b32 v67, v23
  v_mov_b32 v31, v27
  v_permlane32_swap_b32 v120, v64
  v_permlane32_swap_b32 v121, v65
  v_permlane32_swap_b32 v122, v66
  v_permlane32_swap_b32_e64 v123, v67
  s_branch Lfast_join
Lfast_last:
  s_waitcnt lgkmcnt(0)
  s_barrier
  ds_read_b64_tr_b16 v[120:121], v8 offset:0
  ds_read_b64_tr_b16 v[122:123], v8 offset:128
  ds_read_b64_tr_b16 v[124:125], v8 offset:256
  ds_read_b64_tr_b16 v[126:127], v8 offset:384
  s_cmp_lg_u32 s50, 1
  s_cbranch_scc1 Lfast_l2
  v_mov_b32 v0, 0
  v_mov_b32 v92, 63
  s_mov_b64 exec, 1
  buffer_store_dword v92, v0, s[32:35], s68 offen sc1
  s_mov_b64 exec, -1
Lfast_l2:
  ds_read_b128 v[104:107], v3 offset:0
  ds_read_b128 v[108:111], v3 offset:1024
  ds_read_b128 v[112:115], v3 offset:2048
  ds_read_b128 v[116:119], v3 offset:3072
  v_smfmac_f32_16x16x64_bf16 v[100:103], v[32:35], v[224:231], v15
  v_smfmac_f32_16x16x64_bf16 v[100:103], v[36:39], v[232:239], v15
  v_smfmac_f32_16x16x64_bf16 v[100:103], v[40:43], v[240:247], v15
  v_smfmac_f32_16x16x64_bf16 v[100:103], v[44:47], v[248:255], v15
  v_smfmac_f32_16x16x64_bf16 v[100:103], v[48:51], v[192:199], v15
  v_smfmac_f32_16x16x64_bf16 v[100:103], v[52:55], v[200:207], v15
  v_smfmac_f32_16x16x64_bf16 v[100:103], v[56:59], v[208:215], v15
  v_smfmac_f32_16x16x64_bf16 v[100:103], v[60:63], v[216:223], v15
  v_smfmac_f32_16x16x64_bf16 v[100:103], v[72:75], v[128:135], v15
  v_smfmac_f32_16x16x64_bf16 v[100:103], v[76:79], v[136:143], v15
  v_smfmac_f32_16x16x64_bf16 v[100:103], v[80:83], v[144:151], v15
  v_smfmac_f32_16x16x64_bf16 v[100:103], v[84:87], v[152:159], v15
  s_waitcnt lgkmcnt(0)
  v_smfmac_f32_16x16x64_bf16 v[100:103], v[104:107], v[160:167], v15
  v_smfmac_f32_16x16x64_bf16 v[100:103], v[108:111], v[168:175], v15
  v_smfmac_f32_16x16x64_bf16 v[100:103], v[112:115], v[176:183], v15
  v_smfmac_f32_16x16x64_bf16 v[100:103], v[116:119], v[184:191], v15
  s_nop 7
  v_mov_b32 v64, v100
  v_mov_b32 v65, v101
  v_mov_b32 v66, v102
  v_mov_b32 v67, v103
  s_nop 0
  v_permlane32_swap_b32 v100, v64
  v_permlane32_swap_b32 v101, v65
  v_permlane32_swap_b32 v102, v66
  v_permlane32_swap_b32_e64 v103, v67
  v_pk_add_f32 v[64:65], v[64:65], v[100:101]
  v_pk_add_f32 v[66:67], v[66:67], v[102:103]
  v_cvt_pk_bf16_f32 v18, v64, v65
  v_cvt_pk_bf16_f32 v19, v66, v67
  s_cmp_lt_u32 s50, 2
  s_cbranch_scc1 Lfast_km_98
  s_and_b32 s75, s50, 1
  s_lshl_b32 s75, s75, 8
  v_add_u32_e64 v0, s75, v8
  ds_read_b64_tr_b16 v[88:89], v0
  ds_read_b64_tr_b16 v[90:91], v0 offset:128
  s_waitcnt lgkmcnt(0)
  s_mov_b64 exec, s[72:73]
  buffer_store_dwordx4 v[88:91], v11, s[32:35], s64 offen sc1
Lfast_km_98:
  s_mov_b32 exec_lo, 0
  s_mov_b32 exec_hi, -1
  v_lshrrev_b32 v0, 1, v10
  buffer_store_dwordx2 v[18:19], v0, s[32:35], s65 offen sc1
  s_mov_b64 exec, -1
  v_mov_b32 v0, 0
  v_mov_b32 v92, 64
  s_waitcnt vmcnt(0)
  s_barrier
  s_mov_b64 exec, 1
  s_cmp_lg_u32 s50, 1
  s_cbranch_scc1 Lfast_fin
  buffer_store_dword v92, v0, s[32:35], s68 offen sc1
Lfast_fin:
  s_endpgm
Lfast_enter:
  s_waitcnt vmcnt(0)
  v_mov_b32 v120, 0
  v_mov_b32 v121, 0
  v_mov_b32 v122, 0
  v_mov_b32 v123, 0
  v_mov_b32 v124, 0
  v_mov_b32 v125, 0
  v_mov_b32 v126, 0
  v_mov_b32 v127, 0
  v_mov_b32 v64, v20
  v_mov_b32 v28, v24
  v_mov_b32 v65, v21
  v_mov_b32 v29, v25
  v_mov_b32 v66, v22
  v_mov_b32 v30, v26
  v_mov_b32 v67, v23
  v_mov_b32 v31, v27
  v_permlane32_swap_b32 v120, v64
  v_permlane32_swap_b32 v121, v65
  v_permlane32_swap_b32 v122, v66
  v_permlane32_swap_b32 v123, v67
  s_branch Lfast_step
Lhop_0:
  s_branch Lhop_1
Lfast_fb_64:
Lfast_fa_66:
  buffer_load_dword v16, v17, s[32:35], s67 offen sc1
  s_waitcnt vmcnt(0)
  v_cmp_ne_u32 vcc, 1, v16
  s_cbranch_vccz Lfast_fo_65
  s_sub_u32 s69, s69, 1
  s_cbranch_scc0 Lfast_fa_66
  s_endpgm
Lhop_1:
  s_branch Lhop_2
Lfast_bad_69:
  buffer_load_dwordx4 v[32:35], v10, s[32:35], s80 offen sc1
  buffer_load_dwordx4 v[36:39], v10, s[32:35], s81 offen sc1
  s_waitcnt vmcnt(0)
  s_sub_u32 s69, s69, 1
  s_cbranch_scc0 Lfast_chk_68
  s_endpgm
Lhop_2:
  s_branch Lhop_3
Lfast_bad_71:
  buffer_load_dwordx4 v[40:43], v10, s[32:35], s82 offen sc1
  buffer_load_dwordx4 v[44:47], v10, s[32:35], s83 offen sc1
  s_waitcnt vmcnt(0)
  s_sub_u32 s69, s69, 1
  s_cbranch_scc0 Lfast_chk_70
  s_endpgm
Lhop_3:
  s_branch Lhop_4
Lfast_bad_73:
  buffer_load_dwordx4 v[48:51], v10, s[32:35], s44 offen sc1
  buffer_load_dwordx4 v[52:55], v10, s[32:35], s45 offen sc1
  buffer_load_dwordx4 v[56:59], v10, s[32:35], s46 offen sc1
  buffer_load_dwordx4 v[60:63], v10, s[32:35], s47 offen sc1
  s_sub_u32 s69, s69, 1
  s_cbranch_scc0 Lfast_chk_72
  s_endpgm
Lhop_4:
  s_branch Lhop_5
Lfast_bad_75:
  buffer_load_dwordx4 v[56:59], v10, s[32:35], s46 offen sc1
  buffer_load_dwordx4 v[60:63], v10, s[32:35], s47 offen sc1
  s_sub_u32 s69, s69, 1
  s_cbranch_scc0 Lfast_chk_74
  s_endpgm
Lhop_5:
  s_branch Lhop_6
Lfast_p1_76:
  s_waitcnt lgkmcnt(0)
  s_barrier
  ds_read_b64_tr_b16 v[120:121], v8 offset:0
  ds_read_b64_tr_b16 v[122:123], v8 offset:128
  ds_read_b64_tr_b16 v[124:125], v8 offset:256
  ds_read_b64_tr_b16 v[126:127], v8 offset:384
  s_waitcnt lgkmcnt(2)
  v_mfma_f32_16x16x32_bf16 v[92:95], v[112:115], v[120:123], 0
  s_waitcnt lgkmcnt(0)
  v_mfma_f32_16x16x32_bf16 v[92:95], v[116:119], v[124:127], v[92:95]
  v_mfma_f32_16x16x32_bf16 v[88:91], v[104:107], v[120:123], 0
  v_mfma_f32_16x16x32_bf16 v[96:99], v[120:123], v[120:123], 0
  s_mov_b64 exec, s[70:71]
  v_min_u32 v92, -2, v92
  buffer_store_dwordx4 v[92:95], v10, s[32:35], s56 offen offset:128
  s_mov_b64 exec, -1
  v_mfma_f32_16x16x32_bf16 v[88:91], v[108:111], v[124:127], v[88:91]
  v_mfma_f32_16x16x32_bf16 v[96:99], v[124:127], v[124:127], v[96:99]
  s_branch Lfast_pd_78
Lfast_p2_77:
  s_waitcnt lgkmcnt(0)
  s_barrier
  ds_read_b64_tr_b16 v[120:121], v8 offset:0
  ds_read_b64_tr_b16 v[122:123], v8 offset:128
  ds_read_b64_tr_b16 v[124:125], v8 offset:256
  ds_read_b64_tr_b16 v[126:127], v8 offset:384
  s_waitcnt lgkmcnt(2)
  v_mfma_f32_16x16x32_bf16 v[96:99], v[120:123], v[120:123], 0
  s_waitcnt lgkmcnt(0)
  v_mfma_f32_16x16x32_bf16 v[96:99], v[124:127], v[124:127], v[96:99]
  v_mfma_f32_16x16x32_bf16 v[88:91], v[104:107], v[120:123], 0
  v_mfma_f32_16x16x32_bf16 v[92:95], v[112:115], v[120:123], 0
  s_mov_b64 exec, s[70:71]
  v_min_u32 v96, -2, v96
  v_min_u32 v98, -2, v98
  buffer_store_dwordx4 v[96:99], v11, s[32:35], s56 offen offset:1024
  s_mov_b64 exec, -1
  v_mfma_f32_16x16x32_bf16 v[88:91], v[108:111], v[124:127], v[88:91]
  v_mfma_f32_16x16x32_bf16 v[92:95], v[116:119], v[124:127], v[92:95]
  s_branch Lfast_pd_78
Lhop_6:
  s_branch Lhop_7
Lfast_sb_80:
  s_waitcnt vmcnt(0)
  v_max_u32 v0, v48, v52
  v_cmp_eq_u32 vcc, -1, v0
  s_cbranch_vccnz Lfast_sb_81
  v_pk_add_f32 v[88:89], v[88:89], v[48:49]
  v_pk_add_f32 v[90:91], v[90:91], v[50:51]
  v_pk_add_f32 v[96:97], v[96:97], v[52:53]
  s_branch Lfast_sok_82
Lfast_sb_81:
  buffer_load_dwordx4 v[48:51], v10, s[32:35], s57 offen sc1
  buffer_load_dwordx2 v[52:53], v14, s[32:35], s57 offen offset:1024 sc1
  s_sub_u32 s69, s69, 1
  s_cbranch_scc0 Lfast_sb_80
  s_endpgm
Lhop_7:
  s_branch Lhop_8
Lfast_bad_84:
  buffer_load_dwordx4 v[32:35], v10, s[32:35], s59 offen offset:0 sc1
  buffer_load_dwordx4 v[36:39], v10, s[32:35], s59 offen offset:1024 sc1
  buffer_load_dwordx4 v[40:43], v10, s[32:35], s59 offen offset:2048 sc1
  buffer_load_dwordx4 v[44:47], v10, s[32:35], s59 offen offset:3072 sc1
  s_sub_u32 s69, s69, 1
  s_cbranch_scc0 Lfast_chk_83
  s_endpgm
Lhop_8:
  s_branch Lhop_9
Lfast_bad_86:
  buffer_load_dwordx4 v[40:43], v10, s[32:35], s59 offen offset:2048 sc1
  buffer_load_dwordx4 v[44:47], v10, s[32:35], s59 offen offset:3072 sc1
  buffer_load_dwordx4 v[48:51], v10, s[32:35], s60 offen offset:0 sc1
  buffer_load_dwordx4 v[52:55], v10, s[32:35], s60 offen offset:1024 sc1
  s_sub_u32 s69, s69, 1
  s_cbranch_scc0 Lfast_chk_85
  s_endpgm
Lhop_9:
  s_branch Lhop_10
Lfast_bad_88:
  buffer_load_dwordx4 v[48:51], v10, s[32:35], s60 offen offset:0 sc1
  buffer_load_dwordx4 v[52:55], v10, s[32:35], s60 offen offset:1024 sc1
  buffer_load_dwordx4 v[56:59], v10, s[32:35], s60 offen offset:2048 sc1
  buffer_load_dwordx4 v[60:63], v10, s[32:35], s60 offen offset:3072 sc1
  s_sub_u32 s69, s69, 1
  s_cbranch_scc0 Lfast_chk_87
  s_endpgm
Lhop_10:
  s_branch Lhop_11
Lfast_bad_90:
  buffer_load_dwordx4 v[56:59], v10, s[32:35], s60 offen offset:2048 sc1
  buffer_load_dwordx4 v[60:63], v10, s[32:35], s60 offen offset:3072 sc1
  s_sub_u32 s69, s69, 1
  s_cbranch_scc0 Lfast_chk_89
  s_endpgm
Lhop_11:
  s_branch Lhop_12
Lfast_oth_91:
  s_cmp_lg_u32 s50, 1
  s_cbranch_scc1 Lfast_w1_94
  v_mov_b32 v88, -1
  v_mov_b32 v89, -1
  v_mov_b32 v90, -1
  v_mov_b32_e64 v91, -1
  s_xor_b32 s75, s41, 32768
  buffer_store_dwordx4 v[88:91], v10, s[32:35], s56 offen
  buffer_store_dwordx4 v[88:91], v10, s[32:35], s56 offen offset:1024
  buffer_store_dwordx2 v[88:89], v6, s[32:35], s75 offen
Lfast_w1_94:
  s_add_u32 s75, s51, 2
  s_min_u32 s75, s75, 63
  s_and_b32 s75, s75, 0x38
  s_lshl_b32 s75, s75, 1
  s_andn2_b32 s67, s67, 0x70
  s_or_b32 s67, s67, s75
  buffer_load_dword v16, v17, s[32:35], s67 offen sc1
  s_cmp_lt_u32 s50, 2
  s_cbranch_scc1 Lfast_km_95
  s_and_b32 s75, s50, 1
  s_lshl_b32 s75, s75, 8
  v_add_u32 v0, s75, v8
  ds_read_b64_tr_b16 v[88:89], v0
  ds_read_b64_tr_b16 v[90:91], v0 offset:128
  s_waitcnt lgkmcnt(0)
  s_mov_b64 exec, s[72:73]
  buffer_store_dwordx4 v[88:91], v11, s[32:35], s64 offen sc1
Lfast_km_95:
  s_mov_b32 exec_lo, 0
  s_mov_b32 exec_hi, -1
  v_lshrrev_b32 v0, 1, v10
  buffer_store_dwordx2 v[18:19], v0, s[32:35], s65 offen sc1
  s_mov_b64 exec, -1
  s_cmp_lg_u32 s50, 1
  s_cbranch_scc1 Lfast_nc_96
  s_cmp_gt_u32 s51, 58
  s_cbranch_scc1 Lfast_nc_96
  s_add_u32 s75, s40, 131072
  buffer_store_dwordx2 v[88:89], v6, s[32:35], s75 offen sc1
Lfast_nc_96:
  s_cmp_lg_u32 s50, 1
  s_cbranch_scc1 Lfast_nb_97
  v_mov_b32 v92, s51
  v_mov_b32 v0, 0
  s_mov_b64 exec, 1
  buffer_store_dword v92, v0, s[32:35], s68 offen sc1
  s_mov_b64 exec, -1
Lfast_nb_97:
  v_mov_b32 v120, 0
  v_mov_b32 v121, 0
  v_mov_b32 v122, 0
  v_mov_b32 v123, 0
  v_mov_b32 v124, 0
  v_mov_b32 v125, 0
  v_mov_b32 v126, 0
  v_mov_b32 v127, 0
  v_mov_b32 v64, v20
  v_mov_b32 v28, v24
  v_mov_b32 v65, v21
  v_mov_b32 v29, v25
  v_mov_b32 v66, v22
  v_mov_b32 v30, v26
  v_mov_b32 v67, v23
  v_mov_b32 v31, v27
  v_permlane32_swap_b32 v120, v64
  v_permlane32_swap_b32 v121, v65
  v_permlane32_swap_b32 v122, v66
  v_permlane32_swap_b32 v123, v67
  s_branch Lfast_join2
Lhop_12:
  s_branch Lhop_back
  .p2align 6
  s_nop 0
Lslow_join:
  s_waitcnt vmcnt(3)
Lslow_join2:
  s_barrier
Lslow_step:
  buffer_load_dwordx4 v[32:35], v10, s[32:35], s80 offen sc1
  buffer_load_dwordx4 v[36:39], v10, s[32:35], s81 offen sc1
  buffer_load_dwordx4 v[40:43], v10, s[32:35], s82 offen sc1
  buffer_load_dwordx4 v[44:47], v10, s[32:35], s83 offen sc1
  s_cmp_lg_u32 s50, 0
  s_cbranch_scc1 Lslow_nw_102
  s_waitcnt vmcnt(6)
Lslow_nw_102:
  s_barrier
  buffer_load_dwordx4 v[48:51], v10, s[32:35], s44 offen sc1
  buffer_load_dwordx4 v[52:55], v10, s[32:35], s45 offen sc1
  s_barrier
  buffer_load_dwordx4 v[56:59], v10, s[32:35], s46 offen sc1
  buffer_load_dwordx4 v[60:63], v10, s[32:35], s47 offen sc1
  s_add_u32 s51, s51, 1
  s_nop 0
  s_add_u32 s40, s40, 32768
  s_xor_b32 s41, s41, 32768
  s_xor_b32 s56, s56, 131072
  s_xor_b32 s58, s58, 65536
  s_xor_b32 s59, s59, 65536
  s_xor_b32 s60, s60, 65536
  s_add_u32 s42, s42, 262144
  s_lshr_b32 s75, s42, 8
  s_and_b32 s75, s75, 0x2000
  s_xor_b32 s75, s75, s43
  s_add_u32 s64, s42, s75
  s_lshl_b32 s75, s50, 8
  s_add_u32 s65, s64, s75
  s_add_u32 s65, s65, 768
  s_and_b32 s75, s50, 1
  s_lshl_b32 s75, s75, 9
  s_add_u32 s64, s64, s75
  s_xor_b32 s66, s66, 4096
  v_xor_b32 v9, 4096, v9
  s_cmp_lt_u32 s51, 63
  s_cselect_b32 s75, 262144, 0
  s_add_u32 s62, s62, s75
  s_add_u32 s63, s63, s75
  s_mov_b32 m0, s66
  s_waitcnt vmcnt(8)
  v_cmp_ne_u32 vcc, 1, v16
  s_cbranch_vccnz Lslow_fb_99
Lslow_fo_100:
  s_waitcnt vmcnt(6)
Lslow_chk_103:
  v_max3_u32 v0, v32, v34, v36
  v_max_u32 v0, v0, v38
  v_cmp_eq_u32 vcc, -1, v0
  v_mfma_f32_16x16x32_bf16 v[88:91], v[32:35], v[20:23], 0
  v_mfma_f32_16x16x32_bf16 v[92:95], v[32:35], v[120:123], 0
  v_mfma_f32_16x16x32_bf16 v[96:99], v[36:39], v[20:23], 0
  v_mfma_f32_16x16x32_bf16 v[100:103], v[36:39], v[120:123], 0
  s_cbranch_vccnz Lslow_bad_104
  s_waitcnt vmcnt(4)
Lslow_chk_105:
  v_max3_u32 v0, v40, v42, v44
  v_max_u32 v0, v0, v46
  v_cmp_eq_u32 vcc, -1, v0
  v_mfma_f32_16x16x32_bf16 v[104:107], v[40:43], v[20:23], 0
  v_mfma_f32_16x16x32_bf16 v[108:111], v[40:43], v[120:123], 0
  v_mfma_f32_16x16x32_bf16 v[112:115], v[44:47], v[20:23], 0
  v_mfma_f32_16x16x32_bf16 v[116:119], v[44:47], v[120:123], 0
  s_cbranch_vccnz Lslow_bad_106
Lslow_chk_107:
  s_waitcnt vmcnt(3)
  v_mfma_f32_16x16x32_bf16 v[64:67], v[48:51], v[20:23], v[88:91]
  v_mfma_f32_16x16x32_bf16 v[68:71], v[48:51], v[120:123], v[92:95]
  s_waitcnt vmcnt(2)
  v_mfma_f32_16x16x32_bf16 v[32:35], v[52:55], v[20:23], v[96:99]
  v_mfma_f32_16x16x32_bf16 v[36:39], v[52:55], v[120:123], v[100:103]
  v_max3_u32 v0, v48, v50, v52
  v_max_u32 v0, v0, v54
  v_cmp_eq_u32_e64 vcc, -1, v0
  v_cvt_pk_bf16_f32 v72, v64, v65
  v_cvt_pk_bf16_f32 v73, v66, v67
  v_cvt_pk_bf16_f32 v74, v68, v69
  v_cvt_pk_bf16_f32 v75, v70, v71
  ds_write_b128 v2, v[72:75] offset:0
  s_cbranch_vccnz Lslow_bad_108
Lslow_chk_109:
  s_waitcnt vmcnt(1)
  v_mfma_f32_16x16x32_bf16 v[40:43], v[56:59], v[20:23], v[104:107]
  v_mfma_f32_16x16x32_bf16 v[44:47], v[56:59], v[120:123], v[108:111]
  v_cvt_pk_bf16_f32 v76, v32, v33
  v_cvt_pk_bf16_f32 v77, v34, v35
  v_cvt_pk_bf16_f32 v78, v36, v37
  v_cvt_pk_bf16_f32 v79, v38, v39
  ds_write_b128 v2, v[76:79] offset:1024
  s_waitcnt vmcnt(0)
  v_mfma_f32_16x16x32_bf16 v[64:67], v[60:63], v[20:23], v[112:115]
  v_mfma_f32_16x16x32_bf16 v[68:71], v[60:63], v[120:123], v[116:119]
  v_max3_u32 v0, v56, v58, v60
  v_max_u32 v0, v0, v62
  v_cmp_eq_u32_e64 vcc, -1, v0
  v_cvt_pk_bf16_f32 v80, v40, v41
  v_cvt_pk_bf16_f32 v81, v42, v43
  v_cvt_pk_bf16_f32 v82, v44, v45
  v_cvt_pk_bf16_f32 v83, v46, v47
  ds_write_b128 v2, v[80:83] offset:2048
  s_cbranch_vccnz Lslow_bad_110
  s_nop 0
  v_cvt_pk_bf16_f32 v84, v64, v65
  v_cvt_pk_bf16_f32 v85, v66, v67
  v_cvt_pk_bf16_f32 v86, v68, v69
  v_cvt_pk_bf16_f32 v87, v70, v71
  ds_write_b128 v2, v[84:87] offset:3072
  v_mov_b32 v120, 0
  v_mov_b32 v121, 0
  v_mov_b32 v122, 0
  v_mov_b32 v123, 0
  v_mov_b32 v100, 0
  v_mov_b32 v101, 0
  v_mov_b32 v102, 0
  v_mov_b32 v103, 0
  v_smfmac_f32_16x16x64_bf16 v[120:123], v[72:75], a[0:7], v15
  v_smfmac_f32_16x16x64_bf16 v[124:127], v[72:75], a[128:135], v15
  v_smfmac_f32_16x16x64_bf16 v[120:123], v[76:79], a[8:15], v15
  v_smfmac_f32_16x16x64_bf16 v[124:127], v[76:79], a[136:143], v15
  s_waitcnt lgkmcnt(0)
  s_barrier
  ds_read_b128 v[32:35], v3 offset:0
  ds_read_b128 v[36:39], v3 offset:1024
  ds_read_b128 v[40:43], v3 offset:2048
  ds_read_b128 v[44:47], v3 offset:3072
  ds_read_b128 v[48:51], v4 offset:0
  ds_read_b128 v[52:55], v4 offset:1024
  ds_read_b128 v[56:59], v4 offset:2048
  ds_read_b128 v[60:63], v4 offset:3072
  v_smfmac_f32_16x16x64_bf16 v[120:123], v[80:83], a[16:23], v15
  v_smfmac_f32_16x16x64_bf16 v[124:127], v[80:83], a[144:151], v15
  buffer_load_dwordx4 v10, s[32:35], s62 offen sc1 lds
  v_smfmac_f32_16x16x64_bf16 v[120:123], v[84:87], a[24:31], v15
  v_smfmac_f32_16x16x64_bf16 v[124:127], v[84:87], a[152:159], v15
  buffer_load_dwordx4 v[24:27], v10, s[32:35], s63 offen sc1
  s_waitcnt lgkmcnt(7)
  v_smfmac_f32_16x16x64_bf16 v[120:123], v[32:35], a[32:39], v15
  v_smfmac_f32_16x16x64_bf16 v[124:127], v[32:35], a[160:167], v15
  ds_read_b128 v[32:35], v5 offset:0
  s_waitcnt lgkmcnt(7)
  v_smfmac_f32_16x16x64_bf16 v[120:123], v[36:39], a[40:47], v15
  v_smfmac_f32_16x16x64_bf16 v[124:127], v[36:39], a[168:175], v15
  ds_read_b128 v[36:39], v5 offset:1024
  s_waitcnt lgkmcnt(7)
  v_smfmac_f32_16x16x64_bf16 v[120:123], v[40:43], a[48:55], v15
  v_smfmac_f32_16x16x64_bf16 v[124:127], v[40:43], a[176:183], v15
  ds_read_b128 v[40:43], v5 offset:2048
  s_waitcnt lgkmcnt(7)
  v_smfmac_f32_16x16x64_bf16 v[120:123], v[44:47], a[56:63], v15
  v_smfmac_f32_16x16x64_bf16 v[124:127], v[44:47], a[184:191], v15
  ds_read_b128 v[44:47], v5 offset:3072
  s_waitcnt lgkmcnt(7)
  v_smfmac_f32_16x16x64_bf16 v[120:123], v[48:51], a[64:71], v15
  v_smfmac_f32_16x16x64_bf16 v[124:127], v[48:51], a[192:199], v15
  ds_read_b128 v[104:107], v9 offset:0
  s_waitcnt lgkmcnt(7)
  v_smfmac_f32_16x16x64_bf16 v[120:123], v[52:55], a[72:79], v15
  v_smfmac_f32_16x16x64_bf16 v[124:127], v[52:55], a[200:207], v15
  ds_read_b128 v[108:111], v9 offset:1024
  s_waitcnt lgkmcnt(7)
  v_smfmac_f32_16x16x64_bf16 v[120:123], v[56:59], a[80:87], v15
  v_smfmac_f32_16x16x64_bf16 v[124:127], v[56:59], a[208:215], v15
  ds_read_b128 v[112:115], v9 offset:2048
  s_waitcnt lgkmcnt(7)
  v_smfmac_f32_16x16x64_bf16 v[120:123], v[60:63], a[88:95], v15
  v_smfmac_f32_16x16x64_bf16 v[124:127], v[60:63], a[216:223], v15
  ds_read_b128 v[116:119], v9 offset:3072
  s_waitcnt lgkmcnt(7)
  v_smfmac_f32_16x16x64_bf16 v[120:123], v[32:35], a[96:103], v15
  v_smfmac_f32_16x16x64_bf16 v[124:127], v[32:35], a[224:231], v15
  s_waitcnt lgkmcnt(6)
  v_smfmac_f32_16x16x64_bf16 v[120:123], v[36:39], a[104:111], v15
  v_smfmac_f32_16x16x64_bf16 v[124:127], v[36:39], a[232:239], v15
  s_waitcnt lgkmcnt(5)
  v_smfmac_f32_16x16x64_bf16 v[120:123], v[40:43], a[112:119], v15
  v_smfmac_f32_16x16x64_bf16 v[124:127], v[40:43], a[240:247], v15
  s_waitcnt lgkmcnt(4)
  v_smfmac_f32_16x16x64_bf16 v[120:123], v[44:47], a[120:127], v15
  v_smfmac_f32_16x16x64_bf16 v[124:127], v[44:47], a[248:255], v15
  s_cmp_eq_u32 s51, 63
  s_nop 6
  v_permlane32_swap_b32 v120, v124
  v_permlane32_swap_b32 v121, v125
  v_permlane32_swap_b32 v122, v126
  v_permlane32_swap_b32 v123, v127
  v_pk_add_f32 v[120:121], v[120:121], v[124:125]
  v_pk_add_f32 v[122:123], v[122:123], v[126:127]
  v_cvt_pk_bf16_f32 v120, v120, v121
  v_cvt_pk_bf16_f32 v121, v122, v123
  ds_write_b64 v7, v[120:121]
  s_cbranch_scc1 Lslow_last
  s_cmp_eq_u32 s50, 1
  s_cbranch_scc1 Lslow_p1_111
  s_cmp_eq_u32 s50, 2
  s_cbranch_scc1 Lslow_p2_112
  s_waitcnt lgkmcnt(0)
  s_barrier
  ds_read_b64_tr_b16 v[120:121], v8 offset:0
  ds_read_b64_tr_b16 v[122:123], v8 offset:128
  ds_read_b64_tr_b16 v[124:125], v8 offset:256
  ds_read_b64_tr_b16 v[126:127], v8 offset:384
  s_waitcnt lgkmcnt(2)
  v_mfma_f32_16x16x32_bf16 v[88:91], v[104:107], v[120:123], 0
  s_waitcnt lgkmcnt(0)
  v_mfma_f32_16x16x32_bf16 v[88:91], v[108:111], v[124:127], v[88:91]
  v_mfma_f32_16x16x32_bf16 v[92:95], v[112:115], v[120:123], 0
  v_mfma_f32_16x16x32_bf16 v[96:99], v[120:123], v[120:123], 0
  s_mov_b64 exec, s[70:71]
  v_min_u32 v88, -2, v88
  buffer_store_dwordx4 v[88:91], v10, s[32:35], s56 offen offset:0 sc1
  s_mov_b64 exec, -1
  v_mfma_f32_16x16x32_bf16 v[92:95], v[116:119], v[124:127], v[92:95]
  v_mfma_f32_16x16x32_bf16 v[96:99], v[124:127], v[124:127], v[96:99]
Lslow_pd_113:
  ds_read_b128 v[104:107], v3 offset:0
  ds_read_b128 v[108:111], v3 offset:1024
  ds_read_b128 v[112:115], v3 offset:2048
  ds_read_b128 v[116:119], v3 offset:3072
  v_smfmac_f32_16x16x64_bf16 v[100:103], v[32:35], v[224:231], v15
  v_smfmac_f32_16x16x64_bf16 v[100:103], v[36:39], v[232:239], v15
  v_smfmac_f32_16x16x64_bf16 v[100:103], v[40:43], v[240:247], v15
  v_mov_b32_dpp v88, v92 row_ror:8 row_mask:0xf bank_mask:0xc
  v_mov_b32_dpp v89, v93 row_ror:8 row_mask:0xf bank_mask:0xc
  v_smfmac_f32_16x16x64_bf16 v[100:103], v[44:47], v[248:255], v15
  v_mov_b32_dpp v90, v94 row_ror:8 row_mask:0xf bank_mask:0xc
  v_mov_b32_dpp v91, v95 row_ror:8 row_mask:0xf bank_mask:0xc
  v_smfmac_f32_16x16x64_bf16 v[100:103], v[48:51], v[192:199], v15
  v_mov_b32_dpp v96, v98 row_ror:8 row_mask:0xf bank_mask:0xc
  v_mov_b32_dpp v97, v99 row_ror:8 row_mask:0xf bank_mask:0xc
  v_smfmac_f32_16x16x64_bf16 v[100:103], v[52:55], v[200:207], v15
  v_mov_b32 v68, 0xff800000
  v_mov_b32 v40, 0x3f803f80
  v_smfmac_f32_16x16x64_bf16 v[100:103], v[56:59], v[208:215], v15
  v_cndmask_b32 v96, v96, v68, s[54:55]
  v_cndmask_b32 v97, v97, v68, s[54:55]
  v_smfmac_f32_16x16x64_bf16 v[100:103], v[60:63], v[216:223], v15
  v_mov_b32 v41, 0x3f803f80
  v_mov_b32 v42, 0x3f803f80
  v_smfmac_f32_16x16x64_bf16 v[100:103], v[72:75], v[128:135], v15
  buffer_load_dwordx4 v[32:35], v10, s[32:35], s57 offen sc1
  buffer_load_dwordx2 v[36:37], v14, s[32:35], s57 offen offset:1024 sc1
  v_smfmac_f32_16x16x64_bf16 v[100:103], v[76:79], v[136:143], v15
  v_smfmac_f32_16x16x64_bf16 v[100:103], v[80:83], v[144:151], v15
  v_mov_b32 v43, 0x3f803f80
  v_smfmac_f32_16x16x64_bf16 v[100:103], v[84:87], v[152:159], v15
  s_waitcnt lgkmcnt(0)
  v_smfmac_f32_16x16x64_bf16 v[100:103], v[104:107], v[160:167], v15
  v_smfmac_f32_16x16x64_bf16 v[100:103], v[108:111], v[168:175], v15
  buffer_load_dwordx4 v[48:51], v10, s[32:35], s57 offen sc1
  buffer_load_dwordx2 v[52:53], v14, s[32:35], s57 offen offset:1024 sc1
  v_smfmac_f32_16x16x64_bf16 v[100:103], v[112:115], v[176:183], v15
  v_smfmac_f32_16x16x64_bf16 v[100:103], v[116:119], v[184:191], v15
  s_nop 7
  v_mov_b32 v64, v100
  v_mov_b32 v65, v101
  v_mov_b32 v66, v102
  v_mov_b32 v67, v103
  s_nop 0
  v_permlane32_swap_b32 v100, v64
  v_permlane32_swap_b32 v101, v65
  v_permlane32_swap_b32 v102, v66
  v_permlane32_swap_b32_e64 v103, v67
  v_pk_add_f32 v[64:65], v[64:65], v[100:101]
  v_pk_add_f32 v[66:67], v[66:67], v[102:103]
  v_cvt_pk_bf16_f32 v18, v64, v65
  v_cvt_pk_bf16_f32 v19, v66, v67
  s_waitcnt vmcnt(2)
  v_max_u32 v0, v32, v36
  v_cmp_eq_u32 vcc, -1, v0
  s_cbranch_vccnz Lslow_sb_115
  v_pk_add_f32 v[88:89], v[88:89], v[32:33]
  v_pk_add_f32 v[90:91], v[90:91], v[34:35]
  v_pk_add_f32 v[96:97], v[96:97], v[36:37]
Lslow_sok_117:
  v_max3_f32 v38, v88, v89, v90
  v_max3_f32 v39, v91, v96, v97
  v_max_f32 v38, v38, v39
  s_nop 1
  v_max_f32_dpp v38, v38, v38 row_ror:8 row_mask:0xf bank_mask:0xf
  v_mov_b32 v39, v38
  s_nop 1
  v_permlane32_swap_b32 v38, v39
  v_max_f32 v38, v38, v39
  v_mov_b32 v39, v38
  s_nop 1
  v_permlane16_swap_b32 v38, v39
  v_max_f32 v38, v38, v39
  v_mul_f32_e64 v38, s74, v38
  v_fma_f32 v88, v88, s74, -v38
  v_fma_f32 v89, v89, s74, -v38
  v_exp_f32 v88, v88
  v_exp_f32 v89, v89
  v_fma_f32 v90, v90, s74, -v38
  v_fma_f32 v91, v91, s74, -v38
  v_exp_f32 v90, v90
  v_exp_f32 v91, v91
  v_cvt_pk_bf16_f32 v64, v88, v89
  v_fma_f32 v96, v96, s74, -v38
  v_cvt_pk_bf16_f32 v65, v90, v91
  v_fma_f32 v97, v97, s74, -v38
  v_exp_f32_e64 v96, v96
  v_mov_b32_dpp v66, v64 row_ror:8 row_mask:0xf bank_mask:0xf
  v_mov_b32_dpp v67, v65 row_ror:8 row_mask:0xf bank_mask:0xf
  v_exp_f32 v97, v97
  s_nop 0
  v_mfma_f32_16x16x32_bf16 v[120:123], v[40:43], v[64:67], 0
  v_cvt_pk_bf16_f32 v68, v96, v97
  v_mfma_f32_16x16x32_bf16 v[124:127], v[28:31], v[64:67], 0
  s_nop 0
  v_mov_b32_dpp v69, v68 row_ror:8 row_mask:0xf bank_mask:0xf
  s_nop 1
  v_mfma_f32_16x16x16_bf16 v[120:123], v[40:41], v[68:69], v[120:123]
  v_mfma_f32_16x16x16_bf16 v[124:127], v[18:19], v[68:69], v[124:127]
  s_mov_b64 exec, s[70:71]
  s_nop 3
  v_rcp_f32 v0, v120
  s_nop 1
  v_pk_mul_f32 v[124:125], v[124:125], v[0:1] op_sel_hi:[1,0]
  v_pk_mul_f32 v[126:127], v[126:127], v[0:1] op_sel_hi:[1,0]
  v_cvt_pk_bf16_f32 v120, v124, v125
  v_cvt_pk_bf16_f32 v121, v126, v127
  v_min_u32 v120, -2, v120
  buffer_store_dwordx2 v[120:121], v12, s[32:35], s58 offen sc1
  s_mov_b64 exec, -1
  s_cmp_eq_u32 s50, 3
  s_cbranch_scc0 Lslow_w3e_114
  v_mov_b32 v124, -1
  v_mov_b32 v125, -1
  v_mov_b32 v126, -1
  v_mov_b32 v127, -1
  buffer_store_dwordx4 v[124:127], v10, s[32:35], s61 offen sc1
Lslow_w3e_114:
  ds_read_b128 v[72:75], v13 offset:0
  ds_read_b128 v[76:79], v13 offset:1024
  ds_read_b128 v[80:83], v13 offset:2048
  ds_read_b128 v[84:87], v13 offset:3072
  ds_read_b128 v[104:107], v13 offset:4096
  ds_read_b128 v[108:111], v13 offset:5120
  ds_read_b128 v[112:115], v13 offset:6144
  ds_read_b128 v[116:119], v13 offset:7168
  ds_read_b128 v[88:91], v13 offset:8192
  ds_read_b128 v[92:95], v13 offset:9216
  ds_read_b128 v[96:99], v13 offset:10240
  ds_read_b128 v[100:103], v13 offset:11264
  v_mov_b32 v64, 0
  v_mov_b32 v65, 0
  v_mov_b32 v66, 0
  v_mov_b32 v67, 0
  v_mov_b32 v68, 0
  v_mov_b32 v69, 0
  v_mov_b32 v70, 0
  v_mov_b32 v71, 0
  s_xor_b32 s57, s57, 131072
  s_xor_b32 s61, s61, 65536
  s_xor_b32 s80, s80, 0x8000
  s_add_u32 s44, s44, 0x8000
  s_xor_b32 s81, s81, 0x8000
  s_add_u32 s45, s45, 0x8000
  s_xor_b32 s82, s82, 0x8000
  s_add_u32 s46, s46, 0x8000
  s_xor_b32 s83, s83, 0x8000
  s_add_u32 s47, s47, 0x8000
  s_lshl_b32 s75, s50, 10
  v_add_u32_e64 v122, s75, v9
  s_waitcnt vmcnt(0)
  buffer_load_dwordx4 v[32:35], v10, s[32:35], s59 offen offset:0 sc1
  buffer_load_dwordx4 v[36:39], v10, s[32:35], s59 offen offset:1024 sc1
  s_barrier
  buffer_load_dwordx4 v[40:43], v10, s[32:35], s59 offen offset:2048 sc1
  buffer_load_dwordx4 v[44:47], v10, s[32:35], s59 offen offset:3072 sc1
Lslow_chk_118:
  s_waitcnt vmcnt(2)
  v_max3_u32 v0, v32, v34, v36
  v_max_u32 v0, v0, v38
  v_cmp_eq_u32 vcc, -1, v0
  buffer_load_dwordx4 v[48:51], v10, s[32:35], s60 offen offset:0 sc1
  buffer_load_dwordx4 v[52:55], v10, s[32:35], s60 offen offset:1024 sc1
  s_cbranch_vccnz Lslow_bad_119
  s_waitcnt lgkmcnt(8)
  v_smfmac_f32_16x16x64_bf16 v[64:67], v[32:35], v[72:79], v15
  ds_read_b128 v[72:75], v13 offset:12288
  ds_read_b128 v[76:79], v13 offset:13312
  v_smfmac_f32_16x16x64_bf16 v[68:71], v[32:35], v[80:87], v15
  ds_read_b128 v[80:83], v13 offset:14336
  ds_read_b128 v[84:87], v13 offset:15360
  s_waitcnt lgkmcnt(8)
  v_smfmac_f32_16x16x64_bf16 v[64:67], v[36:39], v[104:111], v15
  ds_read_b128 v[104:107], v13 offset:16384
  ds_read_b128 v[108:111], v13 offset:17408
  v_smfmac_f32_16x16x64_bf16 v[68:71], v[36:39], v[112:119], v15
  ds_read_b128 v[112:115], v13 offset:18432
  ds_read_b128 v[116:119], v13 offset:19456
Lslow_chk_120:
  s_waitcnt vmcnt(2)
  v_max3_u32 v0, v40, v42, v44
  v_max_u32 v0, v0, v46
  v_cmp_eq_u32 vcc, -1, v0
  buffer_load_dwordx4 v[56:59], v10, s[32:35], s60 offen offset:2048 sc1
  buffer_load_dwordx4 v[60:63], v10, s[32:35], s60 offen offset:3072 sc1
  s_cbranch_vccnz Lslow_bad_121
  s_waitcnt lgkmcnt(8)
  v_smfmac_f32_16x16x64_bf16 v[64:67], v[40:43], v[88:95], v15
  ds_read_b128 v[88:91], v13 offset:20480
  ds_read_b128 v[92:95], v13 offset:21504
  v_smfmac_f32_16x16x64_bf16 v[68:71], v[40:43], v[96:103], v15
  ds_read_b128 v[96:99], v13 offset:22528
  ds_read_b128 v[100:103], v13 offset:23552
  s_waitcnt lgkmcnt(8)
  v_smfmac_f32_16x16x64_bf16 v[64:67], v[44:47], v[72:79], v15
  ds_read_b128 v[72:75], v13 offset:24576
  ds_read_b128 v[76:79], v13 offset:25600
  v_smfmac_f32_16x16x64_bf16 v[68:71], v[44:47], v[80:87], v15
  ds_read_b128 v[80:83], v13 offset:26624
  ds_read_b128 v[84:87], v13 offset:27648
Lslow_chk_122:
  s_waitcnt vmcnt(2)
  v_max3_u32 v0, v48, v50, v52
  v_max_u32 v0, v0, v54
  v_cmp_eq_u32 vcc, -1, v0
  s_cbranch_vccnz Lslow_bad_123
  s_waitcnt lgkmcnt(8)
  v_smfmac_f32_16x16x64_bf16 v[64:67], v[48:51], v[104:111], v15
  ds_read_b128 v[104:107], v13 offset:28672
  ds_read_b128 v[108:111], v13 offset:29696
  v_smfmac_f32_16x16x64_bf16 v[68:71], v[48:51], v[112:119], v15
  ds_read_b128 v[112:115], v13 offset:30720
  ds_read_b128 v[116:119], v13 offset:31744
  s_waitcnt lgkmcnt(8)
  v_smfmac_f32_16x16x64_bf16 v[64:67], v[52:55], v[88:95], v15
  v_smfmac_f32_16x16x64_bf16 v[68:71], v[52:55], v[96:103], v15
Lslow_chk_124:
  s_waitcnt vmcnt(0)
  v_max3_u32 v0, v56, v58, v60
  v_max_u32 v0, v0, v62
  v_cmp_eq_u32 vcc, -1, v0
  s_cbranch_vccnz Lslow_bad_125
  s_waitcnt lgkmcnt(4)
  v_smfmac_f32_16x16x64_bf16 v[64:67], v[56:59], v[72:79], v15
  v_smfmac_f32_16x16x64_bf16 v[68:71], v[56:59], v[80:87], v15
  s_waitcnt lgkmcnt(0)
  v_smfmac_f32_16x16x64_bf16 v[64:67], v[60:63], v[104:111], v15
  v_smfmac_f32_16x16x64_bf16 v[68:71], v[60:63], v[112:119], v15
  s_cmp_lg_u32 s50, 0
  s_nop 6
  v_permlane32_swap_b32 v64, v68
  v_permlane32_swap_b32 v65, v69
  v_permlane32_swap_b32 v66, v70
  v_permlane32_swap_b32_e64 v67, v71
  v_pk_add_f32 v[64:65], v[64:65], v[68:69]
  v_pk_add_f32 v[66:67], v[66:67], v[70:71]
  ds_write_b128 v122, v[64:67]
  s_waitcnt lgkmcnt(0)
  s_barrier
  s_cbranch_scc1 Lslow_oth_126
  ds_read_b128 v[36:39], v9 offset:1024
  ds_read_b128 v[40:43], v9 offset:2048
  ds_read_b128 v[44:47], v9 offset:3072
  s_waitcnt lgkmcnt(2)
  v_pk_add_f32 v[64:65], v[64:65], v[36:37]
  v_pk_add_f32 v[66:67], v[66:67], v[38:39]
  s_waitcnt lgkmcnt(1)
  v_pk_add_f32 v[64:65], v[64:65], v[40:41]
  v_pk_add_f32 v[66:67], v[66:67], v[42:43]
  s_waitcnt lgkmcnt(0)
  v_pk_add_f32 v[64:65], v[64:65], v[44:45]
  v_pk_add_f32 v[66:67], v[66:67], v[46:47]
  v_cvt_pk_bf16_f32 v64, v64, v65
  v_cvt_pk_bf16_f32 v65, v66, v67
  v_min_u32_e64 v64, -2, v64
  buffer_store_dwordx2 v[64:65], v6, s[32:35], s41 offen sc1
  buffer_store_dwordx2 v[64:65], v6, s[32:35], s40 offen sc1
  s_add_u32 s75, s51, 2
  s_min_u32 s75, s75, 63
  s_and_b32 s75, s75, 0x38
  s_lshl_b32 s75, s75, 1
  s_andn2_b32 s67, s67, 0x70
  s_or_b32 s67, s67, s75
  buffer_load_dword v16, v17, s[32:35], s67 offen sc1
  s_cmp_lt_u32 s50, 2
  s_cbranch_scc1 Lslow_km_128
  s_and_b32 s75, s50, 1
  s_lshl_b32 s75, s75, 8
  v_add_u32 v0, s75, v8
  ds_read_b64_tr_b16 v[88:89], v0
  ds_read_b64_tr_b16 v[90:91], v0 offset:128
  s_waitcnt lgkmcnt(0)
  s_mov_b64 exec, s[72:73]
  buffer_store_dwordx4 v[88:91], v11, s[32:35], s64 offen sc1
Lslow_km_128:
  s_mov_b32 exec_lo, 0
  s_mov_b32 exec_hi, -1
  v_lshrrev_b32 v0, 1, v10
  buffer_store_dwordx2 v[18:19], v0, s[32:35], s65 offen sc1
  s_mov_b64 exec, -1
  v_mov_b32 v120, 0
  v_mov_b32 v121, 0
  v_mov_b32 v122, 0
  v_mov_b32 v123, 0
  v_mov_b32 v124, 0
  v_mov_b32 v125, 0
  v_mov_b32 v126, 0
  v_mov_b32 v127, 0
  v_mov_b32 v64, v20
  v_mov_b32 v28, v24
  v_mov_b32 v65, v21
  v_mov_b32 v29, v25
  v_mov_b32 v66, v22
  v_mov_b32 v30, v26
  v_mov_b32 v67, v23
  v_mov_b32 v31, v27
  v_permlane32_swap_b32 v120, v64
  v_permlane32_swap_b32 v121, v65
  v_permlane32_swap_b32 v122, v66
  v_permlane32_swap_b32_e64 v123, v67
  s_branch Lslow_join
Lslow_last:
  s_waitcnt lgkmcnt(0)
  s_barrier
  ds_read_b64_tr_b16 v[120:121], v8 offset:0
  ds_read_b64_tr_b16 v[122:123], v8 offset:128
  ds_read_b64_tr_b16 v[124:125], v8 offset:256
  ds_read_b64_tr_b16 v[126:127], v8 offset:384
  s_cmp_lg_u32 s50, 1
  s_cbranch_scc1 Lslow_l2
  v_mov_b32 v0, 0
  v_mov_b32 v92, 63
  s_mov_b64 exec, 1
  buffer_store_dword v92, v0, s[32:35], s68 offen sc1
  s_mov_b64 exec, -1
Lslow_l2:
  ds_read_b128 v[104:107], v3 offset:0
  ds_read_b128 v[108:111], v3 offset:1024
  ds_read_b128 v[112:115], v3 offset:2048
  ds_read_b128 v[116:119], v3 offset:3072
  v_smfmac_f32_16x16x64_bf16 v[100:103], v[32:35], v[224:231], v15
  v_smfmac_f32_16x16x64_bf16 v[100:103], v[36:39], v[232:239], v15
  v_smfmac_f32_16x16x64_bf16 v[100:103], v[40:43], v[240:247], v15
  v_smfmac_f32_16x16x64_bf16 v[100:103], v[44:47], v[248:255], v15
  v_smfmac_f32_16x16x64_bf16 v[100:103], v[48:51], v[192:199], v15
  v_smfmac_f32_16x16x64_bf16 v[100:103], v[52:55], v[200:207], v15
  v_smfmac_f32_16x16x64_bf16 v[100:103], v[56:59], v[208:215], v15
  v_smfmac_f32_16x16x64_bf16 v[100:103], v[60:63], v[216:223], v15
  v_smfmac_f32_16x16x64_bf16 v[100:103], v[72:75], v[128:135], v15
  v_smfmac_f32_16x16x64_bf16 v[100:103], v[76:79], v[136:143], v15
  v_smfmac_f32_16x16x64_bf16 v[100:103], v[80:83], v[144:151], v15
  v_smfmac_f32_16x16x64_bf16 v[100:103], v[84:87], v[152:159], v15
  s_waitcnt lgkmcnt(0)
  v_smfmac_f32_16x16x64_bf16 v[100:103], v[104:107], v[160:167], v15
  v_smfmac_f32_16x16x64_bf16 v[100:103], v[108:111], v[168:175], v15
  v_smfmac_f32_16x16x64_bf16 v[100:103], v[112:115], v[176:183], v15
  v_smfmac_f32_16x16x64_bf16 v[100:103], v[116:119], v[184:191], v15
  s_nop 7
  v_mov_b32 v64, v100
  v_mov_b32 v65, v101
  v_mov_b32 v66, v102
  v_mov_b32 v67, v103
  s_nop 0
  v_permlane32_swap_b32 v100, v64
  v_permlane32_swap_b32 v101, v65
  v_permlane32_swap_b32 v102, v66
  v_permlane32_swap_b32_e64 v103, v67
  v_pk_add_f32 v[64:65], v[64:65], v[100:101]
  v_pk_add_f32 v[66:67], v[66:67], v[102:103]
  v_cvt_pk_bf16_f32 v18, v64, v65
  v_cvt_pk_bf16_f32 v19, v66, v67
  s_cmp_lt_u32 s50, 2
  s_cbranch_scc1 Lslow_km_133
  s_and_b32 s75, s50, 1
  s_lshl_b32 s75, s75, 8
  v_add_u32_e64 v0, s75, v8
  ds_read_b64_tr_b16 v[88:89], v0
  ds_read_b64_tr_b16 v[90:91], v0 offset:128
  s_waitcnt lgkmcnt(0)
  s_mov_b64 exec, s[72:73]
  buffer_store_dwordx4 v[88:91], v11, s[32:35], s64 offen sc1
Lslow_km_133:
  s_mov_b32 exec_lo, 0
  s_mov_b32 exec_hi, -1
  v_lshrrev_b32 v0, 1, v10
  buffer_store_dwordx2 v[18:19], v0, s[32:35], s65 offen sc1
  s_mov_b64 exec, -1
  v_mov_b32 v0, 0
  v_mov_b32 v92, 64
  s_waitcnt vmcnt(0)
  s_barrier
  s_mov_b64 exec, 1
  s_cmp_lg_u32 s50, 1
  s_cbranch_scc1 Lslow_fin
  buffer_store_dword v92, v0, s[32:35], s68 offen sc1
Lslow_fin:
  s_endpgm
Lslow_enter:
  s_waitcnt vmcnt(0)
  v_mov_b32 v120, 0
  v_mov_b32 v121, 0
  v_mov_b32 v122, 0
  v_mov_b32 v123, 0
  v_mov_b32 v124, 0
  v_mov_b32 v125, 0
  v_mov_b32 v126, 0
  v_mov_b32 v127, 0
  v_mov_b32 v64, v20
  v_mov_b32 v28, v24
  v_mov_b32 v65, v21
  v_mov_b32 v29, v25
  v_mov_b32 v66, v22
  v_mov_b32 v30, v26
  v_mov_b32 v67, v23
  v_mov_b32 v31, v27
  v_permlane32_swap_b32 v120, v64
  v_permlane32_swap_b32 v121, v65
  v_permlane32_swap_b32 v122, v66
  v_permlane32_swap_b32 v123, v67
  s_branch Lslow_step
Lslow_fb_99:
Lslow_fa_101:
  buffer_load_dword v16, v17, s[32:35], s67 offen sc1
  s_waitcnt vmcnt(0)
  v_cmp_ne_u32 vcc, 1, v16
  s_cbranch_vccz Lslow_fo_100
  s_sub_u32 s69, s69, 1
  s_cbranch_scc0 Lslow_fa_101
  s_endpgm
Lslow_bad_104:
  buffer_load_dwordx4 v[32:35], v10, s[32:35], s80 offen sc1
  buffer_load_dwordx4 v[36:39], v10, s[32:35], s81 offen sc1
  s_waitcnt vmcnt(0)
  s_sub_u32 s69, s69, 1
  s_cbranch_scc0 Lslow_chk_103
  s_endpgm
Lslow_bad_106:
  buffer_load_dwordx4 v[40:43], v10, s[32:35], s82 offen sc1
  buffer_load_dwordx4 v[44:47], v10, s[32:35], s83 offen sc1
  s_waitcnt vmcnt(0)
  s_sub_u32 s69, s69, 1
  s_cbranch_scc0 Lslow_chk_105
  s_endpgm
Lslow_bad_108:
  buffer_load_dwordx4 v[48:51], v10, s[32:35], s44 offen sc1
  buffer_load_dwordx4 v[52:55], v10, s[32:35], s45 offen sc1
  buffer_load_dwordx4 v[56:59], v10, s[32:35], s46 offen sc1
  buffer_load_dwordx4 v[60:63], v10, s[32:35], s47 offen sc1
  s_sub_u32 s69, s69, 1
  s_cbranch_scc0 Lslow_chk_107
  s_endpgm
Lslow_bad_110:
  buffer_load_dwordx4 v[56:59], v10, s[32:35], s46 offen sc1
  buffer_load_dwordx4 v[60:63], v10, s[32:35], s47 offen sc1
  s_sub_u32 s69, s69, 1
  s_cbranch_scc0 Lslow_chk_109
  s_endpgm
Lslow_p1_111:
  s_waitcnt lgkmcnt(0)
  s_barrier
  ds_read_b64_tr_b16 v[120:121], v8 offset:0
  ds_read_b64_tr_b16 v[122:123], v8 offset:128
  ds_read_b64_tr_b16 v[124:125], v8 offset:256
  ds_read_b64_tr_b16 v[126:127], v8 offset:384
  s_waitcnt lgkmcnt(2)
  v_mfma_f32_16x16x32_bf16 v[92:95], v[112:115], v[120:123], 0
  s_waitcnt lgkmcnt(0)
  v_mfma_f32_16x16x32_bf16 v[92:95], v[116:119], v[124:127], v[92:95]
  v_mfma_f32_16x16x32_bf16 v[88:91], v[104:107], v[120:123], 0
  v_mfma_f32_16x16x32_bf16 v[96:99], v[120:123], v[120:123], 0
  s_mov_b64 exec, s[70:71]
  v_min_u32 v92, -2, v92
  buffer_store_dwordx4 v[92:95], v10, s[32:35], s56 offen offset:128 sc1
  s_mov_b64 exec, -1
  v_mfma_f32_16x16x32_bf16 v[88:91], v[108:111], v[124:127], v[88:91]
  v_mfma_f32_16x16x32_bf16 v[96:99], v[124:127], v[124:127], v[96:99]
  s_branch Lslow_pd_113
Lslow_p2_112:
  s_waitcnt lgkmcnt(0)
  s_barrier
  ds_read_b64_tr_b16 v[120:121], v8 offset:0
  ds_read_b64_tr_b16 v[122:123], v8 offset:128
  ds_read_b64_tr_b16 v[124:125], v8 offset:256
  ds_read_b64_tr_b16 v[126:127], v8 offset:384
  s_waitcnt lgkmcnt(2)
  v_mfma_f32_16x16x32_bf16 v[96:99], v[120:123], v[120:123], 0
  s_waitcnt lgkmcnt(0)
  v_mfma_f32_16x16x32_bf16 v[96:99], v[124:127], v[124:127], v[96:99]
  v_mfma_f32_16x16x32_bf16 v[88:91], v[104:107], v[120:123], 0
  v_mfma_f32_16x16x32_bf16 v[92:95], v[112:115], v[120:123], 0
  s_mov_b64 exec, s[70:71]
  v_min_u32 v96, -2, v96
  v_min_u32 v98, -2, v98
  buffer_store_dwordx4 v[96:99], v11, s[32:35], s56 offen offset:1024 sc1
  s_mov_b64 exec, -1
  v_mfma_f32_16x16x32_bf16 v[88:91], v[108:111], v[124:127], v[88:91]
  v_mfma_f32_16x16x32_bf16 v[92:95], v[116:119], v[124:127], v[92:95]
  s_branch Lslow_pd_113
Lslow_sb_115:
  s_waitcnt vmcnt(0)
  v_max_u32 v0, v48, v52
  v_cmp_eq_u32_e64 vcc, -1, v0
  s_cbranch_vccnz Lslow_sb_116
  v_pk_add_f32 v[88:89], v[88:89], v[48:49]
  v_pk_add_f32 v[90:91], v[90:91], v[50:51]
  v_pk_add_f32 v[96:97], v[96:97], v[52:53]
  s_branch Lslow_sok_117
Lslow_sb_116:
  buffer_load_dwordx4 v[48:51], v10, s[32:35], s57 offen sc1
  buffer_load_dwordx2 v[52:53], v14, s[32:35], s57 offen offset:1024 sc1
  s_sub_u32 s69, s69, 1
  s_cbranch_scc0 Lslow_sb_115
  s_endpgm
Lslow_bad_119:
  buffer_load_dwordx4 v[32:35], v10, s[32:35], s59 offen offset:0 sc1
  buffer_load_dwordx4 v[36:39], v10, s[32:35], s59 offen offset:1024 sc1
  buffer_load_dwordx4 v[40:43], v10, s[32:35], s59 offen offset:2048 sc1
  buffer_load_dwordx4 v[44:47], v10, s[32:35], s59 offen offset:3072 sc1
  s_sub_u32 s69, s69, 1
  s_cbranch_scc0 Lslow_chk_118
  s_endpgm
Lslow_bad_121:
  buffer_load_dwordx4 v[40:43], v10, s[32:35], s59 offen offset:2048 sc1
  buffer_load_dwordx4 v[44:47], v10, s[32:35], s59 offen offset:3072 sc1
  buffer_load_dwordx4 v[48:51], v10, s[32:35], s60 offen offset:0 sc1
  buffer_load_dwordx4 v[52:55], v10, s[32:35], s60 offen offset:1024 sc1
  s_sub_u32 s69, s69, 1
  s_cbranch_scc0 Lslow_chk_120
  s_endpgm
Lslow_bad_123:
  buffer_load_dwordx4 v[48:51], v10, s[32:35], s60 offen offset:0 sc1
  buffer_load_dwordx4 v[52:55], v10, s[32:35], s60 offen offset:1024 sc1
  buffer_load_dwordx4 v[56:59], v10, s[32:35], s60 offen offset:2048 sc1
  buffer_load_dwordx4 v[60:63], v10, s[32:35], s60 offen offset:3072 sc1
  s_sub_u32 s69, s69, 1
  s_cbranch_scc0 Lslow_chk_122
  s_endpgm
Lslow_bad_125:
  buffer_load_dwordx4 v[56:59], v10, s[32:35], s60 offen offset:2048 sc1
  buffer_load_dwordx4 v[60:63], v10, s[32:35], s60 offen offset:3072 sc1
  s_sub_u32 s69, s69, 1
  s_cbranch_scc0 Lslow_chk_124
  s_endpgm
Lslow_oth_126:
  s_cmp_lg_u32 s50, 1
  s_cbranch_scc1 Lslow_w1_129
  v_mov_b32 v88, -1
  v_mov_b32 v89, -1
  v_mov_b32 v90, -1
  v_mov_b32 v91, -1
  s_xor_b32 s75, s41, 32768
  buffer_store_dwordx4 v[88:91], v10, s[32:35], s56 offen sc1
  buffer_store_dwordx4 v[88:91], v10, s[32:35], s56 offen offset:1024 sc1
  buffer_store_dwordx2 v[88:89], v6, s[32:35], s75 offen sc1
Lslow_w1_129:
  s_add_u32 s75, s51, 2
  s_min_u32 s75, s75, 63
  s_and_b32 s75, s75, 0x38
  s_lshl_b32 s75, s75, 1
  s_andn2_b32 s67, s67, 0x70
  s_or_b32 s67, s67, s75
  buffer_load_dword v16, v17, s[32:35], s67 offen sc1
  s_cmp_lt_u32 s50, 2
  s_cbranch_scc1 Lslow_km_130
  s_and_b32 s75, s50, 1
  s_lshl_b32 s75, s75, 8
  v_add_u32 v0, s75, v8
  ds_read_b64_tr_b16 v[88:89], v0
  ds_read_b64_tr_b16 v[90:91], v0 offset:128
  s_waitcnt lgkmcnt(0)
  s_mov_b64 exec, s[72:73]
  buffer_store_dwordx4 v[88:91], v11, s[32:35], s64 offen sc1
Lslow_km_130:
  s_mov_b32 exec_lo, 0
  s_mov_b32 exec_hi, -1
  v_lshrrev_b32 v0, 1, v10
  buffer_store_dwordx2 v[18:19], v0, s[32:35], s65 offen sc1
  s_mov_b64 exec, -1
  s_cmp_lg_u32 s50, 1
  s_cbranch_scc1 Lslow_nc_131
  s_cmp_gt_u32 s51, 58
  s_cbranch_scc1 Lslow_nc_131
  s_add_u32 s75, s40, 131072
  buffer_store_dwordx2 v[88:89], v6, s[32:35], s75 offen sc1
Lslow_nc_131:
  s_cmp_lg_u32 s50, 1
  s_cbranch_scc1 Lslow_nb_132
  v_mov_b32 v92, s51
  v_mov_b32 v0, 0
  s_mov_b64 exec, 1
  buffer_store_dword v92, v0, s[32:35], s68 offen sc1
  s_mov_b64 exec, -1
Lslow_nb_132:
  v_mov_b32 v120, 0
  v_mov_b32 v121, 0
  v_mov_b32 v122, 0
  v_mov_b32 v123, 0
  v_mov_b32 v124, 0
  v_mov_b32 v125, 0
  v_mov_b32 v126, 0
  v_mov_b32 v127, 0
  v_mov_b32 v64, v20
  v_mov_b32 v28, v24
  v_mov_b32 v65, v21
  v_mov_b32 v29, v25
  v_mov_b32 v66, v22
  v_mov_b32 v30, v26
  v_mov_b32 v67, v23
  v_mov_b32 v31, v27
  v_permlane32_swap_b32 v120, v64
  v_permlane32_swap_b32 v121, v65
  v_permlane32_swap_b32 v122, v66
  v_permlane32_swap_b32 v123, v67
  s_branch Lslow_join2
Lbulk:
  s_and_b32 s48, s2, 7
  s_sub_u32 s48, s48, 2
  s_lshr_b32 s49, s2, 3
  v_lshrrev_b32 v1, 6, v0
  v_and_b32 v0, 63, v0
  v_readfirstlane_b32 s50, v1
  s_lshl_b32 s95, s48, 5
  s_add_u32 s95, s95, s49
  s_mov_b32 s69, 131072
  s_mov_b32 s76, 0
  s_mov_b32 s96, 49152
  s_cmp_lg_u32 s50, 0
  s_cbranch_scc1 Lb_arr
  s_cmp_eq_u32 s1, 8
  s_cbranch_scc1 Lb_arr
  s_and_b32 s71, s1, 3
  s_lshl_b32 s71, s71, 4
  s_lshl_b64 s[72:73], 1, s71
  s_lshr_b32 s71, s1, 2
  s_lshl_b32 s71, s71, 3
  v_mov_b32 v24, s72
  v_mov_b32 v25, s73
  v_mov_b32 v26, s71
  s_mov_b64 exec, 1
  global_atomic_add_x2 v26, v[24:25], s[28:29] sc1
  s_mov_b64 exec, -1
Lb_arr:
  s_mov_b32 s36, s4
  s_and_b32 s37, s5, 0xffff
  s_mov_b32 s38, 4194304
  s_mov_b32 s39, 0x20000
  s_mov_b32 s40, s8
  s_and_b32 s41, s9, 0xffff
  s_mov_b32 s42, 8388608
  s_mov_b32 s43, 0x20000
  v_mov_b32 v2, 0
  v_mov_b32 v3, 0
  v_mov_b32 v4, 0
  v_mov_b32 v5, 0
  v_mov_b32 v6, 0
  v_mov_b32 v7, 0
  v_mov_b32 v8, 0
  v_mov_b32 v9, 0
  v_mov_b32 v10, 0
  v_mov_b32 v11, 0
  v_mov_b32 v12, 0
  v_mov_b32 v13, 0
  v_mov_b32 v14, 0
  v_mov_b32 v15, 0
  s_getpc_b64 s[52:53]
Lpc0:
  s_lshl_b32 s66, s95, 6
  s_add_u32 s66, s66, Ltasks-Lpc0
  s_add_u32 s52, s52, s66
  s_addc_u32 s53, s53, 0
  v_lshlrev_b32 v1, 4, v0
  s_lshl_b32 s80, s50, 10
  s_add_u32 s80, s80, 147456
  s_lshl_b32 s66, s95, 2
  s_add_u32 s66, s66, s50
  s_lshl_b32 s78, s66, 10
  s_mov_b32 s79, 786432
  s_sub_u32 s78, s78, s79
  s_mov_b32 s44, s20
  s_and_b32 s45, s21, 0xffff
  s_mov_b32 s46, 7340032
  s_mov_b32 s47, 0x20000
  s_lshl_b32 s63, s50, 13
  s_lshl_b32 s64, s50, 12
  s_add_u32 s64, s64, 32768
  s_mul_i32 s66, s95, 0x5556
  s_lshr_b32 s66, s66, 16
  s_mul_i32 s67, s66, 3
  s_sub_u32 s67, s95, s67
  s_cmp_lg_u32 s67, 2
  s_cbranch_scc1 Lpref_done
  s_lshl_b32 s66, s66, 2
  s_add_u32 s66, s66, s50
  s_lshl_b32 s66, s66, 10
  s_add_u32 s66, s66, 384
  v_and_b32 v16, 31, v0
  v_lshlrev_b32 v16, 18, v16
  s_mov_b32 s36, s10
  s_and_b32 s37, s11, 0xffff
  s_mov_b32 s38, 8388608
  s_mov_b32 s39, 0x20000
  buffer_load_dword a0, v16, s[36:39], s66 offen
  s_mov_b32 s36, s12
  s_and_b32 s37, s13, 0xffff
  s_mov_b32 s38, 8388608
  s_mov_b32 s39, 0x20000
  buffer_load_dword a0, v16, s[36:39], s66 offen
  s_mov_b32 s36, s14
  s_and_b32 s37, s15, 0xffff
  s_mov_b32 s38, 8388608
  s_mov_b32 s39, 0x20000
  buffer_load_dword a0, v16, s[36:39], s66 offen
  s_mul_i32 s67, s95, 0x5556
  s_lshr_b32 s67, s67, 16
  s_cmp_ge_u32 s67, 16
  s_cbranch_scc1 Lpref_done
  s_cmp_lg_u32 s50, 0
  s_cbranch_scc1 Lpref_done
  s_cmp_eq_u32 s1, 8
  s_cbranch_scc1 Lpref_done
  v_mov_b32 v16, 0
  s_mov_b64 exec, 1
  s_mov_b32 s86, -1
  s_mov_b32 s87, -1
  s_lshl_b32 s66, s67, 14
  s_add_u32 s66, s66, 142639104
  s_memtime s[82:83]
  s_waitcnt lgkmcnt(0)
  buffer_store_dword v16, v16, s[32:35], s66 offen sc1
  s_waitcnt vmcnt(0)
  s_memtime s[84:85]
  s_waitcnt lgkmcnt(0)
  s_sub_u32 s84, s84, s82
  s_min_u32 s86, s86, s84
  s_xor_b32 s66, s66, 0x2000
  s_memtime s[82:83]
  s_waitcnt lgkmcnt(0)
  buffer_store_dword v16, v16, s[32:35], s66 offen sc1
  s_waitcnt vmcnt(0)
  s_memtime s[84:85]
  s_waitcnt lgkmcnt(0)
  s_sub_u32 s84, s84, s82
  s_min_u32 s87, s87, s84
  s_xor_b32 s66, s66, 0x2000
  s_add_u32 s66, s66, 0x280
  s_memtime s[82:83]
  s_waitcnt lgkmcnt(0)
  buffer_store_dword v16, v16, s[32:35], s66 offen sc1
  s_waitcnt vmcnt(0)
  s_memtime s[84:85]
  s_waitcnt lgkmcnt(0)
  s_sub_u32 s84, s84, s82
  s_min_u32 s86, s86, s84
  s_xor_b32 s66, s66, 0x2000
  s_memtime s[82:83]
  s_waitcnt lgkmcnt(0)
  buffer_store_dword v16, v16, s[32:35], s66 offen sc1
  s_waitcnt vmcnt(0)
  s_memtime s[84:85]
  s_waitcnt lgkmcnt(0)
  s_sub_u32 s84, s84, s82
  s_min_u32 s87, s87, s84
  s_xor_b32 s66, s66, 0x2000
  s_add_u32 s66, s66, 0x280
  s_memtime s[82:83]
  s_waitcnt lgkmcnt(0)
  buffer_store_dword v16, v16, s[32:35], s66 offen sc1
  s_waitcnt vmcnt(0)
  s_memtime s[84:85]
  s_waitcnt lgkmcnt(0)
  s_sub_u32 s84, s84, s82
  s_min_u32 s86, s86, s84
  s_xor_b32 s66, s66, 0x2000
  s_memtime s[82:83]
  s_waitcnt lgkmcnt(0)
  buffer_store_dword v16, v16, s[32:35], s66 offen sc1
  s_waitcnt vmcnt(0)
  s_memtime s[84:85]
  s_waitcnt lgkmcnt(0)
  s_sub_u32 s84, s84, s82
  s_min_u32 s87, s87, s84
  s_xor_b32 s66, s66, 0x2000
  s_add_u32 s66, s66, 0x280
  s_memtime s[82:83]
  s_waitcnt lgkmcnt(0)
  buffer_store_dword v16, v16, s[32:35], s66 offen sc1
  s_waitcnt vmcnt(0)
  s_memtime s[84:85]
  s_waitcnt lgkmcnt(0)
  s_sub_u32 s84, s84, s82
  s_min_u32 s86, s86, s84
  s_xor_b32 s66, s66, 0x2000
  s_memtime s[82:83]
  s_waitcnt lgkmcnt(0)
  buffer_store_dword v16, v16, s[32:35], s66 offen sc1
  s_waitcnt vmcnt(0)
  s_memtime s[84:85]
  s_waitcnt lgkmcnt(0)
  s_sub_u32 s84, s84, s82
  s_min_u32 s87, s87, s84
  s_xor_b32 s66, s66, 0x2000
  s_add_u32 s66, s66, 0x280
  s_cmp_lt_u32 s87, s86
  s_cselect_b32 s66, 1, 0
  s_add_u32 s66, s66, 0x100
  v_mov_b32 v17, s66
  global_atomic_add v16, v17, s[28:29] offset:24 sc1
  s_mov_b64 exec, -1
Lpref_done:
  s_mul_i32 s66, s95, 0x5556
  s_lshr_b32 s66, s66, 16
  s_mul_i32 s67, s66, 3
  s_sub_u32 s67, s95, s67
  s_cmp_eq_u32 s67, 2
  s_cbranch_scc1 Lgate_done
  s_lshl_b32 s70, s66, 1
  s_add_u32 s70, s70, s67
  s_mov_b32 s36, s4
  s_and_b32 s37, s5, 0xffff
  s_mov_b32 s38, 4194304
  s_mov_b32 s39, 0x20000
  s_mov_b32 s40, s24
  s_and_b32 s41, s25, 0xffff
  s_mov_b32 s42, 2048
  s_mov_b32 s43, 0x20000
  s_lshl_b32 s66, s70, 2
  s_add_u32 s66, s66, s50
  s_lshl_b32 s67, s66, 13
  s_add_u32 s68, s67, 4096
  buffer_load_dwordx4 v[32:35], v1, s[40:43], 0 offen
  buffer_load_dwordx4 v[36:39], v1, s[40:43], 0 offen offset:1024
  buffer_load_dwordx4 v[64:67], v1, s[36:39], s67 offen offset:0
  buffer_load_dwordx4 v[68:71], v1, s[36:39], s67 offen offset:1024
  buffer_load_dwordx4 v[72:75], v1, s[36:39], s67 offen offset:2048
  buffer_load_dwordx4 v[76:79], v1, s[36:39], s67 offen offset:3072
  buffer_load_dwordx4 v[80:83], v1, s[36:39], s68 offen offset:0
  buffer_load_dwordx4 v[84:87], v1, s[36:39], s68 offen offset:1024
  buffer_load_dwordx4 v[88:91], v1, s[36:39], s68 offen offset:2048
  buffer_load_dwordx4 v[92:95], v1, s[36:39], s68 offen offset:3072
  s_waitcnt vmcnt(8)
  v_lshlrev_b32 v40, 16, v32
  v_and_b32 v41, 0xffff0000, v32
  v_lshlrev_b32 v42, 16, v33
  v_and_b32 v43, 0xffff0000, v33
  v_lshlrev_b32 v44, 16, v34
  v_and_b32 v45, 0xffff0000, v34
  v_lshlrev_b32 v46, 16, v35
  v_and_b32 v47, 0xffff0000, v35
  v_lshlrev_b32 v48, 16, v36
  v_and_b32 v49, 0xffff0000, v36
  v_lshlrev_b32 v50, 16, v37
  v_and_b32 v51, 0xffff0000, v37
  v_lshlrev_b32 v52, 16, v38
  v_and_b32 v53, 0xffff0000, v38
  v_lshlrev_b32 v54, 16, v39
  v_and_b32 v55, 0xffff0000, v39
  s_waitcnt vmcnt(0)
  v_mov_b32 v24, 0
  v_lshlrev_b32 v16, 16, v64
  v_and_b32 v17, 0xffff0000, v64
  v_mul_f32 v16, v16, v40
  v_mul_f32 v17, v17, v41
  v_cvt_pk_bf16_f32 v16, v16, v17
  v_and_b32 v17, 0xffff0000, v16
  v_lshlrev_b32 v16, 16, v16
  v_add_f32 v24, v24, v17
  v_add_f32 v24, v24, v16
  v_lshlrev_b32 v16, 16, v65
  v_and_b32 v17, 0xffff0000, v65
  v_mul_f32 v16, v16, v42
  v_mul_f32 v17, v17, v43
  v_cvt_pk_bf16_f32 v16, v16, v17
  v_and_b32 v17, 0xffff0000, v16
  v_lshlrev_b32 v16, 16, v16
  v_add_f32 v24, v24, v17
  v_add_f32 v24, v24, v16
  v_lshlrev_b32 v16, 16, v66
  v_and_b32 v17, 0xffff0000, v66
  v_mul_f32 v16, v16, v44
  v_mul_f32 v17, v17, v45
  v_cvt_pk_bf16_f32 v16, v16, v17
  v_and_b32 v17, 0xffff0000, v16
  v_lshlrev_b32 v16, 16, v16
  v_add_f32 v24, v24, v17
  v_add_f32 v24, v24, v16
  v_lshlrev_b32 v16, 16, v67
  v_and_b32 v17, 0xffff0000, v67
  v_mul_f32 v16, v16, v46
  v_mul_f32 v17, v17, v47
  v_cvt_pk_bf16_f32 v16, v16, v17
  v_and_b32 v17, 0xffff0000, v16
  v_lshlrev_b32 v16, 16, v16
  v_add_f32 v24, v24, v17
  v_add_f32 v24, v24, v16
  v_lshlrev_b32 v16, 16, v68
  v_and_b32 v17, 0xffff0000, v68
  v_mul_f32 v16, v16, v48
  v_mul_f32 v17, v17, v49
  v_cvt_pk_bf16_f32 v16, v16, v17
  v_and_b32 v17, 0xffff0000, v16
  v_lshlrev_b32 v16, 16, v16
  v_add_f32 v24, v24, v17
  v_add_f32 v24, v24, v16
  v_lshlrev_b32 v16, 16, v69
  v_and_b32 v17, 0xffff0000, v69
  v_mul_f32 v16, v16, v50
  v_mul_f32 v17, v17, v51
  v_cvt_pk_bf16_f32 v16, v16, v17
  v_and_b32 v17, 0xffff0000, v16
  v_lshlrev_b32 v16, 16, v16
  v_add_f32 v24, v24, v17
  v_add_f32 v24, v24, v16
  v_lshlrev_b32 v16, 16, v70
  v_and_b32 v17, 0xffff0000, v70
  v_mul_f32 v16, v16, v52
  v_mul_f32 v17, v17, v53
  v_cvt_pk_bf16_f32 v16, v16, v17
  v_and_b32 v17, 0xffff0000, v16
  v_lshlrev_b32 v16, 16, v16
  v_add_f32 v24, v24, v17
  v_add_f32 v24, v24, v16
  v_lshlrev_b32 v16, 16, v71
  v_and_b32 v17, 0xffff0000, v71
  v_mul_f32 v16, v16, v54
  v_mul_f32 v17, v17, v55
  v_cvt_pk_bf16_f32 v16, v16, v17
  v_and_b32 v17, 0xffff0000, v16
  v_lshlrev_b32 v16, 16, v16
  v_add_f32 v24, v24, v17
  v_add_f32 v24, v24, v16
  v_mov_b32 v25, 0
  v_lshlrev_b32 v16, 16, v72
  v_and_b32 v17, 0xffff0000, v72
  v_mul_f32 v16, v16, v40
  v_mul_f32 v17, v17, v41
  v_cvt_pk_bf16_f32 v16, v16, v17
  v_and_b32 v17, 0xffff0000, v16
  v_lshlrev_b32 v16, 16, v16
  v_add_f32 v25, v25, v17
  v_add_f32 v25, v25, v16
  v_lshlrev_b32 v16, 16, v73
  v_and_b32 v17, 0xffff0000, v73
  v_mul_f32 v16, v16, v42
  v_mul_f32 v17, v17, v43
  v_cvt_pk_bf16_f32 v16, v16, v17
  v_and_b32 v17, 0xffff0000, v16
  v_lshlrev_b32 v16, 16, v16
  v_add_f32 v25, v25, v17
  v_add_f32 v25, v25, v16
  v_lshlrev_b32 v16, 16, v74
  v_and_b32 v17, 0xffff0000, v74
  v_mul_f32 v16, v16, v44
  v_mul_f32 v17, v17, v45
  v_cvt_pk_bf16_f32 v16, v16, v17
  v_and_b32 v17, 0xffff0000, v16
  v_lshlrev_b32 v16, 16, v16
  v_add_f32 v25, v25, v17
  v_add_f32 v25, v25, v16
  v_lshlrev_b32 v16, 16, v75
  v_and_b32 v17, 0xffff0000, v75
  v_mul_f32 v16, v16, v46
  v_mul_f32 v17, v17, v47
  v_cvt_pk_bf16_f32 v16, v16, v17
  v_and_b32 v17, 0xffff0000, v16
  v_lshlrev_b32 v16, 16, v16
  v_add_f32 v25, v25, v17
  v_add_f32 v25, v25, v16
  v_lshlrev_b32 v16, 16, v76
  v_and_b32 v17, 0xffff0000, v76
  v_mul_f32 v16, v16, v48
  v_mul_f32 v17, v17, v49
  v_cvt_pk_bf16_f32 v16, v16, v17
  v_and_b32 v17, 0xffff0000, v16
  v_lshlrev_b32 v16, 16, v16
  v_add_f32 v25, v25, v17
  v_add_f32 v25, v25, v16
  v_lshlrev_b32 v16, 16, v77
  v_and_b32 v17, 0xffff0000, v77
  v_mul_f32 v16, v16, v50
  v_mul_f32 v17, v17, v51
  v_cvt_pk_bf16_f32 v16, v16, v17
  v_and_b32 v17, 0xffff0000, v16
  v_lshlrev_b32 v16, 16, v16
  v_add_f32 v25, v25, v17
  v_add_f32 v25, v25, v16
  v_lshlrev_b32 v16, 16, v78
  v_and_b32 v17, 0xffff0000, v78
  v_mul_f32 v16, v16, v52
  v_mul_f32 v17, v17, v53
  v_cvt_pk_bf16_f32 v16, v16, v17
  v_and_b32 v17, 0xffff0000, v16
  v_lshlrev_b32 v16, 16, v16
  v_add_f32 v25, v25, v17
  v_add_f32 v25, v25, v16
  v_lshlrev_b32 v16, 16, v79
  v_and_b32 v17, 0xffff0000, v79
  v_mul_f32 v16, v16, v54
  v_mul_f32 v17, v17, v55
  v_cvt_pk_bf16_f32 v16, v16, v17
  v_and_b32 v17, 0xffff0000, v16
  v_lshlrev_b32 v16, 16, v16
  v_add_f32 v25, v25, v17
  v_add_f32 v25, v25, v16
  v_mov_b32 v26, 0
  v_lshlrev_b32 v16, 16, v80
  v_and_b32 v17, 0xffff0000, v80
  v_mul_f32 v16, v16, v40
  v_mul_f32 v17, v17, v41
  v_cvt_pk_bf16_f32 v16, v16, v17
  v_and_b32 v17, 0xffff0000, v16
  v_lshlrev_b32 v16, 16, v16
  v_add_f32 v26, v26, v17
  v_add_f32 v26, v26, v16
  v_lshlrev_b32 v16, 16, v81
  v_and_b32 v17, 0xffff0000, v81
  v_mul_f32 v16, v16, v42
  v_mul_f32 v17, v17, v43
  v_cvt_pk_bf16_f32 v16, v16, v17
  v_and_b32 v17, 0xffff0000, v16
  v_lshlrev_b32 v16, 16, v16
  v_add_f32 v26, v26, v17
  v_add_f32 v26, v26, v16
  v_lshlrev_b32 v16, 16, v82
  v_and_b32 v17, 0xffff0000, v82
  v_mul_f32 v16, v16, v44
  v_mul_f32 v17, v17, v45
  v_cvt_pk_bf16_f32 v16, v16, v17
  v_and_b32 v17, 0xffff0000, v16
  v_lshlrev_b32 v16, 16, v16
  v_add_f32 v26, v26, v17
  v_add_f32 v26, v26, v16
  v_lshlrev_b32 v16, 16, v83
  v_and_b32 v17, 0xffff0000, v83
  v_mul_f32 v16, v16, v46
  v_mul_f32 v17, v17, v47
  v_cvt_pk_bf16_f32 v16, v16, v17
  v_and_b32 v17, 0xffff0000, v16
  v_lshlrev_b32 v16, 16, v16
  v_add_f32 v26, v26, v17
  v_add_f32 v26, v26, v16
  v_lshlrev_b32 v16, 16, v84
  v_and_b32 v17, 0xffff0000, v84
  v_mul_f32 v16, v16, v48
  v_mul_f32 v17, v17, v49
  v_cvt_pk_bf16_f32 v16, v16, v17
  v_and_b32 v17, 0xffff0000, v16
  v_lshlrev_b32 v16, 16, v16
  v_add_f32 v26, v26, v17
  v_add_f32 v26, v26, v16
  v_lshlrev_b32 v16, 16, v85
  v_and_b32 v17, 0xffff0000, v85
  v_mul_f32 v16, v16, v50
  v_mul_f32 v17, v17, v51
  v_cvt_pk_bf16_f32 v16, v16, v17
  v_and_b32 v17, 0xffff0000, v16
  v_lshlrev_b32 v16, 16, v16
  v_add_f32 v26, v26, v17
  v_add_f32 v26, v26, v16
  v_lshlrev_b32 v16, 16, v86
  v_and_b32 v17, 0xffff0000, v86
  v_mul_f32 v16, v16, v52
  v_mul_f32 v17, v17, v53
  v_cvt_pk_bf16_f32 v16, v16, v17
  v_and_b32 v17, 0xffff0000, v16
  v_lshlrev_b32 v16, 16, v16
  v_add_f32 v26, v26, v17
  v_add_f32 v26, v26, v16
  v_lshlrev_b32 v16, 16, v87
  v_and_b32 v17, 0xffff0000, v87
  v_mul_f32 v16, v16, v54
  v_mul_f32 v17, v17, v55
  v_cvt_pk_bf16_f32 v16, v16, v17
  v_and_b32 v17, 0xffff0000, v16
  v_lshlrev_b32 v16, 16, v16
  v_add_f32 v26, v26, v17
  v_add_f32 v26, v26, v16
  v_mov_b32 v27, 0
  v_lshlrev_b32 v16, 16, v88
  v_and_b32 v17, 0xffff0000, v88
  v_mul_f32 v16, v16, v40
  v_mul_f32 v17, v17, v41
  v_cvt_pk_bf16_f32 v16, v16, v17
  v_and_b32 v17, 0xffff0000, v16
  v_lshlrev_b32 v16, 16, v16
  v_add_f32 v27, v27, v17
  v_add_f32 v27, v27, v16
  v_lshlrev_b32 v16, 16, v89
  v_and_b32 v17, 0xffff0000, v89
  v_mul_f32 v16, v16, v42
  v_mul_f32 v17, v17, v43
  v_cvt_pk_bf16_f32 v16, v16, v17
  v_and_b32 v17, 0xffff0000, v16
  v_lshlrev_b32 v16, 16, v16
  v_add_f32 v27, v27, v17
  v_add_f32 v27, v27, v16
  v_lshlrev_b32 v16, 16, v90
  v_and_b32 v17, 0xffff0000, v90
  v_mul_f32 v16, v16, v44
  v_mul_f32 v17, v17, v45
  v_cvt_pk_bf16_f32 v16, v16, v17
  v_and_b32 v17, 0xffff0000, v16
  v_lshlrev_b32 v16, 16, v16
  v_add_f32 v27, v27, v17
  v_add_f32 v27, v27, v16
  v_lshlrev_b32 v16, 16, v91
  v_and_b32 v17, 0xffff0000, v91
  v_mul_f32 v16, v16, v46
  v_mul_f32 v17, v17, v47
  v_cvt_pk_bf16_f32 v16, v16, v17
  v_and_b32 v17, 0xffff0000, v16
  v_lshlrev_b32 v16, 16, v16
  v_add_f32 v27, v27, v17
  v_add_f32 v27, v27, v16
  v_lshlrev_b32 v16, 16, v92
  v_and_b32 v17, 0xffff0000, v92
  v_mul_f32 v16, v16, v48
  v_mul_f32 v17, v17, v49
  v_cvt_pk_bf16_f32 v16, v16, v17
  v_and_b32 v17, 0xffff0000, v16
  v_lshlrev_b32 v16, 16, v16
  v_add_f32 v27, v27, v17
  v_add_f32 v27, v27, v16
  v_lshlrev_b32 v16, 16, v93
  v_and_b32 v17, 0xffff0000, v93
  v_mul_f32 v16, v16, v50
  v_mul_f32 v17, v17, v51
  v_cvt_pk_bf16_f32 v16, v16, v17
  v_and_b32 v17, 0xffff0000, v16
  v_lshlrev_b32 v16, 16, v16
  v_add_f32 v27, v27, v17
  v_add_f32 v27, v27, v16
  v_lshlrev_b32 v16, 16, v94
  v_and_b32 v17, 0xffff0000, v94
  v_mul_f32 v16, v16, v52
  v_mul_f32 v17, v17, v53
  v_cvt_pk_bf16_f32 v16, v16, v17
  v_and_b32 v17, 0xffff0000, v16
  v_lshlrev_b32 v16, 16, v16
  v_add_f32 v27, v27, v17
  v_add_f32 v27, v27, v16
  v_lshlrev_b32 v16, 16, v95
  v_and_b32 v17, 0xffff0000, v95
  v_mul_f32 v16, v16, v54
  v_mul_f32 v17, v17, v55
  v_cvt_pk_bf16_f32 v16, v16, v17
  v_and_b32 v17, 0xffff0000, v16
  v_lshlrev_b32 v16, 16, v16
  v_add_f32 v27, v27, v17
  v_add_f32 v27, v27, v16
  s_nop 1
  v_add_f32_dpp v24, v24, v24 row_ror:1 row_mask:0xf bank_mask:0xf
  v_add_f32_dpp v25, v25, v25 row_ror:1 row_mask:0xf bank_mask:0xf
  v_add_f32_dpp v26, v26, v26 row_ror:1 row_mask:0xf bank_mask:0xf
  v_add_f32_dpp v27, v27, v27 row_ror:1 row_mask:0xf bank_mask:0xf
  s_nop 1
  v_add_f32_dpp v24, v24, v24 row_ror:2 row_mask:0xf bank_mask:0xf
  v_add_f32_dpp v25, v25, v25 row_ror:2 row_mask:0xf bank_mask:0xf
  v_add_f32_dpp v26, v26, v26 row_ror:2 row_mask:0xf bank_mask:0xf
  v_add_f32_dpp v27, v27, v27 row_ror:2 row_mask:0xf bank_mask:0xf
  s_nop 1
  v_add_f32_dpp v24, v24, v24 row_ror:4 row_mask:0xf bank_mask:0xf
  v_add_f32_dpp v25, v25, v25 row_ror:4 row_mask:0xf bank_mask:0xf
  v_add_f32_dpp v26, v26, v26 row_ror:4 row_mask:0xf bank_mask:0xf
  v_add_f32_dpp v27, v27, v27 row_ror:4 row_mask:0xf bank_mask:0xf
  s_nop 1
  v_add_f32_dpp v24, v24, v24 row_ror:8 row_mask:0xf bank_mask:0xf
  v_add_f32_dpp v25, v25, v25 row_ror:8 row_mask:0xf bank_mask:0xf
  v_add_f32_dpp v26, v26, v26 row_ror:8 row_mask:0xf bank_mask:0xf
  v_add_f32_dpp v27, v27, v27 row_ror:8 row_mask:0xf bank_mask:0xf
  v_mov_b32 v56, v24
  v_mov_b32 v57, v25
  v_mov_b32 v58, v26
  v_mov_b32 v59, v27
  s_nop 1
  v_permlane16_swap_b32 v24, v56
  v_permlane16_swap_b32 v25, v57
  v_permlane16_swap_b32 v26, v58
  v_permlane16_swap_b32 v27, v59
  v_add_f32 v24, v24, v56
  v_add_f32 v25, v25, v57
  v_add_f32 v26, v26, v58
  v_add_f32 v27, v27, v59
  v_mov_b32 v56, v24
  v_mov_b32 v57, v25
  v_mov_b32 v58, v26
  v_mov_b32 v59, v27
  s_nop 1
  v_permlane32_swap_b32 v24, v56
  v_permlane32_swap_b32 v25, v57
  v_permlane32_swap_b32 v26, v58
  v_permlane32_swap_b32 v27, v59
  v_add_f32 v24, v24, v56
  v_add_f32 v25, v25, v57
  v_add_f32 v26, v26, v58
  v_add_f32 v27, v27, v59
  v_cvt_pk_bf16_f32 v16, v24, v24
  v_lshlrev_b32 v16, 16, v16
  v_mul_f32 v16, 0xbfb8aa3b, v16
  v_exp_f32 v16, v16
  s_nop 0
  v_add_f32 v16, 1.0, v16
  v_rcp_f32 v16, v16
  s_nop 0
  v_cvt_pk_bf16_f32 v16, v16, v16
  v_lshlrev_b32 v24, 16, v16
  v_cvt_pk_bf16_f32 v16, v25, v25
  v_lshlrev_b32 v16, 16, v16
  v_mul_f32 v16, 0xbfb8aa3b, v16
  v_exp_f32 v16, v16
  s_nop 0
  v_add_f32 v16, 1.0, v16
  v_rcp_f32 v16, v16
  s_nop 0
  v_cvt_pk_bf16_f32 v16, v16, v16
  v_lshlrev_b32 v25, 16, v16
  v_cvt_pk_bf16_f32 v16, v26, v26
  v_lshlrev_b32 v16, 16, v16
  v_mul_f32 v16, 0xbfb8aa3b, v16
  v_exp_f32 v16, v16
  s_nop 0
  v_add_f32 v16, 1.0, v16
  v_rcp_f32 v16, v16
  s_nop 0
  v_cvt_pk_bf16_f32 v16, v16, v16
  v_lshlrev_b32 v26, 16, v16
  v_cvt_pk_bf16_f32 v16, v27, v27
  v_lshlrev_b32 v16, 16, v16
  v_mul_f32 v16, 0xbfb8aa3b, v16
  v_exp_f32 v16, v16
  s_nop 0
  v_add_f32 v16, 1.0, v16
  v_rcp_f32 v16, v16
  s_nop 0
  v_cvt_pk_bf16_f32 v16, v16, v16
  v_lshlrev_b32 v27, 16, v16
  s_lshl_b32 s66, s66, 4
  s_add_u32 s66, s66, 99024896
  v_mov_b32 v16, 0
  s_mov_b64 exec, 1
  buffer_store_dwordx4 v[24:27], v16, s[32:35], s66 offen sc1
  s_mov_b64 exec, -1
Lgate_done:
  s_mov_b32 s82, 0
  s_mov_b32 s51, 0
Lnext:
  s_mov_b32 s93, 0
  s_load_dword s54, s[52:53], 0
  s_add_u32 s52, s52, 4
  s_addc_u32 s53, s53, 0
  s_waitcnt lgkmcnt(0)
  s_bfe_u32 s55, s54, 0x40004
  s_bfe_u32 s56, s54, 0x80008
  s_bfe_u32 s81, s54, 0x80010
  s_lshr_b32 s92, s54, 24
  s_and_b32 s54, s54, 15
  s_cmp_eq_u32 s82, 0
  s_cbranch_scc1 Lsetup
  s_cmp_eq_u32 s54, 0
  s_cbranch_scc1 Lepi
  s_cmp_ge_u32 s54, 5
  s_cbranch_scc1 Lepi
  s_cmp_lg_u32 s85, 0
  s_cbranch_scc1 Lepi
Lsetup:
  s_cmp_eq_u32 s54, 0
  s_cbranch_scc1 Lphase_a_done
  s_cmp_eq_u32 s54, 6
  s_cbranch_scc1 Ltask_wo
  s_cmp_eq_u32 s54, 7
  s_cbranch_scc1 Ltask_sig
  s_lshl_b32 s63, s50, 13
  s_lshr_b32 s63, s63, s92
  s_mov_b32 s75, 0
  s_mov_b32 s65, 0
  s_lshr_b32 s67, s50, 1
  s_and_b32 s68, s50, 1
  v_lshrrev_b32 v16, 4, v0
  v_bfe_u32 v17, v0, 2, 2
  v_lshl_add_u32 v18, v16, 3, v17
  v_lshlrev_b32 v18, 8, v18
  v_and_b32 v19, 3, v0
  v_lshl_add_u32 v18, v19, 3, v18
  v_and_b32 v19, 1, v16
  v_xor_b32 v19, s68, v19
  v_lshl_add_u32 v19, v19, 2, v17
  v_lshl_add_u32 v18, v19, 5, v18
  v_add_u32 v12, 32768, v18
  v_xor_b32 v13, 32, v12
  v_xor_b32 v14, 64, v12
  v_xor_b32 v15, 96, v12
  s_cmp_eq_u32 s54, 5
  s_cbranch_scc1 Lsetup_b
  s_mov_b32 s36, s4
  s_and_b32 s37, s5, 0xffff
  s_mov_b32 s38, 4194304
  s_mov_b32 s39, 0x20000
  s_mov_b32 s57, 16
  s_mov_b32 s61, 128
  s_lshl_b32 s58, s55, 19
  s_lshl_b32 s66, s50, 17
  s_add_u32 s58, s58, s66
  s_lshr_b32 s58, s58, s92
  s_add_u32 s59, s58, 65536
  v_lshrrev_b32 v20, 3, v0
  v_and_b32 v21, 7, v0
  v_xor_b32 v21, v21, v20
  v_lshlrev_b32 v21, 4, v21
  v_lshl_add_u32 v2, v20, 11, v21
  v_add_u32 v3, 15360, v2
  v_add_u32 v4, 30720, v2
  v_add_u32 v5, 46080, v2
  v_and_b32 v20, 15, v0
  v_and_b32 v21, 7, v0
  v_xor_b32 v21, v21, v16
  v_lshlrev_b32 v21, 4, v21
  v_lshl_add_u32 v21, v20, 7, v21
  s_lshl_b32 s66, s67, 14
  s_lshr_b32 s66, s66, s92
  v_add_u32 v10, s66, v21
  v_xor_b32 v11, 64, v10
  s_mov_b32 s70, 8192
  s_cmp_eq_u32 s54, 4
  s_cbranch_scc1 Lsetup_h
  s_cmp_eq_u32 s54, 1
  s_cbranch_scc1 Lsetup_k
  s_cmp_eq_u32 s54, 2
  s_cbranch_scc1 Lsetup_v
  s_mov_b32 s40, s8
  s_and_b32 s41, s9, 0xffff
  s_mov_b32 s42, 8388608
  s_mov_b32 s43, 0x20000
  s_branch Lsetup_x
Lsetup_k:
  s_mov_b32 s40, s10
  s_and_b32 s41, s11, 0xffff
  s_mov_b32 s42, 8388608
  s_mov_b32 s43, 0x20000
  s_branch Lsetup_x
Lsetup_v:
  s_mov_b32 s40, s12
  s_and_b32 s41, s13, 0xffff
  s_mov_b32 s42, 8388608
  s_mov_b32 s43, 0x20000
  s_branch Lsetup_x
Lsetup_h:
  s_mov_b32 s40, s20
  s_and_b32 s41, s21, 0xffff
  s_mov_b32 s42, 7340032
  s_mov_b32 s43, 0x20000
  s_mov_b32 s70, 7168
Lsetup_x:
  s_lshl_b32 s62, s70, 6
  s_lshl_b32 s66, s50, 4
  s_mul_i32 s60, s66, s70
  s_lshl_b32 s71, s70, 2
  s_lshl_b32 s72, s70, 3
  s_mov_b32 s73, 0x80
  s_branch Lsetup_go
Lsetup_b:
  s_cmp_lg_u32 s76, 0
  s_cbranch_scc1 Lini_134
  s_mov_b32 s76, 1
  v_mov_b32 v24, 0
Lrole_135:
  global_load_dwordx4 v[16:19], v24, s[28:29] sc1
  global_load_dwordx4 v[20:23], v24, s[28:29] offset:16 sc1
Lrole_135_c:
  s_waitcnt vmcnt(0)
  s_cmp_eq_u32 s1, 8
  s_cbranch_scc1 Lrole_136
  v_pk_add_u16 v25, v16, v17
  v_pk_add_u16 v25, v25, v18
  v_pk_add_u16 v25, v25, v19
  v_sad_u16 v25, v25, 0, 0
  v_cmp_ne_u32 vcc, 0x100, v25
  s_cbranch_vccnz Lrole_135_w
  v_bcnt_u32_b32 v25, v16, 0
  v_bcnt_u32_b32 v25, v17, v25
  v_bcnt_u32_b32 v25, v18, v25
  v_bcnt_u32_b32 v25, v19, v25
  v_cmp_ne_u32 vcc, 1, v25
  s_cbranch_vccnz Lrestart
  s_branch Lrole_137
Lrole_135_w:
  s_sub_u32 s69, s69, 1
  s_cbranch_scc0 Lrole_135
  s_endpgm
Lrole_136:
  s_mov_b32 s66, 0
  v_cmp_eq_u32 vcc, 64, v20
  s_cbranch_vccz Lrole_135_w
Lrole_137:
Lini_134:
  s_lshl_b32 s66, s55, 7
  s_add_u32 s66, s66, 99045376
  s_cmp_lg_u32 s50, 0
  s_cbranch_scc1 Lhw_139
  v_mov_b32 v16, 0
Lhw_138:
  buffer_load_dword v17, v16, s[32:35], s66 offen sc1
  s_waitcnt vmcnt(0)
  v_cmp_le_u32 vcc, 28, v17
  s_cbranch_vccnz Lhw_139
  s_sleep 2
  s_sub_u32 s69, s69, 1
  s_cbranch_scc0 Lhw_138
  s_endpgm
Lhw_139:
  s_barrier
  s_mov_b32 s36, s30
  s_and_b32 s37, s31, 0xffff
  s_mov_b32 s38, 268435456
  s_mov_b32 s39, 0x20000
  s_mov_b32 s40, s22
  s_and_b32 s41, s23, 0xffff
  s_mov_b32 s42, 7340032
  s_mov_b32 s43, 0x20000
  s_mov_b32 s57, 56
  s_mov_b32 s61, 32768
  s_mul_i32 s58, s55, 1835008
  s_lshl_b32 s66, s50, 13
  s_add_u32 s58, s58, s66
  s_add_u32 s58, s58, 50331648
  s_add_u32 s59, s58, 4096
  v_mov_b32 v2, v1
  v_mov_b32 v3, v1
  v_mov_b32 v4, v1
  v_mov_b32 v5, v1
  s_lshl_b32 s66, s67, 14
  v_add_u32 v10, s66, v1
  v_add_u32 v11, 1024, v10
  s_mov_b32 s70, 2048
  s_mov_b32 s62, 131072
  s_lshl_b32 s60, s67, 16
  s_lshl_b32 s66, s68, 14
  s_add_u32 s60, s60, s66
  s_mov_b32 s71, 32768
  s_mov_b32 s72, 8192
  s_mov_b32 s73, 0x80
  v_lshrrev_b32 v16, 4, v0
Lsetup_go:
  s_lshl_b32 s66, s56, 8
  s_add_u32 s60, s60, s66
  v_mul_lo_u32 v20, v16, s70
  v_and_b32 v21, 15, v0
  v_lshlrev_b32 v21, 4, v21
  v_lshlrev_b32 v22, 5, v16
  v_xor_b32 v21, v21, v22
  v_add_u32 v6, v20, v21
  s_sub_u32 s66, s71, 1024
  v_add_u32 v7, s66, v6
  v_xor_b32 v21, s73, v21
  v_add_u32 v20, v20, v21
  s_sub_u32 s66, s72, 2048
  v_add_u32 v8, s66, v20
  s_add_u32 s66, s71, s72
  s_sub_u32 s66, s66, 3072
  v_add_u32 v9, s66, v20
  s_mul_i32 s66, s81, s61
  s_add_u32 s58, s58, s66
  s_add_u32 s59, s59, s66
  s_mul_i32 s66, s81, s62
  s_add_u32 s60, s60, s66
  s_sub_u32 s81, s57, s81
  s_mul_i32 s88, s57, s61
  s_mul_i32 s89, s57, s62
  s_barrier
  s_mov_b32 s93, 1
  s_cmp_lg_u32 s92, 0
  s_cbranch_scc1 Lpro_half
  s_add_u32 m0, s63, s75
  s_nop 0
  buffer_load_dwordx4 v2, s[36:39], s58 offen offset:0 sc1 lds
  buffer_load_dwordx4 v3, s[36:39], s58 offen offset:1024 sc1 lds
  buffer_load_dwordx4 v4, s[36:39], s58 offen offset:2048 sc1 lds
  buffer_load_dwordx4 v5, s[36:39], s58 offen offset:3072 sc1 lds
  s_add_u32 m0, m0, 4096
  s_nop 0
  buffer_load_dwordx4 v2, s[36:39], s59 offen offset:0 sc1 lds
  buffer_load_dwordx4 v3, s[36:39], s59 offen offset:1024 sc1 lds
  buffer_load_dwordx4 v4, s[36:39], s59 offen offset:2048 sc1 lds
  buffer_load_dwordx4 v5, s[36:39], s59 offen offset:3072 sc1 lds
  s_add_u32 m0, s64, s75
  s_nop 0
  buffer_load_dwordx4 v6, s[40:43], s60 offen offset:0 lds
  buffer_load_dwordx4 v7, s[40:43], s60 offen offset:1024 lds
  buffer_load_dwordx4 v8, s[40:43], s60 offen offset:2048 lds
  buffer_load_dwordx4 v9, s[40:43], s60 offen offset:3072 lds
  s_add_u32 s58, s58, s61
  s_add_u32 s59, s59, s61
  s_add_u32 s60, s60, s62
  s_sub_u32 s81, s81, 1
  s_cmp_eq_u32 s81, 0
  s_cselect_b32 s90, s88, 0
  s_cselect_b32 s91, s89, 0
  s_sub_u32 s58, s58, s90
  s_sub_u32 s59, s59, s90
  s_sub_u32 s60, s60, s91
  s_add_u32 s75, s75, 49152
  s_cmp_eq_u32 s75, 147456
  s_cselect_b32 s75, 0, s75
  s_add_u32 m0, s63, s75
  s_nop 0
  buffer_load_dwordx4 v2, s[36:39], s58 offen offset:0 sc1 lds
  buffer_load_dwordx4 v3, s[36:39], s58 offen offset:1024 sc1 lds
  buffer_load_dwordx4 v4, s[36:39], s58 offen offset:2048 sc1 lds
  buffer_load_dwordx4 v5, s[36:39], s58 offen offset:3072 sc1 lds
  s_add_u32 m0, m0, 4096
  s_nop 0
  buffer_load_dwordx4 v2, s[36:39], s59 offen offset:0 sc1 lds
  buffer_load_dwordx4 v3, s[36:39], s59 offen offset:1024 sc1 lds
  buffer_load_dwordx4 v4, s[36:39], s59 offen offset:2048 sc1 lds
  buffer_load_dwordx4 v5, s[36:39], s59 offen offset:3072 sc1 lds
  s_add_u32 m0, s64, s75
  s_nop 0
  buffer_load_dwordx4 v6, s[40:43], s60 offen offset:0 lds
  buffer_load_dwordx4 v7, s[40:43], s60 offen offset:1024 lds
  buffer_load_dwordx4 v8, s[40:43], s60 offen offset:2048 lds
  buffer_load_dwordx4 v9, s[40:43], s60 offen offset:3072 lds
  s_add_u32 s58, s58, s61
  s_add_u32 s59, s59, s61
  s_add_u32 s60, s60, s62
  s_sub_u32 s81, s81, 1
  s_cmp_eq_u32 s81, 0
  s_cselect_b32 s90, s88, 0
  s_cselect_b32 s91, s89, 0
  s_sub_u32 s58, s58, s90
  s_sub_u32 s59, s59, s90
  s_sub_u32 s60, s60, s91
  s_add_u32 s75, s75, 49152
  s_cmp_eq_u32 s75, 147456
  s_cselect_b32 s75, 0, s75
  s_add_u32 m0, s63, s75
  s_nop 0
  buffer_load_dwordx4 v2, s[36:39], s58 offen offset:0 sc1 lds
  buffer_load_dwordx4 v3, s[36:39], s58 offen offset:1024 sc1 lds
  buffer_load_dwordx4 v4, s[36:39], s58 offen offset:2048 sc1 lds
  buffer_load_dwordx4 v5, s[36:39], s58 offen offset:3072 sc1 lds
  s_add_u32 m0, m0, 4096
  s_nop 0
  buffer_load_dwordx4 v2, s[36:39], s59 offen offset:0 sc1 lds
  buffer_load_dwordx4 v3, s[36:39], s59 offen offset:1024 sc1 lds
  buffer_load_dwordx4 v4, s[36:39], s59 offen offset:2048 sc1 lds
  buffer_load_dwordx4 v5, s[36:39], s59 offen offset:3072 sc1 lds
  s_add_u32 m0, s64, s75
  s_nop 0
  buffer_load_dwordx4 v6, s[40:43], s60 offen offset:0 lds
  buffer_load_dwordx4 v7, s[40:43], s60 offen offset:1024 lds
  buffer_load_dwordx4 v8, s[40:43], s60 offen offset:2048 lds
  buffer_load_dwordx4 v9, s[40:43], s60 offen offset:3072 lds
  s_add_u32 s58, s58, s61
  s_add_u32 s59, s59, s61
  s_add_u32 s60, s60, s62
  s_sub_u32 s81, s81, 1
  s_cmp_eq_u32 s81, 0
  s_cselect_b32 s90, s88, 0
  s_cselect_b32 s91, s89, 0
  s_sub_u32 s58, s58, s90
  s_sub_u32 s59, s59, s90
  s_sub_u32 s60, s60, s91
  s_add_u32 s75, s75, 49152
  s_cmp_eq_u32 s75, 147456
  s_cselect_b32 s75, 0, s75
  s_branch Lpro_done
Lpro_half:
  s_add_u32 m0, s63, s75
  s_nop 0
  buffer_load_dwordx4 v2, s[36:39], s58 offen offset:0 sc1 lds
  buffer_load_dwordx4 v3, s[36:39], s58 offen offset:1024 sc1 lds
  buffer_load_dwordx4 v4, s[36:39], s58 offen offset:2048 sc1 lds
  buffer_load_dwordx4 v5, s[36:39], s58 offen offset:3072 sc1 lds
  s_add_u32 m0, s64, s75
  s_nop 0
  buffer_load_dwordx4 v6, s[40:43], s60 offen offset:0 lds
  buffer_load_dwordx4 v7, s[40:43], s60 offen offset:1024 lds
  buffer_load_dwordx4 v8, s[40:43], s60 offen offset:2048 lds
  buffer_load_dwordx4 v9, s[40:43], s60 offen offset:3072 lds
  s_add_u32 s58, s58, s61
  s_add_u32 s59, s59, s61
  s_add_u32 s60, s60, s62
  s_sub_u32 s81, s81, 1
  s_cmp_eq_u32 s81, 0
  s_cselect_b32 s90, s88, 0
  s_cselect_b32 s91, s89, 0
  s_sub_u32 s58, s58, s90
  s_sub_u32 s59, s59, s90
  s_sub_u32 s60, s60, s91
  s_add_u32 s75, s75, 49152
  s_cmp_eq_u32 s75, 147456
  s_cselect_b32 s75, 0, s75
  s_add_u32 m0, s63, s75
  s_nop 0
  buffer_load_dwordx4 v2, s[36:39], s58 offen offset:0 sc1 lds
  buffer_load_dwordx4 v3, s[36:39], s58 offen offset:1024 sc1 lds
  buffer_load_dwordx4 v4, s[36:39], s58 offen offset:2048 sc1 lds
  buffer_load_dwordx4 v5, s[36:39], s58 offen offset:3072 sc1 lds
  s_add_u32 m0, s64, s75
  s_nop 0
  buffer_load_dwordx4 v6, s[40:43], s60 offen offset:0 lds
  buffer_load_dwordx4 v7, s[40:43], s60 offen offset:1024 lds
  buffer_load_dwordx4 v8, s[40:43], s60 offen offset:2048 lds
  buffer_load_dwordx4 v9, s[40:43], s60 offen offset:3072 lds
  s_add_u32 s58, s58, s61
  s_add_u32 s59, s59, s61
  s_add_u32 s60, s60, s62
  s_sub_u32 s81, s81, 1
  s_cmp_eq_u32 s81, 0
  s_cselect_b32 s90, s88, 0
  s_cselect_b32 s91, s89, 0
  s_sub_u32 s58, s58, s90
  s_sub_u32 s59, s59, s90
  s_sub_u32 s60, s60, s91
  s_add_u32 s75, s75, 49152
  s_cmp_eq_u32 s75, 147456
  s_cselect_b32 s75, 0, s75
  s_add_u32 m0, s63, s75
  s_nop 0
  buffer_load_dwordx4 v2, s[36:39], s58 offen offset:0 sc1 lds
  buffer_load_dwordx4 v3, s[36:39], s58 offen offset:1024 sc1 lds
  buffer_load_dwordx4 v4, s[36:39], s58 offen offset:2048 sc1 lds
  buffer_load_dwordx4 v5, s[36:39], s58 offen offset:3072 sc1 lds
  s_add_u32 m0, s64, s75
  s_nop 0
  buffer_load_dwordx4 v6, s[40:43], s60 offen offset:0 lds
  buffer_load_dwordx4 v7, s[40:43], s60 offen offset:1024 lds
  buffer_load_dwordx4 v8, s[40:43], s60 offen offset:2048 lds
  buffer_load_dwordx4 v9, s[40:43], s60 offen offset:3072 lds
  s_add_u32 s58, s58, s61
  s_add_u32 s59, s59, s61
  s_add_u32 s60, s60, s62
  s_sub_u32 s81, s81, 1
  s_cmp_eq_u32 s81, 0
  s_cselect_b32 s90, s88, 0
  s_cselect_b32 s91, s89, 0
  s_sub_u32 s58, s58, s90
  s_sub_u32 s59, s59, s90
  s_sub_u32 s60, s60, s91
  s_add_u32 s75, s75, 49152
  s_cmp_eq_u32 s75, 147456
  s_cselect_b32 s75, 0, s75
Lpro_done:
  s_cmp_lg_u32 s82, 0
  s_cbranch_scc1 Lepi
Lrun:
  s_mov_b32 s82, s54
  s_mov_b32 s83, s55
  s_mov_b32 s84, s56
  s_mov_b32 s85, s92
  s_cmp_lg_u32 s92, 0
  s_cbranch_scc1 Lgemm_half
  s_cmp_eq_u32 s54, 2
  s_cbranch_scc1 Lgemm_v
  s_waitcnt vmcnt(24)
  s_barrier
  ds_read_b64_tr_b16 v[64:65], v12 offset:0
  ds_read_b64_tr_b16 v[66:67], v12 offset:1024
  ds_read_b64_tr_b16 v[68:69], v13 offset:0
  ds_read_b64_tr_b16 v[70:71], v13 offset:1024
  ds_read_b64_tr_b16 v[72:73], v14 offset:0
  ds_read_b64_tr_b16 v[74:75], v14 offset:1024
  ds_read_b64_tr_b16 v[76:77], v15 offset:0
  ds_read_b64_tr_b16 v[78:79], v15 offset:1024
  ds_read_b128 v[32:35], v10 offset:0
  ds_read_b128 v[36:39], v10 offset:2048
  ds_read_b128 v[40:43], v10 offset:4096
  ds_read_b128 v[44:47], v10 offset:6144
  s_waitcnt lgkmcnt(8)
  ds_read_b128 v[48:51], v10 offset:8192
  ds_read_b128 v[52:55], v10 offset:10240
  ds_read_b128 v[56:59], v10 offset:12288
  ds_read_b128 v[60:63], v10 offset:14336
  s_waitcnt lgkmcnt(0)
  v_mfma_f32_16x16x32_bf16 v[128:131], v[64:67], v[32:35], 0
  ds_read_b64_tr_b16 v[112:113], v12 offset:8192
  v_mfma_f32_16x16x32_bf16 v[132:135], v[68:71], v[32:35], 0
  ds_read_b64_tr_b16 v[114:115], v12 offset:9216
  v_mfma_f32_16x16x32_bf16 v[136:139], v[72:75], v[32:35], 0
  ds_read_b64_tr_b16 v[116:117], v13 offset:8192
  v_mfma_f32_16x16x32_bf16 v[140:143], v[76:79], v[32:35], 0
  ds_read_b64_tr_b16 v[118:119], v13 offset:9216
  v_mfma_f32_16x16x32_bf16 v[144:147], v[64:67], v[36:39], 0
  ds_read_b64_tr_b16 v[120:121], v14 offset:8192
  v_mfma_f32_16x16x32_bf16 v[148:151], v[68:71], v[36:39], 0
  ds_read_b64_tr_b16 v[122:123], v14 offset:9216
  v_mfma_f32_16x16x32_bf16 v[152:155], v[72:75], v[36:39], 0
  ds_read_b64_tr_b16 v[124:125], v15 offset:8192
  v_mfma_f32_16x16x32_bf16 v[156:159], v[76:79], v[36:39], 0
  ds_read_b64_tr_b16 v[126:127], v15 offset:9216
  v_mfma_f32_16x16x32_bf16 v[160:163], v[64:67], v[40:43], 0
  ds_read_b128 v[80:83], v11 offset:0
  v_mfma_f32_16x16x32_bf16 v[164:167], v[68:71], v[40:43], 0
  ds_read_b128 v[84:87], v11 offset:2048
  v_mfma_f32_16x16x32_bf16 v[168:171], v[72:75], v[40:43], 0
  ds_read_b128 v[88:91], v11 offset:4096
  v_mfma_f32_16x16x32_bf16 v[172:175], v[76:79], v[40:43], 0
  ds_read_b128 v[92:95], v11 offset:6144
  v_mfma_f32_16x16x32_bf16 v[176:179], v[64:67], v[44:47], 0
  ds_read_b128 v[96:99], v11 offset:8192
  v_mfma_f32_16x16x32_bf16 v[180:183], v[68:71], v[44:47], 0
  ds_read_b128 v[100:103], v11 offset:10240
  v_mfma_f32_16x16x32_bf16 v[184:187], v[72:75], v[44:47], 0
  ds_read_b128 v[104:107], v11 offset:12288
  v_mfma_f32_16x16x32_bf16 v[188:191], v[76:79], v[44:47], 0
  ds_read_b128 v[108:111], v11 offset:14336
  v_mfma_f32_16x16x32_bf16 v[192:195], v[64:67], v[48:51], 0
  s_add_u32 s65, s65, 1
  s_cmp_eq_u32 s65, 3
  s_cselect_b32 s66, 4294868992, s96
  s_cselect_b32 s65, 0, s65
  v_mfma_f32_16x16x32_bf16 v[196:199], v[68:71], v[48:51], 0
  v_add_u32 v10, s66, v10
  v_mfma_f32_16x16x32_bf16 v[200:203], v[72:75], v[48:51], 0
  v_add_u32 v11, s66, v11
  v_mfma_f32_16x16x32_bf16 v[204:207], v[76:79], v[48:51], 0
  v_add_u32 v12, s66, v12
  v_mfma_f32_16x16x32_bf16 v[208:211], v[64:67], v[52:55], 0
  v_add_u32 v13, s66, v13
  v_mfma_f32_16x16x32_bf16 v[212:215], v[68:71], v[52:55], 0
  v_add_u32 v14, s66, v14
  v_mfma_f32_16x16x32_bf16 v[216:219], v[72:75], v[52:55], 0
  v_add_u32 v15, s66, v15
  v_mfma_f32_16x16x32_bf16 v[220:223], v[76:79], v[52:55], 0
  v_mfma_f32_16x16x32_bf16 v[224:227], v[64:67], v[56:59], 0
  v_mfma_f32_16x16x32_bf16 v[228:231], v[68:71], v[56:59], 0
  v_mfma_f32_16x16x32_bf16 v[232:235], v[72:75], v[56:59], 0
  v_mfma_f32_16x16x32_bf16 v[236:239], v[76:79], v[56:59], 0
  v_mfma_f32_16x16x32_bf16 v[240:243], v[64:67], v[60:63], 0
  v_mfma_f32_16x16x32_bf16 v[244:247], v[68:71], v[60:63], 0
  v_mfma_f32_16x16x32_bf16 v[248:251], v[72:75], v[60:63], 0
  v_mfma_f32_16x16x32_bf16 v[252:255], v[76:79], v[60:63], 0
  s_waitcnt vmcnt(12) lgkmcnt(0)
  s_barrier
  v_mfma_f32_16x16x32_bf16 v[128:131], v[112:115], v[80:83], v[128:131]
  ds_read_b64_tr_b16 v[64:65], v12 offset:0
  v_mfma_f32_16x16x32_bf16 v[132:135], v[116:119], v[80:83], v[132:135]
  ds_read_b64_tr_b16 v[66:67], v12 offset:1024
  v_mfma_f32_16x16x32_bf16 v[136:139], v[120:123], v[80:83], v[136:139]
  s_add_u32 m0, s63, s75
  s_nop 0
  buffer_load_dwordx4 v2, s[36:39], s58 offen offset:0 sc1 lds
  v_mfma_f32_16x16x32_bf16 v[140:143], v[124:127], v[80:83], v[140:143]
  ds_read_b64_tr_b16 v[68:69], v13 offset:0
  v_mfma_f32_16x16x32_bf16 v[144:147], v[112:115], v[84:87], v[144:147]
  ds_read_b64_tr_b16 v[70:71], v13 offset:1024
  v_mfma_f32_16x16x32_bf16 v[148:151], v[116:119], v[84:87], v[148:151]
  ds_read_b64_tr_b16 v[72:73], v14 offset:0
  v_mfma_f32_16x16x32_bf16 v[152:155], v[120:123], v[84:87], v[152:155]
  ds_read_b64_tr_b16 v[74:75], v14 offset:1024
  v_mfma_f32_16x16x32_bf16 v[156:159], v[124:127], v[84:87], v[156:159]
  buffer_load_dwordx4 v3, s[36:39], s58 offen offset:1024 sc1 lds
  v_mfma_f32_16x16x32_bf16 v[160:163], v[112:115], v[88:91], v[160:163]
  ds_read_b64_tr_b16 v[76:77], v15 offset:0
  v_mfma_f32_16x16x32_bf16 v[164:167], v[116:119], v[88:91], v[164:167]
  ds_read_b64_tr_b16 v[78:79], v15 offset:1024
  v_mfma_f32_16x16x32_bf16 v[168:171], v[120:123], v[88:91], v[168:171]
  ds_read_b128 v[32:35], v10 offset:0
  v_mfma_f32_16x16x32_bf16 v[172:175], v[124:127], v[88:91], v[172:175]
  ds_read_b128 v[36:39], v10 offset:2048
  v_mfma_f32_16x16x32_bf16 v[176:179], v[112:115], v[92:95], v[176:179]
  buffer_load_dwordx4 v4, s[36:39], s58 offen offset:2048 sc1 lds
  v_mfma_f32_16x16x32_bf16 v[180:183], v[116:119], v[92:95], v[180:183]
  ds_read_b128 v[40:43], v10 offset:4096
  v_mfma_f32_16x16x32_bf16 v[184:187], v[120:123], v[92:95], v[184:187]
  ds_read_b128 v[44:47], v10 offset:6144
  v_mfma_f32_16x16x32_bf16 v[188:191], v[124:127], v[92:95], v[188:191]
  ds_read_b128 v[48:51], v10 offset:8192
  v_mfma_f32_16x16x32_bf16 v[192:195], v[112:115], v[96:99], v[192:195]
  ds_read_b128 v[52:55], v10 offset:10240
  v_mfma_f32_16x16x32_bf16 v[196:199], v[116:119], v[96:99], v[196:199]
  ds_read_b128 v[56:59], v10 offset:12288
  v_mfma_f32_16x16x32_bf16 v[200:203], v[120:123], v[96:99], v[200:203]
  buffer_load_dwordx4 v5, s[36:39], s58 offen offset:3072 sc1 lds
  v_mfma_f32_16x16x32_bf16 v[204:207], v[124:127], v[96:99], v[204:207]
  ds_read_b128 v[60:63], v10 offset:14336
  v_mfma_f32_16x16x32_bf16 v[208:211], v[112:115], v[100:103], v[208:211]
  v_mfma_f32_16x16x32_bf16 v[212:215], v[116:119], v[100:103], v[212:215]
  v_mfma_f32_16x16x32_bf16 v[216:219], v[120:123], v[100:103], v[216:219]
  v_mfma_f32_16x16x32_bf16 v[220:223], v[124:127], v[100:103], v[220:223]
  s_add_u32 m0, m0, 4096
  s_nop 0
  buffer_load_dwordx4 v2, s[36:39], s59 offen offset:0 sc1 lds
  v_mfma_f32_16x16x32_bf16 v[224:227], v[112:115], v[104:107], v[224:227]
  v_mfma_f32_16x16x32_bf16 v[228:231], v[116:119], v[104:107], v[228:231]
  v_mfma_f32_16x16x32_bf16 v[232:235], v[120:123], v[104:107], v[232:235]
  v_mfma_f32_16x16x32_bf16 v[236:239], v[124:127], v[104:107], v[236:239]
  v_mfma_f32_16x16x32_bf16 v[240:243], v[112:115], v[108:111], v[240:243]
  buffer_load_dwordx4 v3, s[36:39], s59 offen offset:1024 sc1 lds
  v_mfma_f32_16x16x32_bf16 v[244:247], v[116:119], v[108:111], v[244:247]
  v_mfma_f32_16x16x32_bf16 v[248:251], v[120:123], v[108:111], v[248:251]
  v_mfma_f32_16x16x32_bf16 v[252:255], v[124:127], v[108:111], v[252:255]
  s_sub_u32 s57, s57, 4
Lgn_loop:
  s_waitcnt lgkmcnt(0)
  v_mfma_f32_16x16x32_bf16 v[128:131], v[64:67], v[32:35], v[128:131]
  ds_read_b64_tr_b16 v[112:113], v12 offset:8192
  v_mfma_f32_16x16x32_bf16 v[132:135], v[68:71], v[32:35], v[132:135]
  ds_read_b64_tr_b16 v[114:115], v12 offset:9216
  v_mfma_f32_16x16x32_bf16 v[136:139], v[72:75], v[32:35], v[136:139]
  buffer_load_dwordx4 v4, s[36:39], s59 offen offset:2048 sc1 lds
  v_mfma_f32_16x16x32_bf16 v[140:143], v[76:79], v[32:35], v[140:143]
  ds_read_b64_tr_b16 v[116:117], v13 offset:8192
  v_mfma_f32_16x16x32_bf16 v[144:147], v[64:67], v[36:39], v[144:147]
  ds_read_b64_tr_b16 v[118:119], v13 offset:9216
  v_mfma_f32_16x16x32_bf16 v[148:151], v[68:71], v[36:39], v[148:151]
  ds_read_b64_tr_b16 v[120:121], v14 offset:8192
  v_mfma_f32_16x16x32_bf16 v[152:155], v[72:75], v[36:39], v[152:155]
  buffer_load_dwordx4 v5, s[36:39], s59 offen offset:3072 sc1 lds
  v_mfma_f32_16x16x32_bf16 v[156:159], v[76:79], v[36:39], v[156:159]
  ds_read_b64_tr_b16 v[122:123], v14 offset:9216
  v_mfma_f32_16x16x32_bf16 v[160:163], v[64:67], v[40:43], v[160:163]
  ds_read_b64_tr_b16 v[124:125], v15 offset:8192
  v_mfma_f32_16x16x32_bf16 v[164:167], v[68:71], v[40:43], v[164:167]
  ds_read_b64_tr_b16 v[126:127], v15 offset:9216
  v_mfma_f32_16x16x32_bf16 v[168:171], v[72:75], v[40:43], v[168:171]
  ds_read_b128 v[80:83], v11 offset:0
  v_mfma_f32_16x16x32_bf16 v[172:175], v[76:79], v[40:43], v[172:175]
  s_add_u32 m0, s64, s75
  s_nop 0
  buffer_load_dwordx4 v6, s[40:43], s60 offen offset:0 lds
  v_mfma_f32_16x16x32_bf16 v[176:179], v[64:67], v[44:47], v[176:179]
  ds_read_b128 v[84:87], v11 offset:2048
  v_mfma_f32_16x16x32_bf16 v[180:183], v[68:71], v[44:47], v[180:183]
  ds_read_b128 v[88:91], v11 offset:4096
  v_mfma_f32_16x16x32_bf16 v[184:187], v[72:75], v[44:47], v[184:187]
  ds_read_b128 v[92:95], v11 offset:6144
  v_mfma_f32_16x16x32_bf16 v[188:191], v[76:79], v[44:47], v[188:191]
  buffer_load_dwordx4 v7, s[40:43], s60 offen offset:1024 lds
  v_mfma_f32_16x16x32_bf16 v[192:195], v[64:67], v[48:51], v[192:195]
  ds_read_b128 v[96:99], v11 offset:8192
  v_mfma_f32_16x16x32_bf16 v[196:199], v[68:71], v[48:51], v[196:199]
  ds_read_b128 v[100:103], v11 offset:10240
  v_mfma_f32_16x16x32_bf16 v[200:203], v[72:75], v[48:51], v[200:203]
  ds_read_b128 v[104:107], v11 offset:12288
  v_mfma_f32_16x16x32_bf16 v[204:207], v[76:79], v[48:51], v[204:207]
  ds_read_b128 v[108:111], v11 offset:14336
  v_mfma_f32_16x16x32_bf16 v[208:211], v[64:67], v[52:55], v[208:211]
  buffer_load_dwordx4 v8, s[40:43], s60 offen offset:2048 lds
  v_mfma_f32_16x16x32_bf16 v[212:215], v[68:71], v[52:55], v[212:215]
  s_add_u32 s65, s65, 1
  s_cmp_eq_u32 s65, 3
  s_cselect_b32 s66, 4294868992, s96
  s_cselect_b32 s65, 0, s65
  v_mfma_f32_16x16x32_bf16 v[216:219], v[72:75], v[52:55], v[216:219]
  v_add_u32 v10, s66, v10
  v_mfma_f32_16x16x32_bf16 v[220:223], v[76:79], v[52:55], v[220:223]
  v_add_u32 v11, s66, v11
  v_mfma_f32_16x16x32_bf16 v[224:227], v[64:67], v[56:59], v[224:227]
  buffer_load_dwordx4 v9, s[40:43], s60 offen offset:3072 lds
  s_add_u32 s58, s58, s61
  s_add_u32 s59, s59, s61
  s_add_u32 s60, s60, s62
  s_sub_u32 s81, s81, 1
  s_cmp_eq_u32 s81, 0
  s_cselect_b32 s90, s88, 0
  s_cselect_b32 s91, s89, 0
  s_sub_u32 s58, s58, s90
  s_sub_u32 s59, s59, s90
  s_sub_u32 s60, s60, s91
  s_add_u32 s75, s75, 49152
  s_cmp_eq_u32 s75, 147456
  s_cselect_b32 s75, 0, s75
  v_mfma_f32_16x16x32_bf16 v[228:231], v[68:71], v[56:59], v[228:231]
  v_add_u32 v12, s66, v12
  v_mfma_f32_16x16x32_bf16 v[232:235], v[72:75], v[56:59], v[232:235]
  v_add_u32 v13, s66, v13
  v_mfma_f32_16x16x32_bf16 v[236:239], v[76:79], v[56:59], v[236:239]
  v_add_u32 v14, s66, v14
  v_mfma_f32_16x16x32_bf16 v[240:243], v[64:67], v[60:63], v[240:243]
  v_add_u32 v15, s66, v15
  v_mfma_f32_16x16x32_bf16 v[244:247], v[68:71], v[60:63], v[244:247]
  s_add_u32 m0, s80, 0
  s_add_u32 s78, s78, s79
  buffer_load_dwordx4 v1, s[44:47], s78 offen lds
  v_mfma_f32_16x16x32_bf16 v[248:251], v[72:75], v[60:63], v[248:251]
  v_mfma_f32_16x16x32_bf16 v[252:255], v[76:79], v[60:63], v[252:255]
  s_waitcnt vmcnt(13) lgkmcnt(0)
  s_barrier
  v_mfma_f32_16x16x32_bf16 v[128:131], v[112:115], v[80:83], v[128:131]
  ds_read_b64_tr_b16 v[64:65], v12 offset:0
  v_mfma_f32_16x16x32_bf16 v[132:135], v[116:119], v[80:83], v[132:135]
  ds_read_b64_tr_b16 v[66:67], v12 offset:1024
  v_mfma_f32_16x16x32_bf16 v[136:139], v[120:123], v[80:83], v[136:139]
  s_add_u32 m0, s63, s75
  s_nop 0
  buffer_load_dwordx4 v2, s[36:39], s58 offen offset:0 sc1 lds
  v_mfma_f32_16x16x32_bf16 v[140:143], v[124:127], v[80:83], v[140:143]
  ds_read_b64_tr_b16 v[68:69], v13 offset:0
  v_mfma_f32_16x16x32_bf16 v[144:147], v[112:115], v[84:87], v[144:147]
  ds_read_b64_tr_b16 v[70:71], v13 offset:1024
  v_mfma_f32_16x16x32_bf16 v[148:151], v[116:119], v[84:87], v[148:151]
  ds_read_b64_tr_b16 v[72:73], v14 offset:0
  v_mfma_f32_16x16x32_bf16 v[152:155], v[120:123], v[84:87], v[152:155]
  ds_read_b64_tr_b16 v[74:75], v14 offset:1024
  v_mfma_f32_16x16x32_bf16 v[156:159], v[124:127], v[84:87], v[156:159]
  buffer_load_dwordx4 v3, s[36:39], s58 offen offset:1024 sc1 lds
  v_mfma_f32_16x16x32_bf16 v[160:163], v[112:115], v[88:91], v[160:163]
  ds_read_b64_tr_b16 v[76:77], v15 offset:0
  v_mfma_f32_16x16x32_bf16 v[164:167], v[116:119], v[88:91], v[164:167]
  ds_read_b64_tr_b16 v[78:79], v15 offset:1024
  v_mfma_f32_16x16x32_bf16 v[168:171], v[120:123], v[88:91], v[168:171]
  ds_read_b128 v[32:35], v10 offset:0
  v_mfma_f32_16x16x32_bf16 v[172:175], v[124:127], v[88:91], v[172:175]
  ds_read_b128 v[36:39], v10 offset:2048
  v_mfma_f32_16x16x32_bf16 v[176:179], v[112:115], v[92:95], v[176:179]
  buffer_load_dwordx4 v4, s[36:39], s58 offen offset:2048 sc1 lds
  v_mfma_f32_16x16x32_bf16 v[180:183], v[116:119], v[92:95], v[180:183]
  ds_read_b128 v[40:43], v10 offset:4096
  v_mfma_f32_16x16x32_bf16 v[184:187], v[120:123], v[92:95], v[184:187]
  ds_read_b128 v[44:47], v10 offset:6144
  v_mfma_f32_16x16x32_bf16 v[188:191], v[124:127], v[92:95], v[188:191]
  ds_read_b128 v[48:51], v10 offset:8192
  v_mfma_f32_16x16x32_bf16 v[192:195], v[112:115], v[96:99], v[192:195]
  ds_read_b128 v[52:55], v10 offset:10240
  v_mfma_f32_16x16x32_bf16 v[196:199], v[116:119], v[96:99], v[196:199]
  ds_read_b128 v[56:59], v10 offset:12288
  v_mfma_f32_16x16x32_bf16 v[200:203], v[120:123], v[96:99], v[200:203]
  buffer_load_dwordx4 v5, s[36:39], s58 offen offset:3072 sc1 lds
  v_mfma_f32_16x16x32_bf16 v[204:207], v[124:127], v[96:99], v[204:207]
  ds_read_b128 v[60:63], v10 offset:14336
  v_mfma_f32_16x16x32_bf16 v[208:211], v[112:115], v[100:103], v[208:211]
  v_mfma_f32_16x16x32_bf16 v[212:215], v[116:119], v[100:103], v[212:215]
  v_mfma_f32_16x16x32_bf16 v[216:219], v[120:123], v[100:103], v[216:219]
  v_mfma_f32_16x16x32_bf16 v[220:223], v[124:127], v[100:103], v[220:223]
  s_add_u32 m0, m0, 4096
  s_nop 0
  buffer_load_dwordx4 v2, s[36:39], s59 offen offset:0 sc1 lds
  v_mfma_f32_16x16x32_bf16 v[224:227], v[112:115], v[104:107], v[224:227]
  v_mfma_f32_16x16x32_bf16 v[228:231], v[116:119], v[104:107], v[228:231]
  v_mfma_f32_16x16x32_bf16 v[232:235], v[120:123], v[104:107], v[232:235]
  v_mfma_f32_16x16x32_bf16 v[236:239], v[124:127], v[104:107], v[236:239]
  v_mfma_f32_16x16x32_bf16 v[240:243], v[112:115], v[108:111], v[240:243]
  buffer_load_dwordx4 v3, s[36:39], s59 offen offset:1024 sc1 lds
  v_mfma_f32_16x16x32_bf16 v[244:247], v[116:119], v[108:111], v[244:247]
  v_mfma_f32_16x16x32_bf16 v[248:251], v[120:123], v[108:111], v[248:251]
  v_mfma_f32_16x16x32_bf16 v[252:255], v[124:127], v[108:111], v[252:255]
  s_sub_u32 s57, s57, 1
  s_cmp_lg_u32 s57, 0
  s_cbranch_scc1 Lgn_loop
  s_waitcnt lgkmcnt(0)
  v_mfma_f32_16x16x32_bf16 v[128:131], v[64:67], v[32:35], v[128:131]
  ds_read_b64_tr_b16 v[112:113], v12 offset:8192
  v_mfma_f32_16x16x32_bf16 v[132:135], v[68:71], v[32:35], v[132:135]
  ds_read_b64_tr_b16 v[114:115], v12 offset:9216
  v_mfma_f32_16x16x32_bf16 v[136:139], v[72:75], v[32:35], v[136:139]
  buffer_load_dwordx4 v4, s[36:39], s59 offen offset:2048 sc1 lds
  v_mfma_f32_16x16x32_bf16 v[140:143], v[76:79], v[32:35], v[140:143]
  ds_read_b64_tr_b16 v[116:117], v13 offset:8192
  v_mfma_f32_16x16x32_bf16 v[144:147], v[64:67], v[36:39], v[144:147]
  ds_read_b64_tr_b16 v[118:119], v13 offset:9216
  v_mfma_f32_16x16x32_bf16 v[148:151], v[68:71], v[36:39], v[148:151]
  ds_read_b64_tr_b16 v[120:121], v14 offset:8192
  v_mfma_f32_16x16x32_bf16 v[152:155], v[72:75], v[36:39], v[152:155]
  buffer_load_dwordx4 v5, s[36:39], s59 offen offset:3072 sc1 lds
  v_mfma_f32_16x16x32_bf16 v[156:159], v[76:79], v[36:39], v[156:159]
  ds_read_b64_tr_b16 v[122:123], v14 offset:9216
  v_mfma_f32_16x16x32_bf16 v[160:163], v[64:67], v[40:43], v[160:163]
  ds_read_b64_tr_b16 v[124:125], v15 offset:8192
  v_mfma_f32_16x16x32_bf16 v[164:167], v[68:71], v[40:43], v[164:167]
  ds_read_b64_tr_b16 v[126:127], v15 offset:9216
  v_mfma_f32_16x16x32_bf16 v[168:171], v[72:75], v[40:43], v[168:171]
  ds_read_b128 v[80:83], v11 offset:0
  v_mfma_f32_16x16x32_bf16 v[172:175], v[76:79], v[40:43], v[172:175]
  s_add_u32 m0, s64, s75
  s_nop 0
  buffer_load_dwordx4 v6, s[40:43], s60 offen offset:0 lds
  v_mfma_f32_16x16x32_bf16 v[176:179], v[64:67], v[44:47], v[176:179]
  ds_read_b128 v[84:87], v11 offset:2048
  v_mfma_f32_16x16x32_bf16 v[180:183], v[68:71], v[44:47], v[180:183]
  ds_read_b128 v[88:91], v11 offset:4096
  v_mfma_f32_16x16x32_bf16 v[184:187], v[72:75], v[44:47], v[184:187]
  ds_read_b128 v[92:95], v11 offset:6144
  v_mfma_f32_16x16x32_bf16 v[188:191], v[76:79], v[44:47], v[188:191]
  buffer_load_dwordx4 v7, s[40:43], s60 offen offset:1024 lds
  v_mfma_f32_16x16x32_bf16 v[192:195], v[64:67], v[48:51], v[192:195]
  ds_read_b128 v[96:99], v11 offset:8192
  v_mfma_f32_16x16x32_bf16 v[196:199], v[68:71], v[48:51], v[196:199]
  ds_read_b128 v[100:103], v11 offset:10240
  v_mfma_f32_16x16x32_bf16 v[200:203], v[72:75], v[48:51], v[200:203]
  ds_read_b128 v[104:107], v11 offset:12288
  v_mfma_f32_16x16x32_bf16 v[204:207], v[76:79], v[48:51], v[204:207]
  ds_read_b128 v[108:111], v11 offset:14336
  v_mfma_f32_16x16x32_bf16 v[208:211], v[64:67], v[52:55], v[208:211]
  buffer_load_dwordx4 v8, s[40:43], s60 offen offset:2048 lds
  v_mfma_f32_16x16x32_bf16 v[212:215], v[68:71], v[52:55], v[212:215]
  s_add_u32 s65, s65, 1
  s_cmp_eq_u32 s65, 3
  s_cselect_b32 s66, 4294868992, s96
  s_cselect_b32 s65, 0, s65
  v_mfma_f32_16x16x32_bf16 v[216:219], v[72:75], v[52:55], v[216:219]
  v_add_u32 v10, s66, v10
  v_mfma_f32_16x16x32_bf16 v[220:223], v[76:79], v[52:55], v[220:223]
  v_add_u32 v11, s66, v11
  v_mfma_f32_16x16x32_bf16 v[224:227], v[64:67], v[56:59], v[224:227]
  buffer_load_dwordx4 v9, s[40:43], s60 offen offset:3072 lds
  s_add_u32 s58, s58, s61
  s_add_u32 s59, s59, s61
  s_add_u32 s60, s60, s62
  s_sub_u32 s81, s81, 1
  s_cmp_eq_u32 s81, 0
  s_cselect_b32 s90, s88, 0
  s_cselect_b32 s91, s89, 0
  s_sub_u32 s58, s58, s90
  s_sub_u32 s59, s59, s90
  s_sub_u32 s60, s60, s91
  s_add_u32 s75, s75, 49152
  s_cmp_eq_u32 s75, 147456
  s_cselect_b32 s75, 0, s75
  v_mfma_f32_16x16x32_bf16 v[228:231], v[68:71], v[56:59], v[228:231]
  v_add_u32 v12, s66, v12
  v_mfma_f32_16x16x32_bf16 v[232:235], v[72:75], v[56:59], v[232:235]
  v_add_u32 v13, s66, v13
  v_mfma_f32_16x16x32_bf16 v[236:239], v[76:79], v[56:59], v[236:239]
  v_add_u32 v14, s66, v14
  v_mfma_f32_16x16x32_bf16 v[240:243], v[64:67], v[60:63], v[240:243]
  v_add_u32 v15, s66, v15
  v_mfma_f32_16x16x32_bf16 v[244:247], v[68:71], v[60:63], v[244:247]
  s_add_u32 m0, s80, 0
  s_add_u32 s78, s78, s79
  buffer_load_dwordx4 v1, s[44:47], s78 offen lds
  v_mfma_f32_16x16x32_bf16 v[248:251], v[72:75], v[60:63], v[248:251]
  v_mfma_f32_16x16x32_bf16 v[252:255], v[76:79], v[60:63], v[252:255]
  s_waitcnt vmcnt(13) lgkmcnt(0)
  s_barrier
  v_mfma_f32_16x16x32_bf16 v[128:131], v[112:115], v[80:83], v[128:131]
  ds_read_b64_tr_b16 v[64:65], v12 offset:0
  v_mfma_f32_16x16x32_bf16 v[132:135], v[116:119], v[80:83], v[132:135]
  ds_read_b64_tr_b16 v[66:67], v12 offset:1024
  v_mfma_f32_16x16x32_bf16 v[136:139], v[120:123], v[80:83], v[136:139]
  ds_read_b64_tr_b16 v[68:69], v13 offset:0
  v_mfma_f32_16x16x32_bf16 v[140:143], v[124:127], v[80:83], v[140:143]
  ds_read_b64_tr_b16 v[70:71], v13 offset:1024
  v_mfma_f32_16x16x32_bf16 v[144:147], v[112:115], v[84:87], v[144:147]
  ds_read_b64_tr_b16 v[72:73], v14 offset:0
  v_mfma_f32_16x16x32_bf16 v[148:151], v[116:119], v[84:87], v[148:151]
  ds_read_b64_tr_b16 v[74:75], v14 offset:1024
  v_mfma_f32_16x16x32_bf16 v[152:155], v[120:123], v[84:87], v[152:155]
  ds_read_b64_tr_b16 v[76:77], v15 offset:0
  v_mfma_f32_16x16x32_bf16 v[156:159], v[124:127], v[84:87], v[156:159]
  ds_read_b64_tr_b16 v[78:79], v15 offset:1024
  v_mfma_f32_16x16x32_bf16 v[160:163], v[112:115], v[88:91], v[160:163]
  ds_read_b128 v[32:35], v10 offset:0
  v_mfma_f32_16x16x32_bf16 v[164:167], v[116:119], v[88:91], v[164:167]
  ds_read_b128 v[36:39], v10 offset:2048
  v_mfma_f32_16x16x32_bf16 v[168:171], v[120:123], v[88:91], v[168:171]
  ds_read_b128 v[40:43], v10 offset:4096
  v_mfma_f32_16x16x32_bf16 v[172:175], v[124:127], v[88:91], v[172:175]
  ds_read_b128 v[44:47], v10 offset:6144
  v_mfma_f32_16x16x32_bf16 v[176:179], v[112:115], v[92:95], v[176:179]
  ds_read_b128 v[48:51], v10 offset:8192
  v_mfma_f32_16x16x32_bf16 v[180:183], v[116:119], v[92:95], v[180:183]
  ds_read_b128 v[52:55], v10 offset:10240
  v_mfma_f32_16x16x32_bf16 v[184:187], v[120:123], v[92:95], v[184:187]
  ds_read_b128 v[56:59], v10 offset:12288
  v_mfma_f32_16x16x32_bf16 v[188:191], v[124:127], v[92:95], v[188:191]
  ds_read_b128 v[60:63], v10 offset:14336
  v_mfma_f32_16x16x32_bf16 v[192:195], v[112:115], v[96:99], v[192:195]
  v_mfma_f32_16x16x32_bf16 v[196:199], v[116:119], v[96:99], v[196:199]
  v_mfma_f32_16x16x32_bf16 v[200:203], v[120:123], v[96:99], v[200:203]
  v_mfma_f32_16x16x32_bf16 v[204:207], v[124:127], v[96:99], v[204:207]
  v_mfma_f32_16x16x32_bf16 v[208:211], v[112:115], v[100:103], v[208:211]
  v_mfma_f32_16x16x32_bf16 v[212:215], v[116:119], v[100:103], v[212:215]
  v_mfma_f32_16x16x32_bf16 v[216:219], v[120:123], v[100:103], v[216:219]
  v_mfma_f32_16x16x32_bf16 v[220:223], v[124:127], v[100:103], v[220:223]
  v_mfma_f32_16x16x32_bf16 v[224:227], v[112:115], v[104:107], v[224:227]
  v_mfma_f32_16x16x32_bf16 v[228:231], v[116:119], v[104:107], v[228:231]
  v_mfma_f32_16x16x32_bf16 v[232:235], v[120:123], v[104:107], v[232:235]
  v_mfma_f32_16x16x32_bf16 v[236:239], v[124:127], v[104:107], v[236:239]
  v_mfma_f32_16x16x32_bf16 v[240:243], v[112:115], v[108:111], v[240:243]
  v_mfma_f32_16x16x32_bf16 v[244:247], v[116:119], v[108:111], v[244:247]
  v_mfma_f32_16x16x32_bf16 v[248:251], v[120:123], v[108:111], v[248:251]
  v_mfma_f32_16x16x32_bf16 v[252:255], v[124:127], v[108:111], v[252:255]
  s_waitcnt lgkmcnt(0)
  v_mfma_f32_16x16x32_bf16 v[128:131], v[64:67], v[32:35], v[128:131]
  ds_read_b64_tr_b16 v[112:113], v12 offset:8192
  v_mfma_f32_16x16x32_bf16 v[132:135], v[68:71], v[32:35], v[132:135]
  ds_read_b64_tr_b16 v[114:115], v12 offset:9216
  v_mfma_f32_16x16x32_bf16 v[136:139], v[72:75], v[32:35], v[136:139]
  ds_read_b64_tr_b16 v[116:117], v13 offset:8192
  v_mfma_f32_16x16x32_bf16 v[140:143], v[76:79], v[32:35], v[140:143]
  ds_read_b64_tr_b16 v[118:119], v13 offset:9216
  v_mfma_f32_16x16x32_bf16 v[144:147], v[64:67], v[36:39], v[144:147]
  ds_read_b64_tr_b16 v[120:121], v14 offset:8192
  v_mfma_f32_16x16x32_bf16 v[148:151], v[68:71], v[36:39], v[148:151]
  ds_read_b64_tr_b16 v[122:123], v14 offset:9216
  v_mfma_f32_16x16x32_bf16 v[152:155], v[72:75], v[36:39], v[152:155]
  ds_read_b64_tr_b16 v[124:125], v15 offset:8192
  v_mfma_f32_16x16x32_bf16 v[156:159], v[76:79], v[36:39], v[156:159]
  ds_read_b64_tr_b16 v[126:127], v15 offset:9216
  v_mfma_f32_16x16x32_bf16 v[160:163], v[64:67], v[40:43], v[160:163]
  ds_read_b128 v[80:83], v11 offset:0
  v_mfma_f32_16x16x32_bf16 v[164:167], v[68:71], v[40:43], v[164:167]
  ds_read_b128 v[84:87], v11 offset:2048
  v_mfma_f32_16x16x32_bf16 v[168:171], v[72:75], v[40:43], v[168:171]
  ds_read_b128 v[88:91], v11 offset:4096
  v_mfma_f32_16x16x32_bf16 v[172:175], v[76:79], v[40:43], v[172:175]
  ds_read_b128 v[92:95], v11 offset:6144
  v_mfma_f32_16x16x32_bf16 v[176:179], v[64:67], v[44:47], v[176:179]
  ds_read_b128 v[96:99], v11 offset:8192
  v_mfma_f32_16x16x32_bf16 v[180:183], v[68:71], v[44:47], v[180:183]
  ds_read_b128 v[100:103], v11 offset:10240
  v_mfma_f32_16x16x32_bf16 v[184:187], v[72:75], v[44:47], v[184:187]
  ds_read_b128 v[104:107], v11 offset:12288
  v_mfma_f32_16x16x32_bf16 v[188:191], v[76:79], v[44:47], v[188:191]
  ds_read_b128 v[108:111], v11 offset:14336
  v_mfma_f32_16x16x32_bf16 v[192:195], v[64:67], v[48:51], v[192:195]
  s_add_u32 s65, s65, 1
  s_cmp_eq_u32 s65, 3
  s_cselect_b32 s66, 4294868992, s96
  s_cselect_b32 s65, 0, s65
  v_mfma_f32_16x16x32_bf16 v[196:199], v[68:71], v[48:51], v[196:199]
  v_add_u32 v10, s66, v10
  v_mfma_f32_16x16x32_bf16 v[200:203], v[72:75], v[48:51], v[200:203]
  v_add_u32 v11, s66, v11
  v_mfma_f32_16x16x32_bf16 v[204:207], v[76:79], v[48:51], v[204:207]
  v_add_u32 v12, s66, v12
  v_mfma_f32_16x16x32_bf16 v[208:211], v[64:67], v[52:55], v[208:211]
  v_add_u32 v13, s66, v13
  v_mfma_f32_16x16x32_bf16 v[212:215], v[68:71], v[52:55], v[212:215]
  v_add_u32 v14, s66, v14
  v_mfma_f32_16x16x32_bf16 v[216:219], v[72:75], v[52:55], v[216:219]
  v_add_u32 v15, s66, v15
  v_mfma_f32_16x16x32_bf16 v[220:223], v[76:79], v[52:55], v[220:223]
  v_mfma_f32_16x16x32_bf16 v[224:227], v[64:67], v[56:59], v[224:227]
  v_mfma_f32_16x16x32_bf16 v[228:231], v[68:71], v[56:59], v[228:231]
  v_mfma_f32_16x16x32_bf16 v[232:235], v[72:75], v[56:59], v[232:235]
  v_mfma_f32_16x16x32_bf16 v[236:239], v[76:79], v[56:59], v[236:239]
  v_mfma_f32_16x16x32_bf16 v[240:243], v[64:67], v[60:63], v[240:243]
  v_mfma_f32_16x16x32_bf16 v[244:247], v[68:71], v[60:63], v[244:247]
  v_mfma_f32_16x16x32_bf16 v[248:251], v[72:75], v[60:63], v[248:251]
  v_mfma_f32_16x16x32_bf16 v[252:255], v[76:79], v[60:63], v[252:255]
  s_waitcnt vmcnt(0) lgkmcnt(0)
  s_barrier
  v_mfma_f32_16x16x32_bf16 v[128:131], v[112:115], v[80:83], v[128:131]
  ds_read_b64_tr_b16 v[64:65], v12 offset:0
  v_mfma_f32_16x16x32_bf16 v[132:135], v[116:119], v[80:83], v[132:135]
  ds_read_b64_tr_b16 v[66:67], v12 offset:1024
  v_mfma_f32_16x16x32_bf16 v[136:139], v[120:123], v[80:83], v[136:139]
  ds_read_b64_tr_b16 v[68:69], v13 offset:0
  v_mfma_f32_16x16x32_bf16 v[140:143], v[124:127], v[80:83], v[140:143]
  ds_read_b64_tr_b16 v[70:71], v13 offset:1024
  v_mfma_f32_16x16x32_bf16 v[144:147], v[112:115], v[84:87], v[144:147]
  ds_read_b64_tr_b16 v[72:73], v14 offset:0
  v_mfma_f32_16x16x32_bf16 v[148:151], v[116:119], v[84:87], v[148:151]
  ds_read_b64_tr_b16 v[74:75], v14 offset:1024
  v_mfma_f32_16x16x32_bf16 v[152:155], v[120:123], v[84:87], v[152:155]
  ds_read_b64_tr_b16 v[76:77], v15 offset:0
  v_mfma_f32_16x16x32_bf16 v[156:159], v[124:127], v[84:87], v[156:159]
  ds_read_b64_tr_b16 v[78:79], v15 offset:1024
  v_mfma_f32_16x16x32_bf16 v[160:163], v[112:115], v[88:91], v[160:163]
  ds_read_b128 v[32:35], v10 offset:0
  v_mfma_f32_16x16x32_bf16 v[164:167], v[116:119], v[88:91], v[164:167]
  ds_read_b128 v[36:39], v10 offset:2048
  v_mfma_f32_16x16x32_bf16 v[168:171], v[120:123], v[88:91], v[168:171]
  ds_read_b128 v[40:43], v10 offset:4096
  v_mfma_f32_16x16x32_bf16 v[172:175], v[124:127], v[88:91], v[172:175]
  ds_read_b128 v[44:47], v10 offset:6144
  v_mfma_f32_16x16x32_bf16 v[176:179], v[112:115], v[92:95], v[176:179]
  ds_read_b128 v[48:51], v10 offset:8192
  v_mfma_f32_16x16x32_bf16 v[180:183], v[116:119], v[92:95], v[180:183]
  ds_read_b128 v[52:55], v10 offset:10240
  v_mfma_f32_16x16x32_bf16 v[184:187], v[120:123], v[92:95], v[184:187]
  ds_read_b128 v[56:59], v10 offset:12288
  v_mfma_f32_16x16x32_bf16 v[188:191], v[124:127], v[92:95], v[188:191]
  ds_read_b128 v[60:63], v10 offset:14336
  v_mfma_f32_16x16x32_bf16 v[192:195], v[112:115], v[96:99], v[192:195]
  v_mfma_f32_16x16x32_bf16 v[196:199], v[116:119], v[96:99], v[196:199]
  v_mfma_f32_16x16x32_bf16 v[200:203], v[120:123], v[96:99], v[200:203]
  v_mfma_f32_16x16x32_bf16 v[204:207], v[124:127], v[96:99], v[204:207]
  v_mfma_f32_16x16x32_bf16 v[208:211], v[112:115], v[100:103], v[208:211]
  v_mfma_f32_16x16x32_bf16 v[212:215], v[116:119], v[100:103], v[212:215]
  v_mfma_f32_16x16x32_bf16 v[216:219], v[120:123], v[100:103], v[216:219]
  v_mfma_f32_16x16x32_bf16 v[220:223], v[124:127], v[100:103], v[220:223]
  v_mfma_f32_16x16x32_bf16 v[224:227], v[112:115], v[104:107], v[224:227]
  v_mfma_f32_16x16x32_bf16 v[228:231], v[116:119], v[104:107], v[228:231]
  v_mfma_f32_16x16x32_bf16 v[232:235], v[120:123], v[104:107], v[232:235]
  v_mfma_f32_16x16x32_bf16 v[236:239], v[124:127], v[104:107], v[236:239]
  v_mfma_f32_16x16x32_bf16 v[240:243], v[112:115], v[108:111], v[240:243]
  v_mfma_f32_16x16x32_bf16 v[244:247], v[116:119], v[108:111], v[244:247]
  v_mfma_f32_16x16x32_bf16 v[248:251], v[120:123], v[108:111], v[248:251]
  v_mfma_f32_16x16x32_bf16 v[252:255], v[124:127], v[108:111], v[252:255]
  s_waitcnt lgkmcnt(0)
  v_mfma_f32_16x16x32_bf16 v[128:131], v[64:67], v[32:35], v[128:131]
  ds_read_b64_tr_b16 v[112:113], v12 offset:8192
  v_mfma_f32_16x16x32_bf16 v[132:135], v[68:71], v[32:35], v[132:135]
  ds_read_b64_tr_b16 v[114:115], v12 offset:9216
  v_mfma_f32_16x16x32_bf16 v[136:139], v[72:75], v[32:35], v[136:139]
  ds_read_b64_tr_b16 v[116:117], v13 offset:8192
  v_mfma_f32_16x16x32_bf16 v[140:143], v[76:79], v[32:35], v[140:143]
  ds_read_b64_tr_b16 v[118:119], v13 offset:9216
  v_mfma_f32_16x16x32_bf16 v[144:147], v[64:67], v[36:39], v[144:147]
  ds_read_b64_tr_b16 v[120:121], v14 offset:8192
  v_mfma_f32_16x16x32_bf16 v[148:151], v[68:71], v[36:39], v[148:151]
  ds_read_b64_tr_b16 v[122:123], v14 offset:9216
  v_mfma_f32_16x16x32_bf16 v[152:155], v[72:75], v[36:39], v[152:155]
  ds_read_b64_tr_b16 v[124:125], v15 offset:8192
  v_mfma_f32_16x16x32_bf16 v[156:159], v[76:79], v[36:39], v[156:159]
  ds_read_b64_tr_b16 v[126:127], v15 offset:9216
  v_mfma_f32_16x16x32_bf16 v[160:163], v[64:67], v[40:43], v[160:163]
  ds_read_b128 v[80:83], v11 offset:0
  v_mfma_f32_16x16x32_bf16 v[164:167], v[68:71], v[40:43], v[164:167]
  ds_read_b128 v[84:87], v11 offset:2048
  v_mfma_f32_16x16x32_bf16 v[168:171], v[72:75], v[40:43], v[168:171]
  ds_read_b128 v[88:91], v11 offset:4096
  v_mfma_f32_16x16x32_bf16 v[172:175], v[76:79], v[40:43], v[172:175]
  ds_read_b128 v[92:95], v11 offset:6144
  v_mfma_f32_16x16x32_bf16 v[176:179], v[64:67], v[44:47], v[176:179]
  ds_read_b128 v[96:99], v11 offset:8192
  v_mfma_f32_16x16x32_bf16 v[180:183], v[68:71], v[44:47], v[180:183]
  ds_read_b128 v[100:103], v11 offset:10240
  v_mfma_f32_16x16x32_bf16 v[184:187], v[72:75], v[44:47], v[184:187]
  ds_read_b128 v[104:107], v11 offset:12288
  v_mfma_f32_16x16x32_bf16 v[188:191], v[76:79], v[44:47], v[188:191]
  ds_read_b128 v[108:111], v11 offset:14336
  v_mfma_f32_16x16x32_bf16 v[192:195], v[64:67], v[48:51], v[192:195]
  v_mfma_f32_16x16x32_bf16 v[196:199], v[68:71], v[48:51], v[196:199]
  v_mfma_f32_16x16x32_bf16 v[200:203], v[72:75], v[48:51], v[200:203]
  v_mfma_f32_16x16x32_bf16 v[204:207], v[76:79], v[48:51], v[204:207]
  v_mfma_f32_16x16x32_bf16 v[208:211], v[64:67], v[52:55], v[208:211]
  v_mfma_f32_16x16x32_bf16 v[212:215], v[68:71], v[52:55], v[212:215]
  v_mfma_f32_16x16x32_bf16 v[216:219], v[72:75], v[52:55], v[216:219]
  v_mfma_f32_16x16x32_bf16 v[220:223], v[76:79], v[52:55], v[220:223]
  v_mfma_f32_16x16x32_bf16 v[224:227], v[64:67], v[56:59], v[224:227]
  v_mfma_f32_16x16x32_bf16 v[228:231], v[68:71], v[56:59], v[228:231]
  v_mfma_f32_16x16x32_bf16 v[232:235], v[72:75], v[56:59], v[232:235]
  v_mfma_f32_16x16x32_bf16 v[236:239], v[76:79], v[56:59], v[236:239]
  v_mfma_f32_16x16x32_bf16 v[240:243], v[64:67], v[60:63], v[240:243]
  v_mfma_f32_16x16x32_bf16 v[244:247], v[68:71], v[60:63], v[244:247]
  v_mfma_f32_16x16x32_bf16 v[248:251], v[72:75], v[60:63], v[248:251]
  v_mfma_f32_16x16x32_bf16 v[252:255], v[76:79], v[60:63], v[252:255]
  s_waitcnt lgkmcnt(0)
  v_mfma_f32_16x16x32_bf16 v[128:131], v[112:115], v[80:83], v[128:131]
  v_mfma_f32_16x16x32_bf16 v[132:135], v[116:119], v[80:83], v[132:135]
  v_mfma_f32_16x16x32_bf16 v[136:139], v[120:123], v[80:83], v[136:139]
  v_mfma_f32_16x16x32_bf16 v[140:143], v[124:127], v[80:83], v[140:143]
  v_mfma_f32_16x16x32_bf16 v[144:147], v[112:115], v[84:87], v[144:147]
  v_mfma_f32_16x16x32_bf16 v[148:151], v[116:119], v[84:87], v[148:151]
  v_mfma_f32_16x16x32_bf16 v[152:155], v[120:123], v[84:87], v[152:155]
  v_mfma_f32_16x16x32_bf16 v[156:159], v[124:127], v[84:87], v[156:159]
  v_mfma_f32_16x16x32_bf16 v[160:163], v[112:115], v[88:91], v[160:163]
  v_mfma_f32_16x16x32_bf16 v[164:167], v[116:119], v[88:91], v[164:167]
  v_mfma_f32_16x16x32_bf16 v[168:171], v[120:123], v[88:91], v[168:171]
  v_mfma_f32_16x16x32_bf16 v[172:175], v[124:127], v[88:91], v[172:175]
  v_mfma_f32_16x16x32_bf16 v[176:179], v[112:115], v[92:95], v[176:179]
  v_mfma_f32_16x16x32_bf16 v[180:183], v[116:119], v[92:95], v[180:183]
  v_mfma_f32_16x16x32_bf16 v[184:187], v[120:123], v[92:95], v[184:187]
  v_mfma_f32_16x16x32_bf16 v[188:191], v[124:127], v[92:95], v[188:191]
  v_mfma_f32_16x16x32_bf16 v[192:195], v[112:115], v[96:99], v[192:195]
  v_mfma_f32_16x16x32_bf16 v[196:199], v[116:119], v[96:99], v[196:199]
  v_mfma_f32_16x16x32_bf16 v[200:203], v[120:123], v[96:99], v[200:203]
  v_mfma_f32_16x16x32_bf16 v[204:207], v[124:127], v[96:99], v[204:207]
  v_mfma_f32_16x16x32_bf16 v[208:211], v[112:115], v[100:103], v[208:211]
  v_mfma_f32_16x16x32_bf16 v[212:215], v[116:119], v[100:103], v[212:215]
  v_mfma_f32_16x16x32_bf16 v[216:219], v[120:123], v[100:103], v[216:219]
  v_mfma_f32_16x16x32_bf16 v[220:223], v[124:127], v[100:103], v[220:223]
  v_mfma_f32_16x16x32_bf16 v[224:227], v[112:115], v[104:107], v[224:227]
  v_mfma_f32_16x16x32_bf16 v[228:231], v[116:119], v[104:107], v[228:231]
  v_mfma_f32_16x16x32_bf16 v[232:235], v[120:123], v[104:107], v[232:235]
  v_mfma_f32_16x16x32_bf16 v[236:239], v[124:127], v[104:107], v[236:239]
  v_mfma_f32_16x16x32_bf16 v[240:243], v[112:115], v[108:111], v[240:243]
  v_mfma_f32_16x16x32_bf16 v[244:247], v[116:119], v[108:111], v[244:247]
  v_mfma_f32_16x16x32_bf16 v[248:251], v[120:123], v[108:111], v[248:251]
  v_mfma_f32_16x16x32_bf16 v[252:255], v[124:127], v[108:111], v[252:255]
  s_branch Lnext
Lgemm_v:
  s_waitcnt vmcnt(24)
  s_barrier
  ds_read_b64_tr_b16 v[64:65], v12 offset:0
  ds_read_b64_tr_b16 v[66:67], v12 offset:1024
  ds_read_b64_tr_b16 v[68:69], v13 offset:0
  ds_read_b64_tr_b16 v[70:71], v13 offset:1024
  ds_read_b64_tr_b16 v[72:73], v14 offset:0
  ds_read_b64_tr_b16 v[74:75], v14 offset:1024
  ds_read_b64_tr_b16 v[76:77], v15 offset:0
  ds_read_b64_tr_b16 v[78:79], v15 offset:1024
  ds_read_b128 v[32:35], v10 offset:0
  ds_read_b128 v[36:39], v10 offset:2048
  ds_read_b128 v[40:43], v10 offset:4096
  ds_read_b128 v[44:47], v10 offset:6144
  s_waitcnt lgkmcnt(8)
  ds_read_b128 v[48:51], v10 offset:8192
  ds_read_b128 v[52:55], v10 offset:10240
  ds_read_b128 v[56:59], v10 offset:12288
  ds_read_b128 v[60:63], v10 offset:14336
  s_waitcnt lgkmcnt(0)
  v_mfma_f32_16x16x32_bf16 v[128:131], v[32:35], v[64:67], 0
  ds_read_b64_tr_b16 v[112:113], v12 offset:8192
  v_mfma_f32_16x16x32_bf16 v[132:135], v[32:35], v[68:71], 0
  ds_read_b64_tr_b16 v[114:115], v12 offset:9216
  v_mfma_f32_16x16x32_bf16 v[136:139], v[32:35], v[72:75], 0
  ds_read_b64_tr_b16 v[116:117], v13 offset:8192
  v_mfma_f32_16x16x32_bf16 v[140:143], v[32:35], v[76:79], 0
  ds_read_b64_tr_b16 v[118:119], v13 offset:9216
  v_mfma_f32_16x16x32_bf16 v[144:147], v[36:39], v[64:67], 0
  ds_read_b64_tr_b16 v[120:121], v14 offset:8192
  v_mfma_f32_16x16x32_bf16 v[148:151], v[36:39], v[68:71], 0
  ds_read_b64_tr_b16 v[122:123], v14 offset:9216
  v_mfma_f32_16x16x32_bf16 v[152:155], v[36:39], v[72:75], 0
  ds_read_b64_tr_b16 v[124:125], v15 offset:8192
  v_mfma_f32_16x16x32_bf16 v[156:159], v[36:39], v[76:79], 0
  ds_read_b64_tr_b16 v[126:127], v15 offset:9216
  v_mfma_f32_16x16x32_bf16 v[160:163], v[40:43], v[64:67], 0
  ds_read_b128 v[80:83], v11 offset:0
  v_mfma_f32_16x16x32_bf16 v[164:167], v[40:43], v[68:71], 0
  ds_read_b128 v[84:87], v11 offset:2048
  v_mfma_f32_16x16x32_bf16 v[168:171], v[40:43], v[72:75], 0
  ds_read_b128 v[88:91], v11 offset:4096
  v_mfma_f32_16x16x32_bf16 v[172:175], v[40:43], v[76:79], 0
  ds_read_b128 v[92:95], v11 offset:6144
  v_mfma_f32_16x16x32_bf16 v[176:179], v[44:47], v[64:67], 0
  ds_read_b128 v[96:99], v11 offset:8192
  v_mfma_f32_16x16x32_bf16 v[180:183], v[44:47], v[68:71], 0
  ds_read_b128 v[100:103], v11 offset:10240
  v_mfma_f32_16x16x32_bf16 v[184:187], v[44:47], v[72:75], 0
  ds_read_b128 v[104:107], v11 offset:12288
  v_mfma_f32_16x16x32_bf16 v[188:191], v[44:47], v[76:79], 0
  ds_read_b128 v[108:111], v11 offset:14336
  v_mfma_f32_16x16x32_bf16 v[192:195], v[48:51], v[64:67], 0
  s_add_u32 s65, s65, 1
  s_cmp_eq_u32 s65, 3
  s_cselect_b32 s66, 4294868992, s96
  s_cselect_b32 s65, 0, s65
  v_mfma_f32_16x16x32_bf16 v[196:199], v[48:51], v[68:71], 0
  v_add_u32 v10, s66, v10
  v_mfma_f32_16x16x32_bf16 v[200:203], v[48:51], v[72:75], 0
  v_add_u32 v11, s66, v11
  v_mfma_f32_16x16x32_bf16 v[204:207], v[48:51], v[76:79], 0
  v_add_u32 v12, s66, v12
  v_mfma_f32_16x16x32_bf16 v[208:211], v[52:55], v[64:67], 0
  v_add_u32 v13, s66, v13
  v_mfma_f32_16x16x32_bf16 v[212:215], v[52:55], v[68:71], 0
  v_add_u32 v14, s66, v14
  v_mfma_f32_16x16x32_bf16 v[216:219], v[52:55], v[72:75], 0
  v_add_u32 v15, s66, v15
  v_mfma_f32_16x16x32_bf16 v[220:223], v[52:55], v[76:79], 0
  v_mfma_f32_16x16x32_bf16 v[224:227], v[56:59], v[64:67], 0
  v_mfma_f32_16x16x32_bf16 v[228:231], v[56:59], v[68:71], 0
  v_mfma_f32_16x16x32_bf16 v[232:235], v[56:59], v[72:75], 0
  v_mfma_f32_16x16x32_bf16 v[236:239], v[56:59], v[76:79], 0
  v_mfma_f32_16x16x32_bf16 v[240:243], v[60:63], v[64:67], 0
  v_mfma_f32_16x16x32_bf16 v[244:247], v[60:63], v[68:71], 0
  v_mfma_f32_16x16x32_bf16 v[248:251], v[60:63], v[72:75], 0
  v_mfma_f32_16x16x32_bf16 v[252:255], v[60:63], v[76:79], 0
  s_waitcnt vmcnt(12) lgkmcnt(0)
  s_barrier
  v_mfma_f32_16x16x32_bf16 v[128:131], v[80:83], v[112:115], v[128:131]
  ds_read_b64_tr_b16 v[64:65], v12 offset:0
  v_mfma_f32_16x16x32_bf16 v[132:135], v[80:83], v[116:119], v[132:135]
  ds_read_b64_tr_b16 v[66:67], v12 offset:1024
  v_mfma_f32_16x16x32_bf16 v[136:139], v[80:83], v[120:123], v[136:139]
  s_add_u32 m0, s63, s75
  s_nop 0
  buffer_load_dwordx4 v2, s[36:39], s58 offen offset:0 sc1 lds
  v_mfma_f32_16x16x32_bf16 v[140:143], v[80:83], v[124:127], v[140:143]
  ds_read_b64_tr_b16 v[68:69], v13 offset:0
  v_mfma_f32_16x16x32_bf16 v[144:147], v[84:87], v[112:115], v[144:147]
  ds_read_b64_tr_b16 v[70:71], v13 offset:1024
  v_mfma_f32_16x16x32_bf16 v[148:151], v[84:87], v[116:119], v[148:151]
  ds_read_b64_tr_b16 v[72:73], v14 offset:0
  v_mfma_f32_16x16x32_bf16 v[152:155], v[84:87], v[120:123], v[152:155]
  ds_read_b64_tr_b16 v[74:75], v14 offset:1024
  v_mfma_f32_16x16x32_bf16 v[156:159], v[84:87], v[124:127], v[156:159]
  buffer_load_dwordx4 v3, s[36:39], s58 offen offset:1024 sc1 lds
  v_mfma_f32_16x16x32_bf16 v[160:163], v[88:91], v[112:115], v[160:163]
  ds_read_b64_tr_b16 v[76:77], v15 offset:0
  v_mfma_f32_16x16x32_bf16 v[164:167], v[88:91], v[116:119], v[164:167]
  ds_read_b64_tr_b16 v[78:79], v15 offset:1024
  v_mfma_f32_16x16x32_bf16 v[168:171], v[88:91], v[120:123], v[168:171]
  ds_read_b128 v[32:35], v10 offset:0
  v_mfma_f32_16x16x32_bf16 v[172:175], v[88:91], v[124:127], v[172:175]
  ds_read_b128 v[36:39], v10 offset:2048
  v_mfma_f32_16x16x32_bf16 v[176:179], v[92:95], v[112:115], v[176:179]
  buffer_load_dwordx4 v4, s[36:39], s58 offen offset:2048 sc1 lds
  v_mfma_f32_16x16x32_bf16 v[180:183], v[92:95], v[116:119], v[180:183]
  ds_read_b128 v[40:43], v10 offset:4096
  v_mfma_f32_16x16x32_bf16 v[184:187], v[92:95], v[120:123], v[184:187]
  ds_read_b128 v[44:47], v10 offset:6144
  v_mfma_f32_16x16x32_bf16 v[188:191], v[92:95], v[124:127], v[188:191]
  ds_read_b128 v[48:51], v10 offset:8192
  v_mfma_f32_16x16x32_bf16 v[192:195], v[96:99], v[112:115], v[192:195]
  ds_read_b128 v[52:55], v10 offset:10240
  v_mfma_f32_16x16x32_bf16 v[196:199], v[96:99], v[116:119], v[196:199]
  ds_read_b128 v[56:59], v10 offset:12288
  v_mfma_f32_16x16x32_bf16 v[200:203], v[96:99], v[120:123], v[200:203]
  buffer_load_dwordx4 v5, s[36:39], s58 offen offset:3072 sc1 lds
  v_mfma_f32_16x16x32_bf16 v[204:207], v[96:99], v[124:127], v[204:207]
  ds_read_b128 v[60:63], v10 offset:14336
  v_mfma_f32_16x16x32_bf16 v[208:211], v[100:103], v[112:115], v[208:211]
  v_mfma_f32_16x16x32_bf16 v[212:215], v[100:103], v[116:119], v[212:215]
  v_mfma_f32_16x16x32_bf16 v[216:219], v[100:103], v[120:123], v[216:219]
  v_mfma_f32_16x16x32_bf16 v[220:223], v[100:103], v[124:127], v[220:223]
  s_add_u32 m0, m0, 4096
  s_nop 0
  buffer_load_dwordx4 v2, s[36:39], s59 offen offset:0 sc1 lds
  v_mfma_f32_16x16x32_bf16 v[224:227], v[104:107], v[112:115], v[224:227]
  v_mfma_f32_16x16x32_bf16 v[228:231], v[104:107], v[116:119], v[228:231]
  v_mfma_f32_16x16x32_bf16 v[232:235], v[104:107], v[120:123], v[232:235]
  v_mfma_f32_16x16x32_bf16 v[236:239], v[104:107], v[124:127], v[236:239]
  v_mfma_f32_16x16x32_bf16 v[240:243], v[108:111], v[112:115], v[240:243]
  buffer_load_dwordx4 v3, s[36:39], s59 offen offset:1024 sc1 lds
  v_mfma_f32_16x16x32_bf16 v[244:247], v[108:111], v[116:119], v[244:247]
  v_mfma_f32_16x16x32_bf16 v[248:251], v[108:111], v[120:123], v[248:251]
  v_mfma_f32_16x16x32_bf16 v[252:255], v[108:111], v[124:127], v[252:255]
  s_sub_u32 s57, s57, 4
Lgv_loop:
  s_waitcnt lgkmcnt(0)
  v_mfma_f32_16x16x32_bf16 v[128:131], v[32:35], v[64:67], v[128:131]
  ds_read_b64_tr_b16 v[112:113], v12 offset:8192
  v_mfma_f32_16x16x32_bf16 v[132:135], v[32:35], v[68:71], v[132:135]
  ds_read_b64_tr_b16 v[114:115], v12 offset:9216
  v_mfma_f32_16x16x32_bf16 v[136:139], v[32:35], v[72:75], v[136:139]
  buffer_load_dwordx4 v4, s[36:39], s59 offen offset:2048 sc1 lds
  v_mfma_f32_16x16x32_bf16 v[140:143], v[32:35], v[76:79], v[140:143]
  ds_read_b64_tr_b16 v[116:117], v13 offset:8192
  v_mfma_f32_16x16x32_bf16 v[144:147], v[36:39], v[64:67], v[144:147]
  ds_read_b64_tr_b16 v[118:119], v13 offset:9216
  v_mfma_f32_16x16x32_bf16 v[148:151], v[36:39], v[68:71], v[148:151]
  ds_read_b64_tr_b16 v[120:121], v14 offset:8192
  v_mfma_f32_16x16x32_bf16 v[152:155], v[36:39], v[72:75], v[152:155]
  buffer_load_dwordx4 v5, s[36:39], s59 offen offset:3072 sc1 lds
  v_mfma_f32_16x16x32_bf16 v[156:159], v[36:39], v[76:79], v[156:159]
  ds_read_b64_tr_b16 v[122:123], v14 offset:9216
  v_mfma_f32_16x16x32_bf16 v[160:163], v[40:43], v[64:67], v[160:163]
  ds_read_b64_tr_b16 v[124:125], v15 offset:8192
  v_mfma_f32_16x16x32_bf16 v[164:167], v[40:43], v[68:71], v[164:167]
  ds_read_b64_tr_b16 v[126:127], v15 offset:9216
  v_mfma_f32_16x16x32_bf16 v[168:171], v[40:43], v[72:75], v[168:171]
  ds_read_b128 v[80:83], v11 offset:0
  v_mfma_f32_16x16x32_bf16 v[172:175], v[40:43], v[76:79], v[172:175]
  s_add_u32 m0, s64, s75
  s_nop 0
  buffer_load_dwordx4 v6, s[40:43], s60 offen offset:0 lds
  v_mfma_f32_16x16x32_bf16 v[176:179], v[44:47], v[64:67], v[176:179]
  ds_read_b128 v[84:87], v11 offset:2048
  v_mfma_f32_16x16x32_bf16 v[180:183], v[44:47], v[68:71], v[180:183]
  ds_read_b128 v[88:91], v11 offset:4096
  v_mfma_f32_16x16x32_bf16 v[184:187], v[44:47], v[72:75], v[184:187]
  ds_read_b128 v[92:95], v11 offset:6144
  v_mfma_f32_16x16x32_bf16 v[188:191], v[44:47], v[76:79], v[188:191]
  buffer_load_dwordx4 v7, s[40:43], s60 offen offset:1024 lds
  v_mfma_f32_16x16x32_bf16 v[192:195], v[48:51], v[64:67], v[192:195]
  ds_read_b128 v[96:99], v11 offset:8192
  v_mfma_f32_16x16x32_bf16 v[196:199], v[48:51], v[68:71], v[196:199]
  ds_read_b128 v[100:103], v11 offset:10240
  v_mfma_f32_16x16x32_bf16 v[200:203], v[48:51], v[72:75], v[200:203]
  ds_read_b128 v[104:107], v11 offset:12288
  v_mfma_f32_16x16x32_bf16 v[204:207], v[48:51], v[76:79], v[204:207]
  ds_read_b128 v[108:111], v11 offset:14336
  v_mfma_f32_16x16x32_bf16 v[208:211], v[52:55], v[64:67], v[208:211]
  buffer_load_dwordx4 v8, s[40:43], s60 offen offset:2048 lds
  v_mfma_f32_16x16x32_bf16 v[212:215], v[52:55], v[68:71], v[212:215]
  s_add_u32 s65, s65, 1
  s_cmp_eq_u32 s65, 3
  s_cselect_b32 s66, 4294868992, s96
  s_cselect_b32 s65, 0, s65
  v_mfma_f32_16x16x32_bf16 v[216:219], v[52:55], v[72:75], v[216:219]
  v_add_u32 v10, s66, v10
  v_mfma_f32_16x16x32_bf16 v[220:223], v[52:55], v[76:79], v[220:223]
  v_add_u32 v11, s66, v11
  v_mfma_f32_16x16x32_bf16 v[224:227], v[56:59], v[64:67], v[224:227]
  buffer_load_dwordx4 v9, s[40:43], s60 offen offset:3072 lds
  s_add_u32 s58, s58, s61
  s_add_u32 s59, s59, s61
  s_add_u32 s60, s60, s62
  s_sub_u32 s81, s81, 1
  s_cmp_eq_u32 s81, 0
  s_cselect_b32 s90, s88, 0
  s_cselect_b32 s91, s89, 0
  s_sub_u32 s58, s58, s90
  s_sub_u32 s59, s59, s90
  s_sub_u32 s60, s60, s91
  s_add_u32 s75, s75, 49152
  s_cmp_eq_u32 s75, 147456
  s_cselect_b32 s75, 0, s75
  v_mfma_f32_16x16x32_bf16 v[228:231], v[56:59], v[68:71], v[228:231]
  v_add_u32 v12, s66, v12
  v_mfma_f32_16x16x32_bf16 v[232:235], v[56:59], v[72:75], v[232:235]
  v_add_u32 v13, s66, v13
  v_mfma_f32_16x16x32_bf16 v[236:239], v[56:59], v[76:79], v[236:239]
  v_add_u32 v14, s66, v14
  v_mfma_f32_16x16x32_bf16 v[240:243], v[60:63], v[64:67], v[240:243]
  v_add_u32 v15, s66, v15
  v_mfma_f32_16x16x32_bf16 v[244:247], v[60:63], v[68:71], v[244:247]
  s_add_u32 m0, s80, 0
  s_add_u32 s78, s78, s79
  buffer_load_dwordx4 v1, s[44:47], s78 offen lds
  v_mfma_f32_16x16x32_bf16 v[248:251], v[60:63], v[72:75], v[248:251]
  v_mfma_f32_16x16x32_bf16 v[252:255], v[60:63], v[76:79], v[252:255]
  s_waitcnt vmcnt(13) lgkmcnt(0)
  s_barrier
  v_mfma_f32_16x16x32_bf16 v[128:131], v[80:83], v[112:115], v[128:131]
  ds_read_b64_tr_b16 v[64:65], v12 offset:0
  v_mfma_f32_16x16x32_bf16 v[132:135], v[80:83], v[116:119], v[132:135]
  ds_read_b64_tr_b16 v[66:67], v12 offset:1024
  v_mfma_f32_16x16x32_bf16 v[136:139], v[80:83], v[120:123], v[136:139]
  s_add_u32 m0, s63, s75
  s_nop 0
  buffer_load_dwordx4 v2, s[36:39], s58 offen offset:0 sc1 lds
  v_mfma_f32_16x16x32_bf16 v[140:143], v[80:83], v[124:127], v[140:143]
  ds_read_b64_tr_b16 v[68:69], v13 offset:0
  v_mfma_f32_16x16x32_bf16 v[144:147], v[84:87], v[112:115], v[144:147]
  ds_read_b64_tr_b16 v[70:71], v13 offset:1024
  v_mfma_f32_16x16x32_bf16 v[148:151], v[84:87], v[116:119], v[148:151]
  ds_read_b64_tr_b16 v[72:73], v14 offset:0
  v_mfma_f32_16x16x32_bf16 v[152:155], v[84:87], v[120:123], v[152:155]
  ds_read_b64_tr_b16 v[74:75], v14 offset:1024
  v_mfma_f32_16x16x32_bf16 v[156:159], v[84:87], v[124:127], v[156:159]
  buffer_load_dwordx4 v3, s[36:39], s58 offen offset:1024 sc1 lds
  v_mfma_f32_16x16x32_bf16 v[160:163], v[88:91], v[112:115], v[160:163]
  ds_read_b64_tr_b16 v[76:77], v15 offset:0
  v_mfma_f32_16x16x32_bf16 v[164:167], v[88:91], v[116:119], v[164:167]
  ds_read_b64_tr_b16 v[78:79], v15 offset:1024
  v_mfma_f32_16x16x32_bf16 v[168:171], v[88:91], v[120:123], v[168:171]
  ds_read_b128 v[32:35], v10 offset:0
  v_mfma_f32_16x16x32_bf16 v[172:175], v[88:91], v[124:127], v[172:175]
  ds_read_b128 v[36:39], v10 offset:2048
  v_mfma_f32_16x16x32_bf16 v[176:179], v[92:95], v[112:115], v[176:179]
  buffer_load_dwordx4 v4, s[36:39], s58 offen offset:2048 sc1 lds
  v_mfma_f32_16x16x32_bf16 v[180:183], v[92:95], v[116:119], v[180:183]
  ds_read_b128 v[40:43], v10 offset:4096
  v_mfma_f32_16x16x32_bf16 v[184:187], v[92:95], v[120:123], v[184:187]
  ds_read_b128 v[44:47], v10 offset:6144
  v_mfma_f32_16x16x32_bf16 v[188:191], v[92:95], v[124:127], v[188:191]
  ds_read_b128 v[48:51], v10 offset:8192
  v_mfma_f32_16x16x32_bf16 v[192:195], v[96:99], v[112:115], v[192:195]
  ds_read_b128 v[52:55], v10 offset:10240
  v_mfma_f32_16x16x32_bf16 v[196:199], v[96:99], v[116:119], v[196:199]
  ds_read_b128 v[56:59], v10 offset:12288
  v_mfma_f32_16x16x32_bf16 v[200:203], v[96:99], v[120:123], v[200:203]
  buffer_load_dwordx4 v5, s[36:39], s58 offen offset:3072 sc1 lds
  v_mfma_f32_16x16x32_bf16 v[204:207], v[96:99], v[124:127], v[204:207]
  ds_read_b128 v[60:63], v10 offset:14336
  v_mfma_f32_16x16x32_bf16 v[208:211], v[100:103], v[112:115], v[208:211]
  v_mfma_f32_16x16x32_bf16 v[212:215], v[100:103], v[116:119], v[212:215]
  v_mfma_f32_16x16x32_bf16 v[216:219], v[100:103], v[120:123], v[216:219]
  v_mfma_f32_16x16x32_bf16 v[220:223], v[100:103], v[124:127], v[220:223]
  s_add_u32 m0, m0, 4096
  s_nop 0
  buffer_load_dwordx4 v2, s[36:39], s59 offen offset:0 sc1 lds
  v_mfma_f32_16x16x32_bf16 v[224:227], v[104:107], v[112:115], v[224:227]
  v_mfma_f32_16x16x32_bf16 v[228:231], v[104:107], v[116:119], v[228:231]
  v_mfma_f32_16x16x32_bf16 v[232:235], v[104:107], v[120:123], v[232:235]
  v_mfma_f32_16x16x32_bf16 v[236:239], v[104:107], v[124:127], v[236:239]
  v_mfma_f32_16x16x32_bf16 v[240:243], v[108:111], v[112:115], v[240:243]
  buffer_load_dwordx4 v3, s[36:39], s59 offen offset:1024 sc1 lds
  v_mfma_f32_16x16x32_bf16 v[244:247], v[108:111], v[116:119], v[244:247]
  v_mfma_f32_16x16x32_bf16 v[248:251], v[108:111], v[120:123], v[248:251]
  v_mfma_f32_16x16x32_bf16 v[252:255], v[108:111], v[124:127], v[252:255]
  s_sub_u32 s57, s57, 1
  s_cmp_lg_u32 s57, 0
  s_cbranch_scc1 Lgv_loop
  s_waitcnt lgkmcnt(0)
  v_mfma_f32_16x16x32_bf16 v[128:131], v[32:35], v[64:67], v[128:131]
  ds_read_b64_tr_b16 v[112:113], v12 offset:8192
  v_mfma_f32_16x16x32_bf16 v[132:135], v[32:35], v[68:71], v[132:135]
  ds_read_b64_tr_b16 v[114:115], v12 offset:9216
  v_mfma_f32_16x16x32_bf16 v[136:139], v[32:35], v[72:75], v[136:139]
  buffer_load_dwordx4 v4, s[36:39], s59 offen offset:2048 sc1 lds
  v_mfma_f32_16x16x32_bf16 v[140:143], v[32:35], v[76:79], v[140:143]
  ds_read_b64_tr_b16 v[116:117], v13 offset:8192
  v_mfma_f32_16x16x32_bf16 v[144:147], v[36:39], v[64:67], v[144:147]
  ds_read_b64_tr_b16 v[118:119], v13 offset:9216
  v_mfma_f32_16x16x32_bf16 v[148:151], v[36:39], v[68:71], v[148:151]
  ds_read_b64_tr_b16 v[120:121], v14 offset:8192
  v_mfma_f32_16x16x32_bf16 v[152:155], v[36:39], v[72:75], v[152:155]
  buffer_load_dwordx4 v5, s[36:39], s59 offen offset:3072 sc1 lds
  v_mfma_f32_16x16x32_bf16 v[156:159], v[36:39], v[76:79], v[156:159]
  ds_read_b64_tr_b16 v[122:123], v14 offset:9216
  v_mfma_f32_16x16x32_bf16 v[160:163], v[40:43], v[64:67], v[160:163]
  ds_read_b64_tr_b16 v[124:125], v15 offset:8192
  v_mfma_f32_16x16x32_bf16 v[164:167], v[40:43], v[68:71], v[164:167]
  ds_read_b64_tr_b16 v[126:127], v15 offset:9216
  v_mfma_f32_16x16x32_bf16 v[168:171], v[40:43], v[72:75], v[168:171]
  ds_read_b128 v[80:83], v11 offset:0
  v_mfma_f32_16x16x32_bf16 v[172:175], v[40:43], v[76:79], v[172:175]
  s_add_u32 m0, s64, s75
  s_nop 0
  buffer_load_dwordx4 v6, s[40:43], s60 offen offset:0 lds
  v_mfma_f32_16x16x32_bf16 v[176:179], v[44:47], v[64:67], v[176:179]
  ds_read_b128 v[84:87], v11 offset:2048
  v_mfma_f32_16x16x32_bf16 v[180:183], v[44:47], v[68:71], v[180:183]
  ds_read_b128 v[88:91], v11 offset:4096
  v_mfma_f32_16x16x32_bf16 v[184:187], v[44:47], v[72:75], v[184:187]
  ds_read_b128 v[92:95], v11 offset:6144
  v_mfma_f32_16x16x32_bf16 v[188:191], v[44:47], v[76:79], v[188:191]
  buffer_load_dwordx4 v7, s[40:43], s60 offen offset:1024 lds
  v_mfma_f32_16x16x32_bf16 v[192:195], v[48:51], v[64:67], v[192:195]
  ds_read_b128 v[96:99], v11 offset:8192
  v_mfma_f32_16x16x32_bf16 v[196:199], v[48:51], v[68:71], v[196:199]
  ds_read_b128 v[100:103], v11 offset:10240
  v_mfma_f32_16x16x32_bf16 v[200:203], v[48:51], v[72:75], v[200:203]
  ds_read_b128 v[104:107], v11 offset:12288
  v_mfma_f32_16x16x32_bf16 v[204:207], v[48:51], v[76:79], v[204:207]
  ds_read_b128 v[108:111], v11 offset:14336
  v_mfma_f32_16x16x32_bf16 v[208:211], v[52:55], v[64:67], v[208:211]
  buffer_load_dwordx4 v8, s[40:43], s60 offen offset:2048 lds
  v_mfma_f32_16x16x32_bf16 v[212:215], v[52:55], v[68:71], v[212:215]
  s_add_u32 s65, s65, 1
  s_cmp_eq_u32 s65, 3
  s_cselect_b32 s66, 4294868992, s96
  s_cselect_b32 s65, 0, s65
  v_mfma_f32_16x16x32_bf16 v[216:219], v[52:55], v[72:75], v[216:219]
  v_add_u32 v10, s66, v10
  v_mfma_f32_16x16x32_bf16 v[220:223], v[52:55], v[76:79], v[220:223]
  v_add_u32 v11, s66, v11
  v_mfma_f32_16x16x32_bf16 v[224:227], v[56:59], v[64:67], v[224:227]
  buffer_load_dwordx4 v9, s[40:43], s60 offen offset:3072 lds
  s_add_u32 s58, s58, s61
  s_add_u32 s59, s59, s61
  s_add_u32 s60, s60, s62
  s_sub_u32 s81, s81, 1
  s_cmp_eq_u32 s81, 0
  s_cselect_b32 s90, s88, 0
  s_cselect_b32 s91, s89, 0
  s_sub_u32 s58, s58, s90
  s_sub_u32 s59, s59, s90
  s_sub_u32 s60, s60, s91
  s_add_u32 s75, s75, 49152
  s_cmp_eq_u32 s75, 147456
  s_cselect_b32 s75, 0, s75
  v_mfma_f32_16x16x32_bf16 v[228:231], v[56:59], v[68:71], v[228:231]
  v_add_u32 v12, s66, v12
  v_mfma_f32_16x16x32_bf16 v[232:235], v[56:59], v[72:75], v[232:235]
  v_add_u32 v13, s66, v13
  v_mfma_f32_16x16x32_bf16 v[236:239], v[56:59], v[76:79], v[236:239]
  v_add_u32 v14, s66, v14
  v_mfma_f32_16x16x32_bf16 v[240:243], v[60:63], v[64:67], v[240:243]
  v_add_u32 v15, s66, v15
  v_mfma_f32_16x16x32_bf16 v[244:247], v[60:63], v[68:71], v[244:247]
  s_add_u32 m0, s80, 0
  s_add_u32 s78, s78, s79
  buffer_load_dwordx4 v1, s[44:47], s78 offen lds
  v_mfma_f32_16x16x32_bf16 v[248:251], v[60:63], v[72:75], v[248:251]
  v_mfma_f32_16x16x32_bf16 v[252:255], v[60:63], v[76:79], v[252:255]
  s_waitcnt vmcnt(13) lgkmcnt(0)
  s_barrier
  v_mfma_f32_16x16x32_bf16 v[128:131], v[80:83], v[112:115], v[128:131]
  ds_read_b64_tr_b16 v[64:65], v12 offset:0
  v_mfma_f32_16x16x32_bf16 v[132:135], v[80:83], v[116:119], v[132:135]
  ds_read_b64_tr_b16 v[66:67], v12 offset:1024
  v_mfma_f32_16x16x32_bf16 v[136:139], v[80:83], v[120:123], v[136:139]
  ds_read_b64_tr_b16 v[68:69], v13 offset:0
  v_mfma_f32_16x16x32_bf16 v[140:143], v[80:83], v[124:127], v[140:143]
  ds_read_b64_tr_b16 v[70:71], v13 offset:1024
  v_mfma_f32_16x16x32_bf16 v[144:147], v[84:87], v[112:115], v[144:147]
  ds_read_b64_tr_b16 v[72:73], v14 offset:0
  v_mfma_f32_16x16x32_bf16 v[148:151], v[84:87], v[116:119], v[148:151]
  ds_read_b64_tr_b16 v[74:75], v14 offset:1024
  v_mfma_f32_16x16x32_bf16 v[152:155], v[84:87], v[120:123], v[152:155]
  ds_read_b64_tr_b16 v[76:77], v15 offset:0
  v_mfma_f32_16x16x32_bf16 v[156:159], v[84:87], v[124:127], v[156:159]
  ds_read_b64_tr_b16 v[78:79], v15 offset:1024
  v_mfma_f32_16x16x32_bf16 v[160:163], v[88:91], v[112:115], v[160:163]
  ds_read_b128 v[32:35], v10 offset:0
  v_mfma_f32_16x16x32_bf16 v[164:167], v[88:91], v[116:119], v[164:167]
  ds_read_b128 v[36:39], v10 offset:2048
  v_mfma_f32_16x16x32_bf16 v[168:171], v[88:91], v[120:123], v[168:171]
  ds_read_b128 v[40:43], v10 offset:4096
  v_mfma_f32_16x16x32_bf16 v[172:175], v[88:91], v[124:127], v[172:175]
  ds_read_b128 v[44:47], v10 offset:6144
  v_mfma_f32_16x16x32_bf16 v[176:179], v[92:95], v[112:115], v[176:179]
  ds_read_b128 v[48:51], v10 offset:8192
  v_mfma_f32_16x16x32_bf16 v[180:183], v[92:95], v[116:119], v[180:183]
  ds_read_b128 v[52:55], v10 offset:10240
  v_mfma_f32_16x16x32_bf16 v[184:187], v[92:95], v[120:123], v[184:187]
  ds_read_b128 v[56:59], v10 offset:12288
  v_mfma_f32_16x16x32_bf16 v[188:191], v[92:95], v[124:127], v[188:191]
  ds_read_b128 v[60:63], v10 offset:14336
  v_mfma_f32_16x16x32_bf16 v[192:195], v[96:99], v[112:115], v[192:195]
  v_mfma_f32_16x16x32_bf16 v[196:199], v[96:99], v[116:119], v[196:199]
  v_mfma_f32_16x16x32_bf16 v[200:203], v[96:99], v[120:123], v[200:203]
  v_mfma_f32_16x16x32_bf16 v[204:207], v[96:99], v[124:127], v[204:207]
  v_mfma_f32_16x16x32_bf16 v[208:211], v[100:103], v[112:115], v[208:211]
  v_mfma_f32_16x16x32_bf16 v[212:215], v[100:103], v[116:119], v[212:215]
  v_mfma_f32_16x16x32_bf16 v[216:219], v[100:103], v[120:123], v[216:219]
  v_mfma_f32_16x16x32_bf16 v[220:223], v[100:103], v[124:127], v[220:223]
  v_mfma_f32_16x16x32_bf16 v[224:227], v[104:107], v[112:115], v[224:227]
  v_mfma_f32_16x16x32_bf16 v[228:231], v[104:107], v[116:119], v[228:231]
  v_mfma_f32_16x16x32_bf16 v[232:235], v[104:107], v[120:123], v[232:235]
  v_mfma_f32_16x16x32_bf16 v[236:239], v[104:107], v[124:127], v[236:239]
  v_mfma_f32_16x16x32_bf16 v[240:243], v[108:111], v[112:115], v[240:243]
  v_mfma_f32_16x16x32_bf16 v[244:247], v[108:111], v[116:119], v[244:247]
  v_mfma_f32_16x16x32_bf16 v[248:251], v[108:111], v[120:123], v[248:251]
  v_mfma_f32_16x16x32_bf16 v[252:255], v[108:111], v[124:127], v[252:255]
  s_waitcnt lgkmcnt(0)
  v_mfma_f32_16x16x32_bf16 v[128:131], v[32:35], v[64:67], v[128:131]
  ds_read_b64_tr_b16 v[112:113], v12 offset:8192
  v_mfma_f32_16x16x32_bf16 v[132:135], v[32:35], v[68:71], v[132:135]
  ds_read_b64_tr_b16 v[114:115], v12 offset:9216
  v_mfma_f32_16x16x32_bf16 v[136:139], v[32:35], v[72:75], v[136:139]
  ds_read_b64_tr_b16 v[116:117], v13 offset:8192
  v_mfma_f32_16x16x32_bf16 v[140:143], v[32:35], v[76:79], v[140:143]
  ds_read_b64_tr_b16 v[118:119], v13 offset:9216
  v_mfma_f32_16x16x32_bf16 v[144:147], v[36:39], v[64:67], v[144:147]
  ds_read_b64_tr_b16 v[120:121], v14 offset:8192
  v_mfma_f32_16x16x32_bf16 v[148:151], v[36:39], v[68:71], v[148:151]
  ds_read_b64_tr_b16 v[122:123], v14 offset:9216
  v_mfma_f32_16x16x32_bf16 v[152:155], v[36:39], v[72:75], v[152:155]
  ds_read_b64_tr_b16 v[124:125], v15 offset:8192
  v_mfma_f32_16x16x32_bf16 v[156:159], v[36:39], v[76:79], v[156:159]
  ds_read_b64_tr_b16 v[126:127], v15 offset:9216
  v_mfma_f32_16x16x32_bf16 v[160:163], v[40:43], v[64:67], v[160:163]
  ds_read_b128 v[80:83], v11 offset:0
  v_mfma_f32_16x16x32_bf16 v[164:167], v[40:43], v[68:71], v[164:167]
  ds_read_b128 v[84:87], v11 offset:2048
  v_mfma_f32_16x16x32_bf16 v[168:171], v[40:43], v[72:75], v[168:171]
  ds_read_b128 v[88:91], v11 offset:4096
  v_mfma_f32_16x16x32_bf16 v[172:175], v[40:43], v[76:79], v[172:175]
  ds_read_b128 v[92:95], v11 offset:6144
  v_mfma_f32_16x16x32_bf16 v[176:179], v[44:47], v[64:67], v[176:179]
  ds_read_b128 v[96:99], v11 offset:8192
  v_mfma_f32_16x16x32_bf16 v[180:183], v[44:47], v[68:71], v[180:183]
  ds_read_b128 v[100:103], v11 offset:10240
  v_mfma_f32_16x16x32_bf16 v[184:187], v[44:47], v[72:75], v[184:187]
  ds_read_b128 v[104:107], v11 offset:12288
  v_mfma_f32_16x16x32_bf16 v[188:191], v[44:47], v[76:79], v[188:191]
  ds_read_b128 v[108:111], v11 offset:14336
  v_mfma_f32_16x16x32_bf16 v[192:195], v[48:51], v[64:67], v[192:195]
  s_add_u32 s65, s65, 1
  s_cmp_eq_u32 s65, 3
  s_cselect_b32 s66, 4294868992, s96
  s_cselect_b32 s65, 0, s65
  v_mfma_f32_16x16x32_bf16 v[196:199], v[48:51], v[68:71], v[196:199]
  v_add_u32 v10, s66, v10
  v_mfma_f32_16x16x32_bf16 v[200:203], v[48:51], v[72:75], v[200:203]
  v_add_u32 v11, s66, v11
  v_mfma_f32_16x16x32_bf16 v[204:207], v[48:51], v[76:79], v[204:207]
  v_add_u32 v12, s66, v12
  v_mfma_f32_16x16x32_bf16 v[208:211], v[52:55], v[64:67], v[208:211]
  v_add_u32 v13, s66, v13
  v_mfma_f32_16x16x32_bf16 v[212:215], v[52:55], v[68:71], v[212:215]
  v_add_u32 v14, s66, v14
  v_mfma_f32_16x16x32_bf16 v[216:219], v[52:55], v[72:75], v[216:219]
  v_add_u32 v15, s66, v15
  v_mfma_f32_16x16x32_bf16 v[220:223], v[52:55], v[76:79], v[220:223]
  v_mfma_f32_16x16x32_bf16 v[224:227], v[56:59], v[64:67], v[224:227]
  v_mfma_f32_16x16x32_bf16 v[228:231], v[56:59], v[68:71], v[228:231]
  v_mfma_f32_16x16x32_bf16 v[232:235], v[56:59], v[72:75], v[232:235]
  v_mfma_f32_16x16x32_bf16 v[236:239], v[56:59], v[76:79], v[236:239]
  v_mfma_f32_16x16x32_bf16 v[240:243], v[60:63], v[64:67], v[240:243]
  v_mfma_f32_16x16x32_bf16 v[244:247], v[60:63], v[68:71], v[244:247]
  v_mfma_f32_16x16x32_bf16 v[248:251], v[60:63], v[72:75], v[248:251]
  v_mfma_f32_16x16x32_bf16 v[252:255], v[60:63], v[76:79], v[252:255]
  s_waitcnt vmcnt(0) lgkmcnt(0)
  s_barrier
  v_mfma_f32_16x16x32_bf16 v[128:131], v[80:83], v[112:115], v[128:131]
  ds_read_b64_tr_b16 v[64:65], v12 offset:0
  v_mfma_f32_16x16x32_bf16 v[132:135], v[80:83], v[116:119], v[132:135]
  ds_read_b64_tr_b16 v[66:67], v12 offset:1024
  v_mfma_f32_16x16x32_bf16 v[136:139], v[80:83], v[120:123], v[136:139]
  ds_read_b64_tr_b16 v[68:69], v13 offset:0
  v_mfma_f32_16x16x32_bf16 v[140:143], v[80:83], v[124:127], v[140:143]
  ds_read_b64_tr_b16 v[70:71], v13 offset:1024
  v_mfma_f32_16x16x32_bf16 v[144:147], v[84:87], v[112:115], v[144:147]
  ds_read_b64_tr_b16 v[72:73], v14 offset:0
  v_mfma_f32_16x16x32_bf16 v[148:151], v[84:87], v[116:119], v[148:151]
  ds_read_b64_tr_b16 v[74:75], v14 offset:1024
  v_mfma_f32_16x16x32_bf16 v[152:155], v[84:87], v[120:123], v[152:155]
  ds_read_b64_tr_b16 v[76:77], v15 offset:0
  v_mfma_f32_16x16x32_bf16 v[156:159], v[84:87], v[124:127], v[156:159]
  ds_read_b64_tr_b16 v[78:79], v15 offset:1024
  v_mfma_f32_16x16x32_bf16 v[160:163], v[88:91], v[112:115], v[160:163]
  ds_read_b128 v[32:35], v10 offset:0
  v_mfma_f32_16x16x32_bf16 v[164:167], v[88:91], v[116:119], v[164:167]
  ds_read_b128 v[36:39], v10 offset:2048
  v_mfma_f32_16x16x32_bf16 v[168:171], v[88:91], v[120:123], v[168:171]
  ds_read_b128 v[40:43], v10 offset:4096
  v_mfma_f32_16x16x32_bf16 v[172:175], v[88:91], v[124:127], v[172:175]
  ds_read_b128 v[44:47], v10 offset:6144
  v_mfma_f32_16x16x32_bf16 v[176:179], v[92:95], v[112:115], v[176:179]
  ds_read_b128 v[48:51], v10 offset:8192
  v_mfma_f32_16x16x32_bf16 v[180:183], v[92:95], v[116:119], v[180:183]
  ds_read_b128 v[52:55], v10 offset:10240
  v_mfma_f32_16x16x32_bf16 v[184:187], v[92:95], v[120:123], v[184:187]
  ds_read_b128 v[56:59], v10 offset:12288
  v_mfma_f32_16x16x32_bf16 v[188:191], v[92:95], v[124:127], v[188:191]
  ds_read_b128 v[60:63], v10 offset:14336
  v_mfma_f32_16x16x32_bf16 v[192:195], v[96:99], v[112:115], v[192:195]
  v_mfma_f32_16x16x32_bf16 v[196:199], v[96:99], v[116:119], v[196:199]
  v_mfma_f32_16x16x32_bf16 v[200:203], v[96:99], v[120:123], v[200:203]
  v_mfma_f32_16x16x32_bf16 v[204:207], v[96:99], v[124:127], v[204:207]
  v_mfma_f32_16x16x32_bf16 v[208:211], v[100:103], v[112:115], v[208:211]
  v_mfma_f32_16x16x32_bf16 v[212:215], v[100:103], v[116:119], v[212:215]
  v_mfma_f32_16x16x32_bf16 v[216:219], v[100:103], v[120:123], v[216:219]
  v_mfma_f32_16x16x32_bf16 v[220:223], v[100:103], v[124:127], v[220:223]
  v_mfma_f32_16x16x32_bf16 v[224:227], v[104:107], v[112:115], v[224:227]
  v_mfma_f32_16x16x32_bf16 v[228:231], v[104:107], v[116:119], v[228:231]
  v_mfma_f32_16x16x32_bf16 v[232:235], v[104:107], v[120:123], v[232:235]
  v_mfma_f32_16x16x32_bf16 v[236:239], v[104:107], v[124:127], v[236:239]
  v_mfma_f32_16x16x32_bf16 v[240:243], v[108:111], v[112:115], v[240:243]
  v_mfma_f32_16x16x32_bf16 v[244:247], v[108:111], v[116:119], v[244:247]
  v_mfma_f32_16x16x32_bf16 v[248:251], v[108:111], v[120:123], v[248:251]
  v_mfma_f32_16x16x32_bf16 v[252:255], v[108:111], v[124:127], v[252:255]
  s_waitcnt lgkmcnt(0)
  v_mfma_f32_16x16x32_bf16 v[128:131], v[32:35], v[64:67], v[128:131]
  ds_read_b64_tr_b16 v[112:113], v12 offset:8192
  v_mfma_f32_16x16x32_bf16 v[132:135], v[32:35], v[68:71], v[132:135]
  ds_read_b64_tr_b16 v[114:115], v12 offset:9216
  v_mfma_f32_16x16x32_bf16 v[136:139], v[32:35], v[72:75], v[136:139]
  ds_read_b64_tr_b16 v[116:117], v13 offset:8192
  v_mfma_f32_16x16x32_bf16 v[140:143], v[32:35], v[76:79], v[140:143]
  ds_read_b64_tr_b16 v[118:119], v13 offset:9216
  v_mfma_f32_16x16x32_bf16 v[144:147], v[36:39], v[64:67], v[144:147]
  ds_read_b64_tr_b16 v[120:121], v14 offset:8192
  v_mfma_f32_16x16x32_bf16 v[148:151], v[36:39], v[68:71], v[148:151]
  ds_read_b64_tr_b16 v[122:123], v14 offset:9216
  v_mfma_f32_16x16x32_bf16 v[152:155], v[36:39], v[72:75], v[152:155]
  ds_read_b64_tr_b16 v[124:125], v15 offset:8192
  v_mfma_f32_16x16x32_bf16 v[156:159], v[36:39], v[76:79], v[156:159]
  ds_read_b64_tr_b16 v[126:127], v15 offset:9216
  v_mfma_f32_16x16x32_bf16 v[160:163], v[40:43], v[64:67], v[160:163]
  ds_read_b128 v[80:83], v11 offset:0
  v_mfma_f32_16x16x32_bf16 v[164:167], v[40:43], v[68:71], v[164:167]
  ds_read_b128 v[84:87], v11 offset:2048
  v_mfma_f32_16x16x32_bf16 v[168:171], v[40:43], v[72:75], v[168:171]
  ds_read_b128 v[88:91], v11 offset:4096
  v_mfma_f32_16x16x32_bf16 v[172:175], v[40:43], v[76:79], v[172:175]
  ds_read_b128 v[92:95], v11 offset:6144
  v_mfma_f32_16x16x32_bf16 v[176:179], v[44:47], v[64:67], v[176:179]
  ds_read_b128 v[96:99], v11 offset:8192
  v_mfma_f32_16x16x32_bf16 v[180:183], v[44:47], v[68:71], v[180:183]
  ds_read_b128 v[100:103], v11 offset:10240
  v_mfma_f32_16x16x32_bf16 v[184:187], v[44:47], v[72:75], v[184:187]
  ds_read_b128 v[104:107], v11 offset:12288
  v_mfma_f32_16x16x32_bf16 v[188:191], v[44:47], v[76:79], v[188:191]
  ds_read_b128 v[108:111], v11 offset:14336
  v_mfma_f32_16x16x32_bf16 v[192:195], v[48:51], v[64:67], v[192:195]
  v_mfma_f32_16x16x32_bf16 v[196:199], v[48:51], v[68:71], v[196:199]
  v_mfma_f32_16x16x32_bf16 v[200:203], v[48:51], v[72:75], v[200:203]
  v_mfma_f32_16x16x32_bf16 v[204:207], v[48:51], v[76:79], v[204:207]
  v_mfma_f32_16x16x32_bf16 v[208:211], v[52:55], v[64:67], v[208:211]
  v_mfma_f32_16x16x32_bf16 v[212:215], v[52:55], v[68:71], v[212:215]
  v_mfma_f32_16x16x32_bf16 v[216:219], v[52:55], v[72:75], v[216:219]
  v_mfma_f32_16x16x32_bf16 v[220:223], v[52:55], v[76:79], v[220:223]
  v_mfma_f32_16x16x32_bf16 v[224:227], v[56:59], v[64:67], v[224:227]
  v_mfma_f32_16x16x32_bf16 v[228:231], v[56:59], v[68:71], v[228:231]
  v_mfma_f32_16x16x32_bf16 v[232:235], v[56:59], v[72:75], v[232:235]
  v_mfma_f32_16x16x32_bf16 v[236:239], v[56:59], v[76:79], v[236:239]
  v_mfma_f32_16x16x32_bf16 v[240:243], v[60:63], v[64:67], v[240:243]
  v_mfma_f32_16x16x32_bf16 v[244:247], v[60:63], v[68:71], v[244:247]
  v_mfma_f32_16x16x32_bf16 v[248:251], v[60:63], v[72:75], v[248:251]
  v_mfma_f32_16x16x32_bf16 v[252:255], v[60:63], v[76:79], v[252:255]
  s_waitcnt lgkmcnt(0)
  v_mfma_f32_16x16x32_bf16 v[128:131], v[80:83], v[112:115], v[128:131]
  v_mfma_f32_16x16x32_bf16 v[132:135], v[80:83], v[116:119], v[132:135]
  v_mfma_f32_16x16x32_bf16 v[136:139], v[80:83], v[120:123], v[136:139]
  v_mfma_f32_16x16x32_bf16 v[140:143], v[80:83], v[124:127], v[140:143]
  v_mfma_f32_16x16x32_bf16 v[144:147], v[84:87], v[112:115], v[144:147]
  v_mfma_f32_16x16x32_bf16 v[148:151], v[84:87], v[116:119], v[148:151]
  v_mfma_f32_16x16x32_bf16 v[152:155], v[84:87], v[120:123], v[152:155]
  v_mfma_f32_16x16x32_bf16 v[156:159], v[84:87], v[124:127], v[156:159]
  v_mfma_f32_16x16x32_bf16 v[160:163], v[88:91], v[112:115], v[160:163]
  v_mfma_f32_16x16x32_bf16 v[164:167], v[88:91], v[116:119], v[164:167]
  v_mfma_f32_16x16x32_bf16 v[168:171], v[88:91], v[120:123], v[168:171]
  v_mfma_f32_16x16x32_bf16 v[172:175], v[88:91], v[124:127], v[172:175]
  v_mfma_f32_16x16x32_bf16 v[176:179], v[92:95], v[112:115], v[176:179]
  v_mfma_f32_16x16x32_bf16 v[180:183], v[92:95], v[116:119], v[180:183]
  v_mfma_f32_16x16x32_bf16 v[184:187], v[92:95], v[120:123], v[184:187]
  v_mfma_f32_16x16x32_bf16 v[188:191], v[92:95], v[124:127], v[188:191]
  v_mfma_f32_16x16x32_bf16 v[192:195], v[96:99], v[112:115], v[192:195]
  v_mfma_f32_16x16x32_bf16 v[196:199], v[96:99], v[116:119], v[196:199]
  v_mfma_f32_16x16x32_bf16 v[200:203], v[96:99], v[120:123], v[200:203]
  v_mfma_f32_16x16x32_bf16 v[204:207], v[96:99], v[124:127], v[204:207]
  v_mfma_f32_16x16x32_bf16 v[208:211], v[100:103], v[112:115], v[208:211]
  v_mfma_f32_16x16x32_bf16 v[212:215], v[100:103], v[116:119], v[212:215]
  v_mfma_f32_16x16x32_bf16 v[216:219], v[100:103], v[120:123], v[216:219]
  v_mfma_f32_16x16x32_bf16 v[220:223], v[100:103], v[124:127], v[220:223]
  v_mfma_f32_16x16x32_bf16 v[224:227], v[104:107], v[112:115], v[224:227]
  v_mfma_f32_16x16x32_bf16 v[228:231], v[104:107], v[116:119], v[228:231]
  v_mfma_f32_16x16x32_bf16 v[232:235], v[104:107], v[120:123], v[232:235]
  v_mfma_f32_16x16x32_bf16 v[236:239], v[104:107], v[124:127], v[236:239]
  v_mfma_f32_16x16x32_bf16 v[240:243], v[108:111], v[112:115], v[240:243]
  v_mfma_f32_16x16x32_bf16 v[244:247], v[108:111], v[116:119], v[244:247]
  v_mfma_f32_16x16x32_bf16 v[248:251], v[108:111], v[120:123], v[248:251]
  v_mfma_f32_16x16x32_bf16 v[252:255], v[108:111], v[124:127], v[252:255]
  s_branch Lnext
Lgemm_half:
  s_cmp_eq_u32 s54, 2
  s_cbranch_scc1 Lgemm_hv
  s_waitcnt vmcnt(16)
  s_barrier
  ds_read_b64_tr_b16 v[64:65], v12 offset:0
  ds_read_b64_tr_b16 v[66:67], v12 offset:1024
  ds_read_b64_tr_b16 v[68:69], v13 offset:0
  ds_read_b64_tr_b16 v[70:71], v13 offset:1024
  ds_read_b64_tr_b16 v[72:73], v14 offset:0
  ds_read_b64_tr_b16 v[74:75], v14 offset:1024
  ds_read_b64_tr_b16 v[76:77], v15 offset:0
  ds_read_b64_tr_b16 v[78:79], v15 offset:1024
  ds_read_b128 v[32:35], v10 offset:0
  ds_read_b128 v[36:39], v10 offset:2048
  ds_read_b128 v[40:43], v10 offset:4096
  ds_read_b128 v[44:47], v10 offset:6144
  s_waitcnt lgkmcnt(8)
  s_waitcnt lgkmcnt(0)
  v_mfma_f32_16x16x32_bf16 v[128:131], v[64:67], v[32:35], 0
  ds_read_b64_tr_b16 v[112:113], v12 offset:8192
  v_mfma_f32_16x16x32_bf16 v[132:135], v[68:71], v[32:35], 0
  ds_read_b64_tr_b16 v[114:115], v12 offset:9216
  v_mfma_f32_16x16x32_bf16 v[136:139], v[72:75], v[32:35], 0
  ds_read_b64_tr_b16 v[116:117], v13 offset:8192
  v_mfma_f32_16x16x32_bf16 v[140:143], v[76:79], v[32:35], 0
  ds_read_b64_tr_b16 v[118:119], v13 offset:9216
  v_mfma_f32_16x16x32_bf16 v[144:147], v[64:67], v[36:39], 0
  ds_read_b64_tr_b16 v[120:121], v14 offset:8192
  v_mfma_f32_16x16x32_bf16 v[148:151], v[68:71], v[36:39], 0
  ds_read_b64_tr_b16 v[122:123], v14 offset:9216
  v_mfma_f32_16x16x32_bf16 v[152:155], v[72:75], v[36:39], 0
  ds_read_b64_tr_b16 v[124:125], v15 offset:8192
  v_mfma_f32_16x16x32_bf16 v[156:159], v[76:79], v[36:39], 0
  ds_read_b64_tr_b16 v[126:127], v15 offset:9216
  v_mfma_f32_16x16x32_bf16 v[160:163], v[64:67], v[40:43], 0
  ds_read_b128 v[80:83], v11 offset:0
  v_mfma_f32_16x16x32_bf16 v[164:167], v[68:71], v[40:43], 0
  ds_read_b128 v[84:87], v11 offset:2048
  v_mfma_f32_16x16x32_bf16 v[168:171], v[72:75], v[40:43], 0
  ds_read_b128 v[88:91], v11 offset:4096
  v_mfma_f32_16x16x32_bf16 v[172:175], v[76:79], v[40:43], 0
  ds_read_b128 v[92:95], v11 offset:6144
  v_mfma_f32_16x16x32_bf16 v[176:179], v[64:67], v[44:47], 0
  s_add_u32 s65, s65, 1
  s_cmp_eq_u32 s65, 3
  s_cselect_b32 s66, 4294868992, s96
  s_cselect_b32 s65, 0, s65
  v_mfma_f32_16x16x32_bf16 v[180:183], v[68:71], v[44:47], 0
  v_add_u32 v10, s66, v10
  v_mfma_f32_16x16x32_bf16 v[184:187], v[72:75], v[44:47], 0
  v_add_u32 v11, s66, v11
  v_mfma_f32_16x16x32_bf16 v[188:191], v[76:79], v[44:47], 0
  v_add_u32 v12, s66, v12
  v_add_u32 v13, s66, v13
  v_add_u32 v14, s66, v14
  v_add_u32 v15, s66, v15
  s_waitcnt vmcnt(8) lgkmcnt(0)
  s_barrier
  v_mfma_f32_16x16x32_bf16 v[128:131], v[112:115], v[80:83], v[128:131]
  ds_read_b64_tr_b16 v[64:65], v12 offset:0
  v_mfma_f32_16x16x32_bf16 v[132:135], v[116:119], v[80:83], v[132:135]
  ds_read_b64_tr_b16 v[66:67], v12 offset:1024
  v_mfma_f32_16x16x32_bf16 v[136:139], v[120:123], v[80:83], v[136:139]
  s_add_u32 m0, s63, s75
  s_nop 0
  buffer_load_dwordx4 v2, s[36:39], s58 offen offset:0 sc1 lds
  v_mfma_f32_16x16x32_bf16 v[140:143], v[124:127], v[80:83], v[140:143]
  ds_read_b64_tr_b16 v[68:69], v13 offset:0
  v_mfma_f32_16x16x32_bf16 v[144:147], v[112:115], v[84:87], v[144:147]
  ds_read_b64_tr_b16 v[70:71], v13 offset:1024
  v_mfma_f32_16x16x32_bf16 v[148:151], v[116:119], v[84:87], v[148:151]
  ds_read_b64_tr_b16 v[72:73], v14 offset:0
  v_mfma_f32_16x16x32_bf16 v[152:155], v[120:123], v[84:87], v[152:155]
  buffer_load_dwordx4 v3, s[36:39], s58 offen offset:1024 sc1 lds
  v_mfma_f32_16x16x32_bf16 v[156:159], v[124:127], v[84:87], v[156:159]
  ds_read_b64_tr_b16 v[74:75], v14 offset:1024
  v_mfma_f32_16x16x32_bf16 v[160:163], v[112:115], v[88:91], v[160:163]
  ds_read_b64_tr_b16 v[76:77], v15 offset:0
  v_mfma_f32_16x16x32_bf16 v[164:167], v[116:119], v[88:91], v[164:167]
  ds_read_b64_tr_b16 v[78:79], v15 offset:1024
  v_mfma_f32_16x16x32_bf16 v[168:171], v[120:123], v[88:91], v[168:171]
  buffer_load_dwordx4 v4, s[36:39], s58 offen offset:2048 sc1 lds
  v_mfma_f32_16x16x32_bf16 v[172:175], v[124:127], v[88:91], v[172:175]
  ds_read_b128 v[32:35], v10 offset:0
  v_mfma_f32_16x16x32_bf16 v[176:179], v[112:115], v[92:95], v[176:179]
  ds_read_b128 v[36:39], v10 offset:2048
  v_mfma_f32_16x16x32_bf16 v[180:183], v[116:119], v[92:95], v[180:183]
  ds_read_b128 v[40:43], v10 offset:4096
  v_mfma_f32_16x16x32_bf16 v[184:187], v[120:123], v[92:95], v[184:187]
  buffer_load_dwordx4 v5, s[36:39], s58 offen offset:3072 sc1 lds
  v_mfma_f32_16x16x32_bf16 v[188:191], v[124:127], v[92:95], v[188:191]
  ds_read_b128 v[44:47], v10 offset:6144
  s_sub_u32 s57, s57, 4
Lhn_loop:
  s_waitcnt lgkmcnt(0)
  v_mfma_f32_16x16x32_bf16 v[128:131], v[64:67], v[32:35], v[128:131]
  ds_read_b64_tr_b16 v[112:113], v12 offset:8192
  v_mfma_f32_16x16x32_bf16 v[132:135], v[68:71], v[32:35], v[132:135]
  ds_read_b64_tr_b16 v[114:115], v12 offset:9216
  v_mfma_f32_16x16x32_bf16 v[136:139], v[72:75], v[32:35], v[136:139]
  s_add_u32 m0, s64, s75
  s_nop 0
  buffer_load_dwordx4 v6, s[40:43], s60 offen offset:0 lds
  v_mfma_f32_16x16x32_bf16 v[140:143], v[76:79], v[32:35], v[140:143]
  ds_read_b64_tr_b16 v[116:117], v13 offset:8192
  v_mfma_f32_16x16x32_bf16 v[144:147], v[64:67], v[36:39], v[144:147]
  ds_read_b64_tr_b16 v[118:119], v13 offset:9216
  v_mfma_f32_16x16x32_bf16 v[148:151], v[68:71], v[36:39], v[148:151]
  buffer_load_dwordx4 v7, s[40:43], s60 offen offset:1024 lds
  v_mfma_f32_16x16x32_bf16 v[152:155], v[72:75], v[36:39], v[152:155]
  ds_read_b64_tr_b16 v[120:121], v14 offset:8192
  v_mfma_f32_16x16x32_bf16 v[156:159], v[76:79], v[36:39], v[156:159]
  ds_read_b64_tr_b16 v[122:123], v14 offset:9216
  v_mfma_f32_16x16x32_bf16 v[160:163], v[64:67], v[40:43], v[160:163]
  buffer_load_dwordx4 v8, s[40:43], s60 offen offset:2048 lds
  v_mfma_f32_16x16x32_bf16 v[164:167], v[68:71], v[40:43], v[164:167]
  ds_read_b64_tr_b16 v[124:125], v15 offset:8192
  v_mfma_f32_16x16x32_bf16 v[168:171], v[72:75], v[40:43], v[168:171]
  ds_read_b64_tr_b16 v[126:127], v15 offset:9216
  v_mfma_f32_16x16x32_bf16 v[172:175], v[76:79], v[40:43], v[172:175]
  buffer_load_dwordx4 v9, s[40:43], s60 offen offset:3072 lds
  s_add_u32 s58, s58, s61
  s_add_u32 s59, s59, s61
  s_add_u32 s60, s60, s62
  s_sub_u32 s81, s81, 1
  s_cmp_eq_u32 s81, 0
  s_cselect_b32 s90, s88, 0
  s_cselect_b32 s91, s89, 0
  s_sub_u32 s58, s58, s90
  s_sub_u32 s59, s59, s90
  s_sub_u32 s60, s60, s91
  s_add_u32 s75, s75, 49152
  s_cmp_eq_u32 s75, 147456
  s_cselect_b32 s75, 0, s75
  v_mfma_f32_16x16x32_bf16 v[176:179], v[64:67], v[44:47], v[176:179]
  ds_read_b128 v[80:83], v11 offset:0
  v_mfma_f32_16x16x32_bf16 v[180:183], v[68:71], v[44:47], v[180:183]
  ds_read_b128 v[84:87], v11 offset:2048
  v_mfma_f32_16x16x32_bf16 v[184:187], v[72:75], v[44:47], v[184:187]
  s_add_u32 m0, s80, 0
  s_add_u32 s78, s78, s79
  buffer_load_dwordx4 v1, s[44:47], s78 offen lds
  v_mfma_f32_16x16x32_bf16 v[188:191], v[76:79], v[44:47], v[188:191]
  ds_read_b128 v[88:91], v11 offset:4096
  ds_read_b128 v[92:95], v11 offset:6144
  s_add_u32 s65, s65, 1
  s_cmp_eq_u32 s65, 3
  s_cselect_b32 s66, 4294868992, s96
  s_cselect_b32 s65, 0, s65
  v_add_u32 v10, s66, v10
  v_add_u32 v11, s66, v11
  v_add_u32 v12, s66, v12
  v_add_u32 v13, s66, v13
  v_add_u32 v14, s66, v14
  v_add_u32 v15, s66, v15
  s_waitcnt vmcnt(9) lgkmcnt(0)
  s_barrier
  v_mfma_f32_16x16x32_bf16 v[128:131], v[112:115], v[80:83], v[128:131]
  ds_read_b64_tr_b16 v[64:65], v12 offset:0
  v_mfma_f32_16x16x32_bf16 v[132:135], v[116:119], v[80:83], v[132:135]
  ds_read_b64_tr_b16 v[66:67], v12 offset:1024
  v_mfma_f32_16x16x32_bf16 v[136:139], v[120:123], v[80:83], v[136:139]
  s_add_u32 m0, s63, s75
  s_nop 0
  buffer_load_dwordx4 v2, s[36:39], s58 offen offset:0 sc1 lds
  v_mfma_f32_16x16x32_bf16 v[140:143], v[124:127], v[80:83], v[140:143]
  ds_read_b64_tr_b16 v[68:69], v13 offset:0
  v_mfma_f32_16x16x32_bf16 v[144:147], v[112:115], v[84:87], v[144:147]
  ds_read_b64_tr_b16 v[70:71], v13 offset:1024
  v_mfma_f32_16x16x32_bf16 v[148:151], v[116:119], v[84:87], v[148:151]
  ds_read_b64_tr_b16 v[72:73], v14 offset:0
  v_mfma_f32_16x16x32_bf16 v[152:155], v[120:123], v[84:87], v[152:155]
  buffer_load_dwordx4 v3, s[36:39], s58 offen offset:1024 sc1 lds
  v_mfma_f32_16x16x32_bf16 v[156:159], v[124:127], v[84:87], v[156:159]
  ds_read_b64_tr_b16 v[74:75], v14 offset:1024
  v_mfma_f32_16x16x32_bf16 v[160:163], v[112:115], v[88:91], v[160:163]
  ds_read_b64_tr_b16 v[76:77], v15 offset:0
  v_mfma_f32_16x16x32_bf16 v[164:167], v[116:119], v[88:91], v[164:167]
  ds_read_b64_tr_b16 v[78:79], v15 offset:1024
  v_mfma_f32_16x16x32_bf16 v[168:171], v[120:123], v[88:91], v[168:171]
  buffer_load_dwordx4 v4, s[36:39], s58 offen offset:2048 sc1 lds
  v_mfma_f32_16x16x32_bf16 v[172:175], v[124:127], v[88:91], v[172:175]
  ds_read_b128 v[32:35], v10 offset:0
  v_mfma_f32_16x16x32_bf16 v[176:179], v[112:115], v[92:95], v[176:179]
  ds_read_b128 v[36:39], v10 offset:2048
  v_mfma_f32_16x16x32_bf16 v[180:183], v[116:119], v[92:95], v[180:183]
  ds_read_b128 v[40:43], v10 offset:4096
  v_mfma_f32_16x16x32_bf16 v[184:187], v[120:123], v[92:95], v[184:187]
  buffer_load_dwordx4 v5, s[36:39], s58 offen offset:3072 sc1 lds
  v_mfma_f32_16x16x32_bf16 v[188:191], v[124:127], v[92:95], v[188:191]
  ds_read_b128 v[44:47], v10 offset:6144
  s_sub_u32 s57, s57, 1
  s_cmp_lg_u32 s57, 0
  s_cbranch_scc1 Lhn_loop
  s_waitcnt lgkmcnt(0)
  v_mfma_f32_16x16x32_bf16 v[128:131], v[64:67], v[32:35], v[128:131]
  ds_read_b64_tr_b16 v[112:113], v12 offset:8192
  v_mfma_f32_16x16x32_bf16 v[132:135], v[68:71], v[32:35], v[132:135]
  ds_read_b64_tr_b16 v[114:115], v12 offset:9216
  v_mfma_f32_16x16x32_bf16 v[136:139], v[72:75], v[32:35], v[136:139]
  s_add_u32 m0, s64, s75
  s_nop 0
  buffer_load_dwordx4 v6, s[40:43], s60 offen offset:0 lds
  v_mfma_f32_16x16x32_bf16 v[140:143], v[76:79], v[32:35], v[140:143]
  ds_read_b64_tr_b16 v[116:117], v13 offset:8192
  v_mfma_f32_16x16x32_bf16 v[144:147], v[64:67], v[36:39], v[144:147]
  ds_read_b64_tr_b16 v[118:119], v13 offset:9216
  v_mfma_f32_16x16x32_bf16 v[148:151], v[68:71], v[36:39], v[148:151]
  buffer_load_dwordx4 v7, s[40:43], s60 offen offset:1024 lds
  v_mfma_f32_16x16x32_bf16 v[152:155], v[72:75], v[36:39], v[152:155]
  ds_read_b64_tr_b16 v[120:121], v14 offset:8192
  v_mfma_f32_16x16x32_bf16 v[156:159], v[76:79], v[36:39], v[156:159]
  ds_read_b64_tr_b16 v[122:123], v14 offset:9216
  v_mfma_f32_16x16x32_bf16 v[160:163], v[64:67], v[40:43], v[160:163]
  buffer_load_dwordx4 v8, s[40:43], s60 offen offset:2048 lds
  v_mfma_f32_16x16x32_bf16 v[164:167], v[68:71], v[40:43], v[164:167]
  ds_read_b64_tr_b16 v[124:125], v15 offset:8192
  v_mfma_f32_16x16x32_bf16 v[168:171], v[72:75], v[40:43], v[168:171]
  ds_read_b64_tr_b16 v[126:127], v15 offset:9216
  v_mfma_f32_16x16x32_bf16 v[172:175], v[76:79], v[40:43], v[172:175]
  buffer_load_dwordx4 v9, s[40:43], s60 offen offset:3072 lds
  s_add_u32 s58, s58, s61
  s_add_u32 s59, s59, s61
  s_add_u32 s60, s60, s62
  s_sub_u32 s81, s81, 1
  s_cmp_eq_u32 s81, 0
  s_cselect_b32 s90, s88, 0
  s_cselect_b32 s91, s89, 0
  s_sub_u32 s58, s58, s90
  s_sub_u32 s59, s59, s90
  s_sub_u32 s60, s60, s91
  s_add_u32 s75, s75, 49152
  s_cmp_eq_u32 s75, 147456
  s_cselect_b32 s75, 0, s75
  v_mfma_f32_16x16x32_bf16 v[176:179], v[64:67], v[44:47], v[176:179]
  ds_read_b128 v[80:83], v11 offset:0
  v_mfma_f32_16x16x32_bf16 v[180:183], v[68:71], v[44:47], v[180:183]
  ds_read_b128 v[84:87], v11 offset:2048
  v_mfma_f32_16x16x32_bf16 v[184:187], v[72:75], v[44:47], v[184:187]
  s_add_u32 m0, s80, 0
  s_add_u32 s78, s78, s79
  buffer_load_dwordx4 v1, s[44:47], s78 offen lds
  v_mfma_f32_16x16x32_bf16 v[188:191], v[76:79], v[44:47], v[188:191]
  ds_read_b128 v[88:91], v11 offset:4096
  ds_read_b128 v[92:95], v11 offset:6144
  s_add_u32 s65, s65, 1
  s_cmp_eq_u32 s65, 3
  s_cselect_b32 s66, 4294868992, s96
  s_cselect_b32 s65, 0, s65
  v_add_u32 v10, s66, v10
  v_add_u32 v11, s66, v11
  v_add_u32 v12, s66, v12
  v_add_u32 v13, s66, v13
  v_add_u32 v14, s66, v14
  v_add_u32 v15, s66, v15
  s_waitcnt vmcnt(9) lgkmcnt(0)
  s_barrier
  v_mfma_f32_16x16x32_bf16 v[128:131], v[112:115], v[80:83], v[128:131]
  ds_read_b64_tr_b16 v[64:65], v12 offset:0
  v_mfma_f32_16x16x32_bf16 v[132:135], v[116:119], v[80:83], v[132:135]
  ds_read_b64_tr_b16 v[66:67], v12 offset:1024
  v_mfma_f32_16x16x32_bf16 v[136:139], v[120:123], v[80:83], v[136:139]
  ds_read_b64_tr_b16 v[68:69], v13 offset:0
  v_mfma_f32_16x16x32_bf16 v[140:143], v[124:127], v[80:83], v[140:143]
  ds_read_b64_tr_b16 v[70:71], v13 offset:1024
  v_mfma_f32_16x16x32_bf16 v[144:147], v[112:115], v[84:87], v[144:147]
  ds_read_b64_tr_b16 v[72:73], v14 offset:0
  v_mfma_f32_16x16x32_bf16 v[148:151], v[116:119], v[84:87], v[148:151]
  ds_read_b64_tr_b16 v[74:75], v14 offset:1024
  v_mfma_f32_16x16x32_bf16 v[152:155], v[120:123], v[84:87], v[152:155]
  ds_read_b64_tr_b16 v[76:77], v15 offset:0
  v_mfma_f32_16x16x32_bf16 v[156:159], v[124:127], v[84:87], v[156:159]
  ds_read_b64_tr_b16 v[78:79], v15 offset:1024
  v_mfma_f32_16x16x32_bf16 v[160:163], v[112:115], v[88:91], v[160:163]
  ds_read_b128 v[32:35], v10 offset:0
  v_mfma_f32_16x16x32_bf16 v[164:167], v[116:119], v[88:91], v[164:167]
  ds_read_b128 v[36:39], v10 offset:2048
  v_mfma_f32_16x16x32_bf16 v[168:171], v[120:123], v[88:91], v[168:171]
  ds_read_b128 v[40:43], v10 offset:4096
  v_mfma_f32_16x16x32_bf16 v[172:175], v[124:127], v[88:91], v[172:175]
  ds_read_b128 v[44:47], v10 offset:6144
  v_mfma_f32_16x16x32_bf16 v[176:179], v[112:115], v[92:95], v[176:179]
  v_mfma_f32_16x16x32_bf16 v[180:183], v[116:119], v[92:95], v[180:183]
  v_mfma_f32_16x16x32_bf16 v[184:187], v[120:123], v[92:95], v[184:187]
  v_mfma_f32_16x16x32_bf16 v[188:191], v[124:127], v[92:95], v[188:191]
  s_waitcnt lgkmcnt(0)
  v_mfma_f32_16x16x32_bf16 v[128:131], v[64:67], v[32:35], v[128:131]
  ds_read_b64_tr_b16 v[112:113], v12 offset:8192
  v_mfma_f32_16x16x32_bf16 v[132:135], v[68:71], v[32:35], v[132:135]
  ds_read_b64_tr_b16 v[114:115], v12 offset:9216
  v_mfma_f32_16x16x32_bf16 v[136:139], v[72:75], v[32:35], v[136:139]
  ds_read_b64_tr_b16 v[116:117], v13 offset:8192
  v_mfma_f32_16x16x32_bf16 v[140:143], v[76:79], v[32:35], v[140:143]
  ds_read_b64_tr_b16 v[118:119], v13 offset:9216
  v_mfma_f32_16x16x32_bf16 v[144:147], v[64:67], v[36:39], v[144:147]
  ds_read_b64_tr_b16 v[120:121], v14 offset:8192
  v_mfma_f32_16x16x32_bf16 v[148:151], v[68:71], v[36:39], v[148:151]
  ds_read_b64_tr_b16 v[122:123], v14 offset:9216
  v_mfma_f32_16x16x32_bf16 v[152:155], v[72:75], v[36:39], v[152:155]
  ds_read_b64_tr_b16 v[124:125], v15 offset:8192
  v_mfma_f32_16x16x32_bf16 v[156:159], v[76:79], v[36:39], v[156:159]
  ds_read_b64_tr_b16 v[126:127], v15 offset:9216
  v_mfma_f32_16x16x32_bf16 v[160:163], v[64:67], v[40:43], v[160:163]
  ds_read_b128 v[80:83], v11 offset:0
  v_mfma_f32_16x16x32_bf16 v[164:167], v[68:71], v[40:43], v[164:167]
  ds_read_b128 v[84:87], v11 offset:2048
  v_mfma_f32_16x16x32_bf16 v[168:171], v[72:75], v[40:43], v[168:171]
  ds_read_b128 v[88:91], v11 offset:4096
  v_mfma_f32_16x16x32_bf16 v[172:175], v[76:79], v[40:43], v[172:175]
  ds_read_b128 v[92:95], v11 offset:6144
  v_mfma_f32_16x16x32_bf16 v[176:179], v[64:67], v[44:47], v[176:179]
  s_add_u32 s65, s65, 1
  s_cmp_eq_u32 s65, 3
  s_cselect_b32 s66, 4294868992, s96
  s_cselect_b32 s65, 0, s65
  v_mfma_f32_16x16x32_bf16 v[180:183], v[68:71], v[44:47], v[180:183]
  v_add_u32 v10, s66, v10
  v_mfma_f32_16x16x32_bf16 v[184:187], v[72:75], v[44:47], v[184:187]
  v_add_u32 v11, s66, v11
  v_mfma_f32_16x16x32_bf16 v[188:191], v[76:79], v[44:47], v[188:191]
  v_add_u32 v12, s66, v12
  v_add_u32 v13, s66, v13
  v_add_u32 v14, s66, v14
  v_add_u32 v15, s66, v15
  s_waitcnt vmcnt(0) lgkmcnt(0)
  s_barrier
  v_mfma_f32_16x16x32_bf16 v[128:131], v[112:115], v[80:83], v[128:131]
  ds_read_b64_tr_b16 v[64:65], v12 offset:0
  v_mfma_f32_16x16x32_bf16 v[132:135], v[116:119], v[80:83], v[132:135]
  ds_read_b64_tr_b16 v[66:67], v12 offset:1024
  v_mfma_f32_16x16x32_bf16 v[136:139], v[120:123], v[80:83], v[136:139]
  ds_read_b64_tr_b16 v[68:69], v13 offset:0
  v_mfma_f32_16x16x32_bf16 v[140:143], v[124:127], v[80:83], v[140:143]
  ds_read_b64_tr_b16 v[70:71], v13 offset:1024
  v_mfma_f32_16x16x32_bf16 v[144:147], v[112:115], v[84:87], v[144:147]
  ds_read_b64_tr_b16 v[72:73], v14 offset:0
  v_mfma_f32_16x16x32_bf16 v[148:151], v[116:119], v[84:87], v[148:151]
  ds_read_b64_tr_b16 v[74:75], v14 offset:1024
  v_mfma_f32_16x16x32_bf16 v[152:155], v[120:123], v[84:87], v[152:155]
  ds_read_b64_tr_b16 v[76:77], v15 offset:0
  v_mfma_f32_16x16x32_bf16 v[156:159], v[124:127], v[84:87], v[156:159]
  ds_read_b64_tr_b16 v[78:79], v15 offset:1024
  v_mfma_f32_16x16x32_bf16 v[160:163], v[112:115], v[88:91], v[160:163]
  ds_read_b128 v[32:35], v10 offset:0
  v_mfma_f32_16x16x32_bf16 v[164:167], v[116:119], v[88:91], v[164:167]
  ds_read_b128 v[36:39], v10 offset:2048
  v_mfma_f32_16x16x32_bf16 v[168:171], v[120:123], v[88:91], v[168:171]
  ds_read_b128 v[40:43], v10 offset:4096
  v_mfma_f32_16x16x32_bf16 v[172:175], v[124:127], v[88:91], v[172:175]
  ds_read_b128 v[44:47], v10 offset:6144
  v_mfma_f32_16x16x32_bf16 v[176:179], v[112:115], v[92:95], v[176:179]
  v_mfma_f32_16x16x32_bf16 v[180:183], v[116:119], v[92:95], v[180:183]
  v_mfma_f32_16x16x32_bf16 v[184:187], v[120:123], v[92:95], v[184:187]
  v_mfma_f32_16x16x32_bf16 v[188:191], v[124:127], v[92:95], v[188:191]
  s_waitcnt lgkmcnt(0)
  v_mfma_f32_16x16x32_bf16 v[128:131], v[64:67], v[32:35], v[128:131]
  ds_read_b64_tr_b16 v[112:113], v12 offset:8192
  v_mfma_f32_16x16x32_bf16 v[132:135], v[68:71], v[32:35], v[132:135]
  ds_read_b64_tr_b16 v[114:115], v12 offset:9216
  v_mfma_f32_16x16x32_bf16 v[136:139], v[72:75], v[32:35], v[136:139]
  ds_read_b64_tr_b16 v[116:117], v13 offset:8192
  v_mfma_f32_16x16x32_bf16 v[140:143], v[76:79], v[32:35], v[140:143]
  ds_read_b64_tr_b16 v[118:119], v13 offset:9216
  v_mfma_f32_16x16x32_bf16 v[144:147], v[64:67], v[36:39], v[144:147]
  ds_read_b64_tr_b16 v[120:121], v14 offset:8192
  v_mfma_f32_16x16x32_bf16 v[148:151], v[68:71], v[36:39], v[148:151]
  ds_read_b64_tr_b16 v[122:123], v14 offset:9216
  v_mfma_f32_16x16x32_bf16 v[152:155], v[72:75], v[36:39], v[152:155]
  ds_read_b64_tr_b16 v[124:125], v15 offset:8192
  v_mfma_f32_16x16x32_bf16 v[156:159], v[76:79], v[36:39], v[156:159]
  ds_read_b64_tr_b16 v[126:127], v15 offset:9216
  v_mfma_f32_16x16x32_bf16 v[160:163], v[64:67], v[40:43], v[160:163]
  ds_read_b128 v[80:83], v11 offset:0
  v_mfma_f32_16x16x32_bf16 v[164:167], v[68:71], v[40:43], v[164:167]
  ds_read_b128 v[84:87], v11 offset:2048
  v_mfma_f32_16x16x32_bf16 v[168:171], v[72:75], v[40:43], v[168:171]
  ds_read_b128 v[88:91], v11 offset:4096
  v_mfma_f32_16x16x32_bf16 v[172:175], v[76:79], v[40:43], v[172:175]
  ds_read_b128 v[92:95], v11 offset:6144
  v_mfma_f32_16x16x32_bf16 v[176:179], v[64:67], v[44:47], v[176:179]
  v_mfma_f32_16x16x32_bf16 v[180:183], v[68:71], v[44:47], v[180:183]
  v_mfma_f32_16x16x32_bf16 v[184:187], v[72:75], v[44:47], v[184:187]
  v_mfma_f32_16x16x32_bf16 v[188:191], v[76:79], v[44:47], v[188:191]
  s_waitcnt lgkmcnt(0)
  v_mfma_f32_16x16x32_bf16 v[128:131], v[112:115], v[80:83], v[128:131]
  v_mfma_f32_16x16x32_bf16 v[132:135], v[116:119], v[80:83], v[132:135]
  v_mfma_f32_16x16x32_bf16 v[136:139], v[120:123], v[80:83], v[136:139]
  v_mfma_f32_16x16x32_bf16 v[140:143], v[124:127], v[80:83], v[140:143]
  v_mfma_f32_16x16x32_bf16 v[144:147], v[112:115], v[84:87], v[144:147]
  v_mfma_f32_16x16x32_bf16 v[148:151], v[116:119], v[84:87], v[148:151]
  v_mfma_f32_16x16x32_bf16 v[152:155], v[120:123], v[84:87], v[152:155]
  v_mfma_f32_16x16x32_bf16 v[156:159], v[124:127], v[84:87], v[156:159]
  v_mfma_f32_16x16x32_bf16 v[160:163], v[112:115], v[88:91], v[160:163]
  v_mfma_f32_16x16x32_bf16 v[164:167], v[116:119], v[88:91], v[164:167]
  v_mfma_f32_16x16x32_bf16 v[168:171], v[120:123], v[88:91], v[168:171]
  v_mfma_f32_16x16x32_bf16 v[172:175], v[124:127], v[88:91], v[172:175]
  v_mfma_f32_16x16x32_bf16 v[176:179], v[112:115], v[92:95], v[176:179]
  v_mfma_f32_16x16x32_bf16 v[180:183], v[116:119], v[92:95], v[180:183]
  v_mfma_f32_16x16x32_bf16 v[184:187], v[120:123], v[92:95], v[184:187]
  v_mfma_f32_16x16x32_bf16 v[188:191], v[124:127], v[92:95], v[188:191]
  s_branch Lnext
Lgemm_hv:
  s_waitcnt vmcnt(16)
  s_barrier
  ds_read_b64_tr_b16 v[64:65], v12 offset:0
  ds_read_b64_tr_b16 v[66:67], v12 offset:1024
  ds_read_b64_tr_b16 v[68:69], v13 offset:0
  ds_read_b64_tr_b16 v[70:71], v13 offset:1024
  ds_read_b64_tr_b16 v[72:73], v14 offset:0
  ds_read_b64_tr_b16 v[74:75], v14 offset:1024
  ds_read_b64_tr_b16 v[76:77], v15 offset:0
  ds_read_b64_tr_b16 v[78:79], v15 offset:1024
  ds_read_b128 v[32:35], v10 offset:0
  ds_read_b128 v[36:39], v10 offset:2048
  ds_read_b128 v[40:43], v10 offset:4096
  ds_read_b128 v[44:47], v10 offset:6144
  s_waitcnt lgkmcnt(8)
  s_waitcnt lgkmcnt(0)
  v_mfma_f32_16x16x32_bf16 v[128:131], v[32:35], v[64:67], 0
  ds_read_b64_tr_b16 v[112:113], v12 offset:8192
  v_mfma_f32_16x16x32_bf16 v[132:135], v[32:35], v[68:71], 0
  ds_read_b64_tr_b16 v[114:115], v12 offset:9216
  v_mfma_f32_16x16x32_bf16 v[136:139], v[32:35], v[72:75], 0
  ds_read_b64_tr_b16 v[116:117], v13 offset:8192
  v_mfma_f32_16x16x32_bf16 v[140:143], v[32:35], v[76:79], 0
  ds_read_b64_tr_b16 v[118:119], v13 offset:9216
  v_mfma_f32_16x16x32_bf16 v[144:147], v[36:39], v[64:67], 0
  ds_read_b64_tr_b16 v[120:121], v14 offset:8192
  v_mfma_f32_16x16x32_bf16 v[148:151], v[36:39], v[68:71], 0
  ds_read_b64_tr_b16 v[122:123], v14 offset:9216
  v_mfma_f32_16x16x32_bf16 v[152:155], v[36:39], v[72:75], 0
  ds_read_b64_tr_b16 v[124:125], v15 offset:8192
  v_mfma_f32_16x16x32_bf16 v[156:159], v[36:39], v[76:79], 0
  ds_read_b64_tr_b16 v[126:127], v15 offset:9216
  v_mfma_f32_16x16x32_bf16 v[160:163], v[40:43], v[64:67], 0
  ds_read_b128 v[80:83], v11 offset:0
  v_mfma_f32_16x16x32_bf16 v[164:167], v[40:43], v[68:71], 0
  ds_read_b128 v[84:87], v11 offset:2048
  v_mfma_f32_16x16x32_bf16 v[168:171], v[40:43], v[72:75], 0
  ds_read_b128 v[88:91], v11 offset:4096
  v_mfma_f32_16x16x32_bf16 v[172:175], v[40:43], v[76:79], 0
  ds_read_b128 v[92:95], v11 offset:6144
  v_mfma_f32_16x16x32_bf16 v[176:179], v[44:47], v[64:67], 0
  s_add_u32 s65, s65, 1
  s_cmp_eq_u32 s65, 3
  s_cselect_b32 s66, 4294868992, s96
  s_cselect_b32 s65, 0, s65
  v_mfma_f32_16x16x32_bf16 v[180:183], v[44:47], v[68:71], 0
  v_add_u32 v10, s66, v10
  v_mfma_f32_16x16x32_bf16 v[184:187], v[44:47], v[72:75], 0
  v_add_u32 v11, s66, v11
  v_mfma_f32_16x16x32_bf16 v[188:191], v[44:47], v[76:79], 0
  v_add_u32 v12, s66, v12
  v_add_u32 v13, s66, v13
  v_add_u32 v14, s66, v14
  v_add_u32 v15, s66, v15
  s_waitcnt vmcnt(8) lgkmcnt(0)
  s_barrier
  v_mfma_f32_16x16x32_bf16 v[128:131], v[80:83], v[112:115], v[128:131]
  ds_read_b64_tr_b16 v[64:65], v12 offset:0
  v_mfma_f32_16x16x32_bf16 v[132:135], v[80:83], v[116:119], v[132:135]
  ds_read_b64_tr_b16 v[66:67], v12 offset:1024
  v_mfma_f32_16x16x32_bf16 v[136:139], v[80:83], v[120:123], v[136:139]
  s_add_u32 m0, s63, s75
  s_nop 0
  buffer_load_dwordx4 v2, s[36:39], s58 offen offset:0 sc1 lds
  v_mfma_f32_16x16x32_bf16 v[140:143], v[80:83], v[124:127], v[140:143]
  ds_read_b64_tr_b16 v[68:69], v13 offset:0
  v_mfma_f32_16x16x32_bf16 v[144:147], v[84:87], v[112:115], v[144:147]
  ds_read_b64_tr_b16 v[70:71], v13 offset:1024
  v_mfma_f32_16x16x32_bf16 v[148:151], v[84:87], v[116:119], v[148:151]
  ds_read_b64_tr_b16 v[72:73], v14 offset:0
  v_mfma_f32_16x16x32_bf16 v[152:155], v[84:87], v[120:123], v[152:155]
  buffer_load_dwordx4 v3, s[36:39], s58 offen offset:1024 sc1 lds
  v_mfma_f32_16x16x32_bf16 v[156:159], v[84:87], v[124:127], v[156:159]
  ds_read_b64_tr_b16 v[74:75], v14 offset:1024
  v_mfma_f32_16x16x32_bf16 v[160:163], v[88:91], v[112:115], v[160:163]
  ds_read_b64_tr_b16 v[76:77], v15 offset:0
  v_mfma_f32_16x16x32_bf16 v[164:167], v[88:91], v[116:119], v[164:167]
  ds_read_b64_tr_b16 v[78:79], v15 offset:1024
  v_mfma_f32_16x16x32_bf16 v[168:171], v[88:91], v[120:123], v[168:171]
  buffer_load_dwordx4 v4, s[36:39], s58 offen offset:2048 sc1 lds
  v_mfma_f32_16x16x32_bf16 v[172:175], v[88:91], v[124:127], v[172:175]
  ds_read_b128 v[32:35], v10 offset:0
  v_mfma_f32_16x16x32_bf16 v[176:179], v[92:95], v[112:115], v[176:179]
  ds_read_b128 v[36:39], v10 offset:2048
  v_mfma_f32_16x16x32_bf16 v[180:183], v[92:95], v[116:119], v[180:183]
  ds_read_b128 v[40:43], v10 offset:4096
  v_mfma_f32_16x16x32_bf16 v[184:187], v[92:95], v[120:123], v[184:187]
  buffer_load_dwordx4 v5, s[36:39], s58 offen offset:3072 sc1 lds
  v_mfma_f32_16x16x32_bf16 v[188:191], v[92:95], v[124:127], v[188:191]
  ds_read_b128 v[44:47], v10 offset:6144
  s_sub_u32 s57, s57, 4
Lhv_loop:
  s_waitcnt lgkmcnt(0)
  v_mfma_f32_16x16x32_bf16 v[128:131], v[32:35], v[64:67], v[128:131]
  ds_read_b64_tr_b16 v[112:113], v12 offset:8192
  v_mfma_f32_16x16x32_bf16 v[132:135], v[32:35], v[68:71], v[132:135]
  ds_read_b64_tr_b16 v[114:115], v12 offset:9216
  v_mfma_f32_16x16x32_bf16 v[136:139], v[32:35], v[72:75], v[136:139]
  s_add_u32 m0, s64, s75
  s_nop 0
  buffer_load_dwordx4 v6, s[40:43], s60 offen offset:0 lds
  v_mfma_f32_16x16x32_bf16 v[140:143], v[32:35], v[76:79], v[140:143]
  ds_read_b64_tr_b16 v[116:117], v13 offset:8192
  v_mfma_f32_16x16x32_bf16 v[144:147], v[36:39], v[64:67], v[144:147]
  ds_read_b64_tr_b16 v[118:119], v13 offset:9216
  v_mfma_f32_16x16x32_bf16 v[148:151], v[36:39], v[68:71], v[148:151]
  buffer_load_dwordx4 v7, s[40:43], s60 offen offset:1024 lds
  v_mfma_f32_16x16x32_bf16 v[152:155], v[36:39], v[72:75], v[152:155]
  ds_read_b64_tr_b16 v[120:121], v14 offset:8192
  v_mfma_f32_16x16x32_bf16 v[156:159], v[36:39], v[76:79], v[156:159]
  ds_read_b64_tr_b16 v[122:123], v14 offset:9216
  v_mfma_f32_16x16x32_bf16 v[160:163], v[40:43], v[64:67], v[160:163]
  buffer_load_dwordx4 v8, s[40:43], s60 offen offset:2048 lds
  v_mfma_f32_16x16x32_bf16 v[164:167], v[40:43], v[68:71], v[164:167]
  ds_read_b64_tr_b16 v[124:125], v15 offset:8192
  v_mfma_f32_16x16x32_bf16 v[168:171], v[40:43], v[72:75], v[168:171]
  ds_read_b64_tr_b16 v[126:127], v15 offset:9216
  v_mfma_f32_16x16x32_bf16 v[172:175], v[40:43], v[76:79], v[172:175]
  buffer_load_dwordx4 v9, s[40:43], s60 offen offset:3072 lds
  s_add_u32 s58, s58, s61
  s_add_u32 s59, s59, s61
  s_add_u32 s60, s60, s62
  s_sub_u32 s81, s81, 1
  s_cmp_eq_u32 s81, 0
  s_cselect_b32 s90, s88, 0
  s_cselect_b32 s91, s89, 0
  s_sub_u32 s58, s58, s90
  s_sub_u32 s59, s59, s90
  s_sub_u32 s60, s60, s91
  s_add_u32 s75, s75, 49152
  s_cmp_eq_u32 s75, 147456
  s_cselect_b32 s75, 0, s75
  v_mfma_f32_16x16x32_bf16 v[176:179], v[44:47], v[64:67], v[176:179]
  ds_read_b128 v[80:83], v11 offset:0
  v_mfma_f32_16x16x32_bf16 v[180:183], v[44:47], v[68:71], v[180:183]
  ds_read_b128 v[84:87], v11 offset:2048
  v_mfma_f32_16x16x32_bf16 v[184:187], v[44:47], v[72:75], v[184:187]
  s_add_u32 m0, s80, 0
  s_add_u32 s78, s78, s79
  buffer_load_dwordx4 v1, s[44:47], s78 offen lds
  v_mfma_f32_16x16x32_bf16 v[188:191], v[44:47], v[76:79], v[188:191]
  ds_read_b128 v[88:91], v11 offset:4096
  ds_read_b128 v[92:95], v11 offset:6144
  s_add_u32 s65, s65, 1
  s_cmp_eq_u32 s65, 3
  s_cselect_b32 s66, 4294868992, s96
  s_cselect_b32 s65, 0, s65
  v_add_u32 v10, s66, v10
  v_add_u32 v11, s66, v11
  v_add_u32 v12, s66, v12
  v_add_u32 v13, s66, v13
  v_add_u32 v14, s66, v14
  v_add_u32 v15, s66, v15
  s_waitcnt vmcnt(9) lgkmcnt(0)
  s_barrier
  v_mfma_f32_16x16x32_bf16 v[128:131], v[80:83], v[112:115], v[128:131]
  ds_read_b64_tr_b16 v[64:65], v12 offset:0
  v_mfma_f32_16x16x32_bf16 v[132:135], v[80:83], v[116:119], v[132:135]
  ds_read_b64_tr_b16 v[66:67], v12 offset:1024
  v_mfma_f32_16x16x32_bf16 v[136:139], v[80:83], v[120:123], v[136:139]
  s_add_u32 m0, s63, s75
  s_nop 0
  buffer_load_dwordx4 v2, s[36:39], s58 offen offset:0 sc1 lds
  v_mfma_f32_16x16x32_bf16 v[140:143], v[80:83], v[124:127], v[140:143]
  ds_read_b64_tr_b16 v[68:69], v13 offset:0
  v_mfma_f32_16x16x32_bf16 v[144:147], v[84:87], v[112:115], v[144:147]
  ds_read_b64_tr_b16 v[70:71], v13 offset:1024
  v_mfma_f32_16x16x32_bf16 v[148:151], v[84:87], v[116:119], v[148:151]
  ds_read_b64_tr_b16 v[72:73], v14 offset:0
  v_mfma_f32_16x16x32_bf16 v[152:155], v[84:87], v[120:123], v[152:155]
  buffer_load_dwordx4 v3, s[36:39], s58 offen offset:1024 sc1 lds
  v_mfma_f32_16x16x32_bf16 v[156:159], v[84:87], v[124:127], v[156:159]
  ds_read_b64_tr_b16 v[74:75], v14 offset:1024
  v_mfma_f32_16x16x32_bf16 v[160:163], v[88:91], v[112:115], v[160:163]
  ds_read_b64_tr_b16 v[76:77], v15 offset:0
  v_mfma_f32_16x16x32_bf16 v[164:167], v[88:91], v[116:119], v[164:167]
  ds_read_b64_tr_b16 v[78:79], v15 offset:1024
  v_mfma_f32_16x16x32_bf16 v[168:171], v[88:91], v[120:123], v[168:171]
  buffer_load_dwordx4 v4, s[36:39], s58 offen offset:2048 sc1 lds
  v_mfma_f32_16x16x32_bf16 v[172:175], v[88:91], v[124:127], v[172:175]
  ds_read_b128 v[32:35], v10 offset:0
  v_mfma_f32_16x16x32_bf16 v[176:179], v[92:95], v[112:115], v[176:179]
  ds_read_b128 v[36:39], v10 offset:2048
  v_mfma_f32_16x16x32_bf16 v[180:183], v[92:95], v[116:119], v[180:183]
  ds_read_b128 v[40:43], v10 offset:4096
  v_mfma_f32_16x16x32_bf16 v[184:187], v[92:95], v[120:123], v[184:187]
  buffer_load_dwordx4 v5, s[36:39], s58 offen offset:3072 sc1 lds
  v_mfma_f32_16x16x32_bf16 v[188:191], v[92:95], v[124:127], v[188:191]
  ds_read_b128 v[44:47], v10 offset:6144
  s_sub_u32 s57, s57, 1
  s_cmp_lg_u32 s57, 0
  s_cbranch_scc1 Lhv_loop
  s_waitcnt lgkmcnt(0)
  v_mfma_f32_16x16x32_bf16 v[128:131], v[32:35], v[64:67], v[128:131]
  ds_read_b64_tr_b16 v[112:113], v12 offset:8192
  v_mfma_f32_16x16x32_bf16 v[132:135], v[32:35], v[68:71], v[132:135]
  ds_read_b64_tr_b16 v[114:115], v12 offset:9216
  v_mfma_f32_16x16x32_bf16 v[136:139], v[32:35], v[72:75], v[136:139]
  s_add_u32 m0, s64, s75
  s_nop 0
  buffer_load_dwordx4 v6, s[40:43], s60 offen offset:0 lds
  v_mfma_f32_16x16x32_bf16 v[140:143], v[32:35], v[76:79], v[140:143]
  ds_read_b64_tr_b16 v[116:117], v13 offset:8192
  v_mfma_f32_16x16x32_bf16 v[144:147], v[36:39], v[64:67], v[144:147]
  ds_read_b64_tr_b16 v[118:119], v13 offset:9216
  v_mfma_f32_16x16x32_bf16 v[148:151], v[36:39], v[68:71], v[148:151]
  buffer_load_dwordx4 v7, s[40:43], s60 offen offset:1024 lds
  v_mfma_f32_16x16x32_bf16 v[152:155], v[36:39], v[72:75], v[152:155]
  ds_read_b64_tr_b16 v[120:121], v14 offset:8192
  v_mfma_f32_16x16x32_bf16 v[156:159], v[36:39], v[76:79], v[156:159]
  ds_read_b64_tr_b16 v[122:123], v14 offset:9216
  v_mfma_f32_16x16x32_bf16 v[160:163], v[40:43], v[64:67], v[160:163]
  buffer_load_dwordx4 v8, s[40:43], s60 offen offset:2048 lds
  v_mfma_f32_16x16x32_bf16 v[164:167], v[40:43], v[68:71], v[164:167]
  ds_read_b64_tr_b16 v[124:125], v15 offset:8192
  v_mfma_f32_16x16x32_bf16 v[168:171], v[40:43], v[72:75], v[168:171]
  ds_read_b64_tr_b16 v[126:127], v15 offset:9216
  v_mfma_f32_16x16x32_bf16 v[172:175], v[40:43], v[76:79], v[172:175]
  buffer_load_dwordx4 v9, s[40:43], s60 offen offset:3072 lds
  s_add_u32 s58, s58, s61
  s_add_u32 s59, s59, s61
  s_add_u32 s60, s60, s62
  s_sub_u32 s81, s81, 1
  s_cmp_eq_u32 s81, 0
  s_cselect_b32 s90, s88, 0
  s_cselect_b32 s91, s89, 0
  s_sub_u32 s58, s58, s90
  s_sub_u32 s59, s59, s90
  s_sub_u32 s60, s60, s91
  s_add_u32 s75, s75, 49152
  s_cmp_eq_u32 s75, 147456
  s_cselect_b32 s75, 0, s75
  v_mfma_f32_16x16x32_bf16 v[176:179], v[44:47], v[64:67], v[176:179]
  ds_read_b128 v[80:83], v11 offset:0
  v_mfma_f32_16x16x32_bf16 v[180:183], v[44:47], v[68:71], v[180:183]
  ds_read_b128 v[84:87], v11 offset:2048
  v_mfma_f32_16x16x32_bf16 v[184:187], v[44:47], v[72:75], v[184:187]
  s_add_u32 m0, s80, 0
  s_add_u32 s78, s78, s79
  buffer_load_dwordx4 v1, s[44:47], s78 offen lds
  v_mfma_f32_16x16x32_bf16 v[188:191], v[44:47], v[76:79], v[188:191]
  ds_read_b128 v[88:91], v11 offset:4096
  ds_read_b128 v[92:95], v11 offset:6144
  s_add_u32 s65, s65, 1
  s_cmp_eq_u32 s65, 3
  s_cselect_b32 s66, 4294868992, s96
  s_cselect_b32 s65, 0, s65
  v_add_u32 v10, s66, v10
  v_add_u32 v11, s66, v11
  v_add_u32 v12, s66, v12
  v_add_u32 v13, s66, v13
  v_add_u32 v14, s66, v14
  v_add_u32 v15, s66, v15
  s_waitcnt vmcnt(9) lgkmcnt(0)
  s_barrier
  v_mfma_f32_16x16x32_bf16 v[128:131], v[80:83], v[112:115], v[128:131]
  ds_read_b64_tr_b16 v[64:65], v12 offset:0
  v_mfma_f32_16x16x32_bf16 v[132:135], v[80:83], v[116:119], v[132:135]
  ds_read_b64_tr_b16 v[66:67], v12 offset:1024
  v_mfma_f32_16x16x32_bf16 v[136:139], v[80:83], v[120:123], v[136:139]
  ds_read_b64_tr_b16 v[68:69], v13 offset:0
  v_mfma_f32_16x16x32_bf16 v[140:143], v[80:83], v[124:127], v[140:143]
  ds_read_b64_tr_b16 v[70:71], v13 offset:1024
  v_mfma_f32_16x16x32_bf16 v[144:147], v[84:87], v[112:115], v[144:147]
  ds_read_b64_tr_b16 v[72:73], v14 offset:0
  v_mfma_f32_16x16x32_bf16 v[148:151], v[84:87], v[116:119], v[148:151]
  ds_read_b64_tr_b16 v[74:75], v14 offset:1024
  v_mfma_f32_16x16x32_bf16 v[152:155], v[84:87], v[120:123], v[152:155]
  ds_read_b64_tr_b16 v[76:77], v15 offset:0
  v_mfma_f32_16x16x32_bf16 v[156:159], v[84:87], v[124:127], v[156:159]
  ds_read_b64_tr_b16 v[78:79], v15 offset:1024
  v_mfma_f32_16x16x32_bf16 v[160:163], v[88:91], v[112:115], v[160:163]
  ds_read_b128 v[32:35], v10 offset:0
  v_mfma_f32_16x16x32_bf16 v[164:167], v[88:91], v[116:119], v[164:167]
  ds_read_b128 v[36:39], v10 offset:2048
  v_mfma_f32_16x16x32_bf16 v[168:171], v[88:91], v[120:123], v[168:171]
  ds_read_b128 v[40:43], v10 offset:4096
  v_mfma_f32_16x16x32_bf16 v[172:175], v[88:91], v[124:127], v[172:175]
  ds_read_b128 v[44:47], v10 offset:6144
  v_mfma_f32_16x16x32_bf16 v[176:179], v[92:95], v[112:115], v[176:179]
  v_mfma_f32_16x16x32_bf16 v[180:183], v[92:95], v[116:119], v[180:183]
  v_mfma_f32_16x16x32_bf16 v[184:187], v[92:95], v[120:123], v[184:187]
  v_mfma_f32_16x16x32_bf16 v[188:191], v[92:95], v[124:127], v[188:191]
  s_waitcnt lgkmcnt(0)
  v_mfma_f32_16x16x32_bf16 v[128:131], v[32:35], v[64:67], v[128:131]
  ds_read_b64_tr_b16 v[112:113], v12 offset:8192
  v_mfma_f32_16x16x32_bf16 v[132:135], v[32:35], v[68:71], v[132:135]
  ds_read_b64_tr_b16 v[114:115], v12 offset:9216
  v_mfma_f32_16x16x32_bf16 v[136:139], v[32:35], v[72:75], v[136:139]
  ds_read_b64_tr_b16 v[116:117], v13 offset:8192
  v_mfma_f32_16x16x32_bf16 v[140:143], v[32:35], v[76:79], v[140:143]
  ds_read_b64_tr_b16 v[118:119], v13 offset:9216
  v_mfma_f32_16x16x32_bf16 v[144:147], v[36:39], v[64:67], v[144:147]
  ds_read_b64_tr_b16 v[120:121], v14 offset:8192
  v_mfma_f32_16x16x32_bf16 v[148:151], v[36:39], v[68:71], v[148:151]
  ds_read_b64_tr_b16 v[122:123], v14 offset:9216
  v_mfma_f32_16x16x32_bf16 v[152:155], v[36:39], v[72:75], v[152:155]
  ds_read_b64_tr_b16 v[124:125], v15 offset:8192
  v_mfma_f32_16x16x32_bf16 v[156:159], v[36:39], v[76:79], v[156:159]
  ds_read_b64_tr_b16 v[126:127], v15 offset:9216
  v_mfma_f32_16x16x32_bf16 v[160:163], v[40:43], v[64:67], v[160:163]
  ds_read_b128 v[80:83], v11 offset:0
  v_mfma_f32_16x16x32_bf16 v[164:167], v[40:43], v[68:71], v[164:167]
  ds_read_b128 v[84:87], v11 offset:2048
  v_mfma_f32_16x16x32_bf16 v[168:171], v[40:43], v[72:75], v[168:171]
  ds_read_b128 v[88:91], v11 offset:4096
  v_mfma_f32_16x16x32_bf16 v[172:175], v[40:43], v[76:79], v[172:175]
  ds_read_b128 v[92:95], v11 offset:6144
  v_mfma_f32_16x16x32_bf16 v[176:179], v[44:47], v[64:67], v[176:179]
  s_add_u32 s65, s65, 1
  s_cmp_eq_u32 s65, 3
  s_cselect_b32 s66, 4294868992, s96
  s_cselect_b32 s65, 0, s65
  v_mfma_f32_16x16x32_bf16 v[180:183], v[44:47], v[68:71], v[180:183]
  v_add_u32 v10, s66, v10
  v_mfma_f32_16x16x32_bf16 v[184:187], v[44:47], v[72:75], v[184:187]
  v_add_u32 v11, s66, v11
  v_mfma_f32_16x16x32_bf16 v[188:191], v[44:47], v[76:79], v[188:191]
  v_add_u32 v12, s66, v12
  v_add_u32 v13, s66, v13
  v_add_u32 v14, s66, v14
  v_add_u32 v15, s66, v15
  s_waitcnt vmcnt(0) lgkmcnt(0)
  s_barrier
  v_mfma_f32_16x16x32_bf16 v[128:131], v[80:83], v[112:115], v[128:131]
  ds_read_b64_tr_b16 v[64:65], v12 offset:0
  v_mfma_f32_16x16x32_bf16 v[132:135], v[80:83], v[116:119], v[132:135]
  ds_read_b64_tr_b16 v[66:67], v12 offset:1024
  v_mfma_f32_16x16x32_bf16 v[136:139], v[80:83], v[120:123], v[136:139]
  ds_read_b64_tr_b16 v[68:69], v13 offset:0
  v_mfma_f32_16x16x32_bf16 v[140:143], v[80:83], v[124:127], v[140:143]
  ds_read_b64_tr_b16 v[70:71], v13 offset:1024
  v_mfma_f32_16x16x32_bf16 v[144:147], v[84:87], v[112:115], v[144:147]
  ds_read_b64_tr_b16 v[72:73], v14 offset:0
  v_mfma_f32_16x16x32_bf16 v[148:151], v[84:87], v[116:119], v[148:151]
  ds_read_b64_tr_b16 v[74:75], v14 offset:1024
  v_mfma_f32_16x16x32_bf16 v[152:155], v[84:87], v[120:123], v[152:155]
  ds_read_b64_tr_b16 v[76:77], v15 offset:0
  v_mfma_f32_16x16x32_bf16 v[156:159], v[84:87], v[124:127], v[156:159]
  ds_read_b64_tr_b16 v[78:79], v15 offset:1024
  v_mfma_f32_16x16x32_bf16 v[160:163], v[88:91], v[112:115], v[160:163]
  ds_read_b128 v[32:35], v10 offset:0
  v_mfma_f32_16x16x32_bf16 v[164:167], v[88:91], v[116:119], v[164:167]
  ds_read_b128 v[36:39], v10 offset:2048
  v_mfma_f32_16x16x32_bf16 v[168:171], v[88:91], v[120:123], v[168:171]
  ds_read_b128 v[40:43], v10 offset:4096
  v_mfma_f32_16x16x32_bf16 v[172:175], v[88:91], v[124:127], v[172:175]
  ds_read_b128 v[44:47], v10 offset:6144
  v_mfma_f32_16x16x32_bf16 v[176:179], v[92:95], v[112:115], v[176:179]
  v_mfma_f32_16x16x32_bf16 v[180:183], v[92:95], v[116:119], v[180:183]
  v_mfma_f32_16x16x32_bf16 v[184:187], v[92:95], v[120:123], v[184:187]
  v_mfma_f32_16x16x32_bf16 v[188:191], v[92:95], v[124:127], v[188:191]
  s_waitcnt lgkmcnt(0)
  v_mfma_f32_16x16x32_bf16 v[128:131], v[32:35], v[64:67], v[128:131]
  ds_read_b64_tr_b16 v[112:113], v12 offset:8192
  v_mfma_f32_16x16x32_bf16 v[132:135], v[32:35], v[68:71], v[132:135]
  ds_read_b64_tr_b16 v[114:115], v12 offset:9216
  v_mfma_f32_16x16x32_bf16 v[136:139], v[32:35], v[72:75], v[136:139]
  ds_read_b64_tr_b16 v[116:117], v13 offset:8192
  v_mfma_f32_16x16x32_bf16 v[140:143], v[32:35], v[76:79], v[140:143]
  ds_read_b64_tr_b16 v[118:119], v13 offset:9216
  v_mfma_f32_16x16x32_bf16 v[144:147], v[36:39], v[64:67], v[144:147]
  ds_read_b64_tr_b16 v[120:121], v14 offset:8192
  v_mfma_f32_16x16x32_bf16 v[148:151], v[36:39], v[68:71], v[148:151]
  ds_read_b64_tr_b16 v[122:123], v14 offset:9216
  v_mfma_f32_16x16x32_bf16 v[152:155], v[36:39], v[72:75], v[152:155]
  ds_read_b64_tr_b16 v[124:125], v15 offset:8192
  v_mfma_f32_16x16x32_bf16 v[156:159], v[36:39], v[76:79], v[156:159]
  ds_read_b64_tr_b16 v[126:127], v15 offset:9216
  v_mfma_f32_16x16x32_bf16 v[160:163], v[40:43], v[64:67], v[160:163]
  ds_read_b128 v[80:83], v11 offset:0
  v_mfma_f32_16x16x32_bf16 v[164:167], v[40:43], v[68:71], v[164:167]
  ds_read_b128 v[84:87], v11 offset:2048
  v_mfma_f32_16x16x32_bf16 v[168:171], v[40:43], v[72:75], v[168:171]
  ds_read_b128 v[88:91], v11 offset:4096
  v_mfma_f32_16x16x32_bf16 v[172:175], v[40:43], v[76:79], v[172:175]
  ds_read_b128 v[92:95], v11 offset:6144
  v_mfma_f32_16x16x32_bf16 v[176:179], v[44:47], v[64:67], v[176:179]
  v_mfma_f32_16x16x32_bf16 v[180:183], v[44:47], v[68:71], v[180:183]
  v_mfma_f32_16x16x32_bf16 v[184:187], v[44:47], v[72:75], v[184:187]
  v_mfma_f32_16x16x32_bf16 v[188:191], v[44:47], v[76:79], v[188:191]
  s_waitcnt lgkmcnt(0)
  v_mfma_f32_16x16x32_bf16 v[128:131], v[80:83], v[112:115], v[128:131]
  v_mfma_f32_16x16x32_bf16 v[132:135], v[80:83], v[116:119], v[132:135]
  v_mfma_f32_16x16x32_bf16 v[136:139], v[80:83], v[120:123], v[136:139]
  v_mfma_f32_16x16x32_bf16 v[140:143], v[80:83], v[124:127], v[140:143]
  v_mfma_f32_16x16x32_bf16 v[144:147], v[84:87], v[112:115], v[144:147]
  v_mfma_f32_16x16x32_bf16 v[148:151], v[84:87], v[116:119], v[148:151]
  v_mfma_f32_16x16x32_bf16 v[152:155], v[84:87], v[120:123], v[152:155]
  v_mfma_f32_16x16x32_bf16 v[156:159], v[84:87], v[124:127], v[156:159]
  v_mfma_f32_16x16x32_bf16 v[160:163], v[88:91], v[112:115], v[160:163]
  v_mfma_f32_16x16x32_bf16 v[164:167], v[88:91], v[116:119], v[164:167]
  v_mfma_f32_16x16x32_bf16 v[168:171], v[88:91], v[120:123], v[168:171]
  v_mfma_f32_16x16x32_bf16 v[172:175], v[88:91], v[124:127], v[172:175]
  v_mfma_f32_16x16x32_bf16 v[176:179], v[92:95], v[112:115], v[176:179]
  v_mfma_f32_16x16x32_bf16 v[180:183], v[92:95], v[116:119], v[180:183]
  v_mfma_f32_16x16x32_bf16 v[184:187], v[92:95], v[120:123], v[184:187]
  v_mfma_f32_16x16x32_bf16 v[188:191], v[92:95], v[124:127], v[188:191]
  s_branch Lnext
Lepi:
  s_cmp_lg_u32 s85, 0
  s_cbranch_scc1 Lepi_half
  s_cmp_eq_u32 s82, 2
  s_cbranch_scc1 Lepi_v
  s_lshr_b32 s67, s50, 1
  s_and_b32 s68, s50, 1
  s_mov_b32 s74, 0x80008000
  s_cmp_eq_u32 s82, 4
  s_cbranch_scc1 Lep_h
  s_cmp_eq_u32 s82, 5
  s_cbranch_scc1 Lep_b
  s_cmp_eq_u32 s82, 1
  s_cselect_b32 s70, 0, 33554432
  s_lshl_b32 s66, s83, 1
  s_add_u32 s66, s66, s67
  s_lshl_b32 s66, s66, 20
  s_add_u32 s70, s70, s66
  s_lshl_b32 s66, s84, 13
  s_add_u32 s70, s70, s66
  s_lshl_b32 s66, s68, 11
  s_add_u32 s70, s70, s66
  s_mov_b32 s71, 262144
  s_mov_b32 s72, 4096
  s_mov_b32 s73, 1024
  s_branch Lep_go
Lep_h:
  s_mov_b32 s74, 0
  s_mul_i32 s70, s83, 56
  s_lshl_b32 s66, s84, 1
  s_add_u32 s70, s70, s66
  s_add_u32 s70, s70, s68
  s_lshl_b32 s70, s70, 15
  s_lshl_b32 s66, s67, 14
  s_add_u32 s70, s70, s66
  s_add_u32 s70, s70, 50331648
  s_mov_b32 s71, 4096
  s_mov_b32 s72, 2048
  s_mov_b32 s73, 1024
  s_branch Lep_go
Lep_b:
  s_lshl_b32 s66, s83, 1
  s_add_u32 s66, s66, s67
  s_lshl_b32 s70, s66, 18
  s_lshl_b32 s66, s84, 1
  s_add_u32 s66, s66, s68
  s_lshl_b32 s66, s66, 12
  s_add_u32 s70, s70, s66
  s_add_u32 s70, s70, 83886080
  s_mov_b32 s71, 65536
  s_mov_b32 s72, 1024
  s_mov_b32 s73, 2048
Lep_go:
  s_sub_u32 s71, s71, s72
  s_nop 7
  v_cvt_pk_bf16_f32 v32, v128, v129
  v_cvt_pk_bf16_f32 v33, v130, v131
  v_cvt_pk_bf16_f32 v34, v132, v133
  v_cvt_pk_bf16_f32 v35, v134, v135
  v_pk_max_i16 v32, v32, s74
  v_pk_max_i16 v33, v33, s74
  v_pk_max_i16 v34, v34, s74
  v_pk_max_i16 v35, v35, s74
  s_add_u32 s66, s70, s73
  buffer_store_dwordx4 v[32:35], v1, s[32:35], s70 offen sc1
  v_cvt_pk_bf16_f32 v36, v136, v137
  v_cvt_pk_bf16_f32 v37, v138, v139
  v_cvt_pk_bf16_f32 v38, v140, v141
  v_cvt_pk_bf16_f32 v39, v142, v143
  v_pk_max_i16 v36, v36, s74
  v_pk_max_i16 v37, v37, s74
  v_pk_max_i16 v38, v38, s74
  v_pk_max_i16 v39, v39, s74
  buffer_store_dwordx4 v[36:39], v1, s[32:35], s66 offen sc1
  s_add_u32 s70, s70, s72
  v_cvt_pk_bf16_f32 v40, v144, v145
  v_cvt_pk_bf16_f32 v41, v146, v147
  v_cvt_pk_bf16_f32 v42, v148, v149
  v_cvt_pk_bf16_f32 v43, v150, v151
  v_pk_max_i16 v40, v40, s74
  v_pk_max_i16 v41, v41, s74
  v_pk_max_i16 v42, v42, s74
  v_pk_max_i16 v43, v43, s74
  s_add_u32 s66, s70, s73
  buffer_store_dwordx4 v[40:43], v1, s[32:35], s70 offen sc1
  v_cvt_pk_bf16_f32 v44, v152, v153
  v_cvt_pk_bf16_f32 v45, v154, v155
  v_cvt_pk_bf16_f32 v46, v156, v157
  v_cvt_pk_bf16_f32 v47, v158, v159
  v_pk_max_i16 v44, v44, s74
  v_pk_max_i16 v45, v45, s74
  v_pk_max_i16 v46, v46, s74
  v_pk_max_i16 v47, v47, s74
  buffer_store_dwordx4 v[44:47], v1, s[32:35], s66 offen sc1
  s_add_u32 s70, s70, s71
  v_cvt_pk_bf16_f32 v48, v160, v161
  v_cvt_pk_bf16_f32 v49, v162, v163
  v_cvt_pk_bf16_f32 v50, v164, v165
  v_cvt_pk_bf16_f32 v51, v166, v167
  v_pk_max_i16 v48, v48, s74
  v_pk_max_i16 v49, v49, s74
  v_pk_max_i16 v50, v50, s74
  v_pk_max_i16 v51, v51, s74
  s_add_u32 s66, s70, s73
  buffer_store_dwordx4 v[48:51], v1, s[32:35], s70 offen sc1
  v_cvt_pk_bf16_f32 v52, v168, v169
  v_cvt_pk_bf16_f32 v53, v170, v171
  v_cvt_pk_bf16_f32 v54, v172, v173
  v_cvt_pk_bf16_f32 v55, v174, v175
  v_pk_max_i16 v52, v52, s74
  v_pk_max_i16 v53, v53, s74
  v_pk_max_i16 v54, v54, s74
  v_pk_max_i16 v55, v55, s74
  buffer_store_dwordx4 v[52:55], v1, s[32:35], s66 offen sc1
  s_add_u32 s70, s70, s72
  v_cvt_pk_bf16_f32 v56, v176, v177
  v_cvt_pk_bf16_f32 v57, v178, v179
  v_cvt_pk_bf16_f32 v58, v180, v181
  v_cvt_pk_bf16_f32 v59, v182, v183
  v_pk_max_i16 v56, v56, s74
  v_pk_max_i16 v57, v57, s74
  v_pk_max_i16 v58, v58, s74
  v_pk_max_i16 v59, v59, s74
  s_add_u32 s66, s70, s73
  buffer_store_dwordx4 v[56:59], v1, s[32:35], s70 offen sc1
  v_cvt_pk_bf16_f32 v60, v184, v185
  v_cvt_pk_bf16_f32 v61, v186, v187
  v_cvt_pk_bf16_f32 v62, v188, v189
  v_cvt_pk_bf16_f32 v63, v190, v191
  v_pk_max_i16 v60, v60, s74
  v_pk_max_i16 v61, v61, s74
  v_pk_max_i16 v62, v62, s74
  v_pk_max_i16 v63, v63, s74
  buffer_store_dwordx4 v[60:63], v1, s[32:35], s66 offen sc1
  s_add_u32 s70, s70, s71
  v_cvt_pk_bf16_f32 v32, v192, v193
  v_cvt_pk_bf16_f32 v33, v194, v195
  v_cvt_pk_bf16_f32 v34, v196, v197
  v_cvt_pk_bf16_f32 v35, v198, v199
  v_pk_max_i16 v32, v32, s74
  v_pk_max_i16 v33, v33, s74
  v_pk_max_i16 v34, v34, s74
  v_pk_max_i16 v35, v35, s74
  s_add_u32 s66, s70, s73
  buffer_store_dwordx4 v[32:35], v1, s[32:35], s70 offen sc1
  v_cvt_pk_bf16_f32 v36, v200, v201
  v_cvt_pk_bf16_f32 v37, v202, v203
  v_cvt_pk_bf16_f32 v38, v204, v205
  v_cvt_pk_bf16_f32 v39, v206, v207
  v_pk_max_i16 v36, v36, s74
  v_pk_max_i16 v37, v37, s74
  v_pk_max_i16 v38, v38, s74
  v_pk_max_i16 v39, v39, s74
  buffer_store_dwordx4 v[36:39], v1, s[32:35], s66 offen sc1
  s_add_u32 s70, s70, s72
  v_cvt_pk_bf16_f32 v40, v208, v209
  v_cvt_pk_bf16_f32 v41, v210, v211
  v_cvt_pk_bf16_f32 v42, v212, v213
  v_cvt_pk_bf16_f32 v43, v214, v215
  v_pk_max_i16 v40, v40, s74
  v_pk_max_i16 v41, v41, s74
  v_pk_max_i16 v42, v42, s74
  v_pk_max_i16 v43, v43, s74
  s_add_u32 s66, s70, s73
  buffer_store_dwordx4 v[40:43], v1, s[32:35], s70 offen sc1
  v_cvt_pk_bf16_f32 v44, v216, v217
  v_cvt_pk_bf16_f32 v45, v218, v219
  v_cvt_pk_bf16_f32 v46, v220, v221
  v_cvt_pk_bf16_f32 v47, v222, v223
  v_pk_max_i16 v44, v44, s74
  v_pk_max_i16 v45, v45, s74
  v_pk_max_i16 v46, v46, s74
  v_pk_max_i16 v47, v47, s74
  buffer_store_dwordx4 v[44:47], v1, s[32:35], s66 offen sc1
  s_add_u32 s70, s70, s71
  v_cvt_pk_bf16_f32 v48, v224, v225
  v_cvt_pk_bf16_f32 v49, v226, v227
  v_cvt_pk_bf16_f32 v50, v228, v229
  v_cvt_pk_bf16_f32 v51, v230, v231
  v_pk_max_i16 v48, v48, s74
  v_pk_max_i16 v49, v49, s74
  v_pk_max_i16 v50, v50, s74
  v_pk_max_i16 v51, v51, s74
  s_add_u32 s66, s70, s73
  buffer_store_dwordx4 v[48:51], v1, s[32:35], s70 offen sc1
  v_cvt_pk_bf16_f32 v52, v232, v233
  v_cvt_pk_bf16_f32 v53, v234, v235
  v_cvt_pk_bf16_f32 v54, v236, v237
  v_cvt_pk_bf16_f32 v55, v238, v239
  v_pk_max_i16 v52, v52, s74
  v_pk_max_i16 v53, v53, s74
  v_pk_max_i16 v54, v54, s74
  v_pk_max_i16 v55, v55, s74
  buffer_store_dwordx4 v[52:55], v1, s[32:35], s66 offen sc1
  s_add_u32 s70, s70, s72
  v_cvt_pk_bf16_f32 v56, v240, v241
  v_cvt_pk_bf16_f32 v57, v242, v243
  v_cvt_pk_bf16_f32 v58, v244, v245
  v_cvt_pk_bf16_f32 v59, v246, v247
  v_pk_max_i16 v56, v56, s74
  v_pk_max_i16 v57, v57, s74
  v_pk_max_i16 v58, v58, s74
  v_pk_max_i16 v59, v59, s74
  s_add_u32 s66, s70, s73
  buffer_store_dwordx4 v[56:59], v1, s[32:35], s70 offen sc1
  v_cvt_pk_bf16_f32 v60, v248, v249
  v_cvt_pk_bf16_f32 v61, v250, v251
  v_cvt_pk_bf16_f32 v62, v252, v253
  v_cvt_pk_bf16_f32 v63, v254, v255
  v_pk_max_i16 v60, v60, s74
  v_pk_max_i16 v61, v61, s74
  v_pk_max_i16 v62, v62, s74
  v_pk_max_i16 v63, v63, s74
  buffer_store_dwordx4 v[60:63], v1, s[32:35], s66 offen sc1
  s_add_u32 s70, s70, s71
  s_branch Lsignal
Lepi_v:
  s_lshr_b32 s67, s50, 1
  s_and_b32 s68, s50, 1
  s_lshl_b32 s66, s83, 1
  s_add_u32 s66, s66, s67
  s_lshl_b32 s70, s66, 20
  s_lshl_b32 s66, s84, 13
  s_add_u32 s70, s70, s66
  s_lshl_b32 s66, s68, 12
  s_add_u32 s70, s70, s66
  s_add_u32 s70, s70, 16777216
  s_nop 7
  v_cvt_pk_bf16_f32 v32, v128, v129
  v_cvt_pk_bf16_f32 v33, v130, v131
  v_cvt_pk_bf16_f32 v34, v144, v145
  v_cvt_pk_bf16_f32 v35, v146, v147
  buffer_store_dwordx4 v[32:35], v1, s[32:35], s70 offen offset:0 sc1
  v_cvt_pk_bf16_f32 v36, v132, v133
  v_cvt_pk_bf16_f32 v37, v134, v135
  v_cvt_pk_bf16_f32 v38, v148, v149
  v_cvt_pk_bf16_f32 v39, v150, v151
  buffer_store_dwordx4 v[36:39], v1, s[32:35], s70 offen offset:1024 sc1
  v_cvt_pk_bf16_f32 v40, v136, v137
  v_cvt_pk_bf16_f32 v41, v138, v139
  v_cvt_pk_bf16_f32 v42, v152, v153
  v_cvt_pk_bf16_f32 v43, v154, v155
  buffer_store_dwordx4 v[40:43], v1, s[32:35], s70 offen offset:2048 sc1
  v_cvt_pk_bf16_f32 v44, v140, v141
  v_cvt_pk_bf16_f32 v45, v142, v143
  v_cvt_pk_bf16_f32 v46, v156, v157
  v_cvt_pk_bf16_f32 v47, v158, v159
  buffer_store_dwordx4 v[44:47], v1, s[32:35], s70 offen offset:3072 sc1
  s_add_u32 s70, s70, 262144
  v_cvt_pk_bf16_f32 v48, v160, v161
  v_cvt_pk_bf16_f32 v49, v162, v163
  v_cvt_pk_bf16_f32 v50, v176, v177
  v_cvt_pk_bf16_f32 v51, v178, v179
  buffer_store_dwordx4 v[48:51], v1, s[32:35], s70 offen offset:0 sc1
  v_cvt_pk_bf16_f32 v52, v164, v165
  v_cvt_pk_bf16_f32 v53, v166, v167
  v_cvt_pk_bf16_f32 v54, v180, v181
  v_cvt_pk_bf16_f32 v55, v182, v183
  buffer_store_dwordx4 v[52:55], v1, s[32:35], s70 offen offset:1024 sc1
  v_cvt_pk_bf16_f32 v56, v168, v169
  v_cvt_pk_bf16_f32 v57, v170, v171
  v_cvt_pk_bf16_f32 v58, v184, v185
  v_cvt_pk_bf16_f32 v59, v186, v187
  buffer_store_dwordx4 v[56:59], v1, s[32:35], s70 offen offset:2048 sc1
  v_cvt_pk_bf16_f32 v60, v172, v173
  v_cvt_pk_bf16_f32 v61, v174, v175
  v_cvt_pk_bf16_f32 v62, v188, v189
  v_cvt_pk_bf16_f32 v63, v190, v191
  buffer_store_dwordx4 v[60:63], v1, s[32:35], s70 offen offset:3072 sc1
  s_add_u32 s70, s70, 262144
  v_cvt_pk_bf16_f32 v32, v192, v193
  v_cvt_pk_bf16_f32 v33, v194, v195
  v_cvt_pk_bf16_f32 v34, v208, v209
  v_cvt_pk_bf16_f32 v35, v210, v211
  buffer_store_dwordx4 v[32:35], v1, s[32:35], s70 offen offset:0 sc1
  v_cvt_pk_bf16_f32 v36, v196, v197
  v_cvt_pk_bf16_f32 v37, v198, v199
  v_cvt_pk_bf16_f32 v38, v212, v213
  v_cvt_pk_bf16_f32 v39, v214, v215
  buffer_store_dwordx4 v[36:39], v1, s[32:35], s70 offen offset:1024 sc1
  v_cvt_pk_bf16_f32 v40, v200, v201
  v_cvt_pk_bf16_f32 v41, v202, v203
  v_cvt_pk_bf16_f32 v42, v216, v217
  v_cvt_pk_bf16_f32 v43, v218, v219
  buffer_store_dwordx4 v[40:43], v1, s[32:35], s70 offen offset:2048 sc1
  v_cvt_pk_bf16_f32 v44, v204, v205
  v_cvt_pk_bf16_f32 v45, v206, v207
  v_cvt_pk_bf16_f32 v46, v220, v221
  v_cvt_pk_bf16_f32 v47, v222, v223
  buffer_store_dwordx4 v[44:47], v1, s[32:35], s70 offen offset:3072 sc1
  s_add_u32 s70, s70, 262144
  v_cvt_pk_bf16_f32 v48, v224, v225
  v_cvt_pk_bf16_f32 v49, v226, v227
  v_cvt_pk_bf16_f32 v50, v240, v241
  v_cvt_pk_bf16_f32 v51, v242, v243
  buffer_store_dwordx4 v[48:51], v1, s[32:35], s70 offen offset:0 sc1
  v_cvt_pk_bf16_f32 v52, v228, v229
  v_cvt_pk_bf16_f32 v53, v230, v231
  v_cvt_pk_bf16_f32 v54, v244, v245
  v_cvt_pk_bf16_f32 v55, v246, v247
  buffer_store_dwordx4 v[52:55], v1, s[32:35], s70 offen offset:1024 sc1
  v_cvt_pk_bf16_f32 v56, v232, v233
  v_cvt_pk_bf16_f32 v57, v234, v235
  v_cvt_pk_bf16_f32 v58, v248, v249
  v_cvt_pk_bf16_f32 v59, v250, v251
  buffer_store_dwordx4 v[56:59], v1, s[32:35], s70 offen offset:2048 sc1
  v_cvt_pk_bf16_f32 v60, v236, v237
  v_cvt_pk_bf16_f32 v61, v238, v239
  v_cvt_pk_bf16_f32 v62, v252, v253
  v_cvt_pk_bf16_f32 v63, v254, v255
  buffer_store_dwordx4 v[60:63], v1, s[32:35], s70 offen offset:3072 sc1
  s_add_u32 s70, s70, 262144
  s_branch Lsignal
Lepi_half:
  s_cmp_eq_u32 s82, 2
  s_cbranch_scc1 Lepi_hv
  s_lshr_b32 s67, s50, 1
  s_and_b32 s68, s50, 1
  s_lshl_b32 s66, s83, 1
  s_add_u32 s66, s66, s67
  s_lshl_b32 s70, s66, 19
  s_lshl_b32 s66, s84, 13
  s_add_u32 s70, s70, s66
  s_lshl_b32 s66, s68, 11
  s_add_u32 s70, s70, s66
  s_add_u32 s70, s70, 0
  v_cvt_pk_bf16_f32 v32, v128, v129
  v_cvt_pk_bf16_f32 v33, v130, v131
  v_cvt_pk_bf16_f32 v34, v132, v133
  v_cvt_pk_bf16_f32 v35, v134, v135
  buffer_store_dwordx4 v[32:35], v1, s[32:35], s70 offen offset:0 sc1
  v_cvt_pk_bf16_f32 v36, v136, v137
  v_cvt_pk_bf16_f32 v37, v138, v139
  v_cvt_pk_bf16_f32 v38, v140, v141
  v_cvt_pk_bf16_f32 v39, v142, v143
  buffer_store_dwordx4 v[36:39], v1, s[32:35], s70 offen offset:1024 sc1
  s_add_u32 s70, s70, 4096
  v_cvt_pk_bf16_f32 v40, v144, v145
  v_cvt_pk_bf16_f32 v41, v146, v147
  v_cvt_pk_bf16_f32 v42, v148, v149
  v_cvt_pk_bf16_f32 v43, v150, v151
  buffer_store_dwordx4 v[40:43], v1, s[32:35], s70 offen offset:0 sc1
  v_cvt_pk_bf16_f32 v44, v152, v153
  v_cvt_pk_bf16_f32 v45, v154, v155
  v_cvt_pk_bf16_f32 v46, v156, v157
  v_cvt_pk_bf16_f32 v47, v158, v159
  buffer_store_dwordx4 v[44:47], v1, s[32:35], s70 offen offset:1024 sc1
  s_add_u32 s70, s70, 258048
  v_cvt_pk_bf16_f32 v48, v160, v161
  v_cvt_pk_bf16_f32 v49, v162, v163
  v_cvt_pk_bf16_f32 v50, v164, v165
  v_cvt_pk_bf16_f32 v51, v166, v167
  buffer_store_dwordx4 v[48:51], v1, s[32:35], s70 offen offset:0 sc1
  v_cvt_pk_bf16_f32 v52, v168, v169
  v_cvt_pk_bf16_f32 v53, v170, v171
  v_cvt_pk_bf16_f32 v54, v172, v173
  v_cvt_pk_bf16_f32 v55, v174, v175
  buffer_store_dwordx4 v[52:55], v1, s[32:35], s70 offen offset:1024 sc1
  s_add_u32 s70, s70, 4096
  v_cvt_pk_bf16_f32 v56, v176, v177
  v_cvt_pk_bf16_f32 v57, v178, v179
  v_cvt_pk_bf16_f32 v58, v180, v181
  v_cvt_pk_bf16_f32 v59, v182, v183
  buffer_store_dwordx4 v[56:59], v1, s[32:35], s70 offen offset:0 sc1
  v_cvt_pk_bf16_f32 v60, v184, v185
  v_cvt_pk_bf16_f32 v61, v186, v187
  v_cvt_pk_bf16_f32 v62, v188, v189
  v_cvt_pk_bf16_f32 v63, v190, v191
  buffer_store_dwordx4 v[60:63], v1, s[32:35], s70 offen offset:1024 sc1
  s_add_u32 s70, s70, 258048
  s_branch Lsignal
Lepi_hv:
  s_lshr_b32 s67, s50, 1
  s_and_b32 s68, s50, 1
  s_lshl_b32 s66, s83, 1
  s_add_u32 s66, s66, s67
  s_lshl_b32 s70, s66, 19
  s_lshl_b32 s66, s84, 13
  s_add_u32 s70, s70, s66
  s_lshl_b32 s66, s68, 12
  s_add_u32 s70, s70, s66
  s_add_u32 s70, s70, 16777216
  v_cvt_pk_bf16_f32 v32, v128, v129
  v_cvt_pk_bf16_f32 v33, v130, v131
  v_cvt_pk_bf16_f32 v34, v144, v145
  v_cvt_pk_bf16_f32 v35, v146, v147
  buffer_store_dwordx4 v[32:35], v1, s[32:35], s70 offen offset:0 sc1
  v_cvt_pk_bf16_f32 v36, v132, v133
  v_cvt_pk_bf16_f32 v37, v134, v135
  v_cvt_pk_bf16_f32 v38, v148, v149
  v_cvt_pk_bf16_f32 v39, v150, v151
  buffer_store_dwordx4 v[36:39], v1, s[32:35], s70 offen offset:1024 sc1
  v_cvt_pk_bf16_f32 v40, v136, v137
  v_cvt_pk_bf16_f32 v41, v138, v139
  v_cvt_pk_bf16_f32 v42, v152, v153
  v_cvt_pk_bf16_f32 v43, v154, v155
  buffer_store_dwordx4 v[40:43], v1, s[32:35], s70 offen offset:2048 sc1
  v_cvt_pk_bf16_f32 v44, v140, v141
  v_cvt_pk_bf16_f32 v45, v142, v143
  v_cvt_pk_bf16_f32 v46, v156, v157
  v_cvt_pk_bf16_f32 v47, v158, v159
  buffer_store_dwordx4 v[44:47], v1, s[32:35], s70 offen offset:3072 sc1
  s_add_u32 s70, s70, 262144
  v_cvt_pk_bf16_f32 v48, v160, v161
  v_cvt_pk_bf16_f32 v49, v162, v163
  v_cvt_pk_bf16_f32 v50, v176, v177
  v_cvt_pk_bf16_f32 v51, v178, v179
  buffer_store_dwordx4 v[48:51], v1, s[32:35], s70 offen offset:0 sc1
  v_cvt_pk_bf16_f32 v52, v164, v165
  v_cvt_pk_bf16_f32 v53, v166, v167
  v_cvt_pk_bf16_f32 v54, v180, v181
  v_cvt_pk_bf16_f32 v55, v182, v183
  buffer_store_dwordx4 v[52:55], v1, s[32:35], s70 offen offset:1024 sc1
  v_cvt_pk_bf16_f32 v56, v168, v169
  v_cvt_pk_bf16_f32 v57, v170, v171
  v_cvt_pk_bf16_f32 v58, v184, v185
  v_cvt_pk_bf16_f32 v59, v186, v187
  buffer_store_dwordx4 v[56:59], v1, s[32:35], s70 offen offset:2048 sc1
  v_cvt_pk_bf16_f32 v60, v172, v173
  v_cvt_pk_bf16_f32 v61, v174, v175
  v_cvt_pk_bf16_f32 v62, v188, v189
  v_cvt_pk_bf16_f32 v63, v190, v191
  buffer_store_dwordx4 v[60:63], v1, s[32:35], s70 offen offset:3072 sc1
  s_add_u32 s70, s70, 262144
Lsignal:
  s_cmp_lg_u32 s85, 0
  s_cselect_b32 s66, s83, 3
  s_cmp_lt_u32 s66, 0
  s_cbranch_scc1 Lwu_set
  s_cmp_eq_u32 s44, s22
  s_cbranch_scc1 Lwu_off
  s_mov_b32 s44, s22
  s_and_b32 s45, s23, 0xffff
  s_lshl_b32 s66, s95, 2
  s_add_u32 s66, s66, s50
  s_lshl_b32 s78, s66, 10
  s_sub_u32 s78, s78, s79
  s_branch Lwu_set
Lwu_off:
  s_mov_b32 s78, 7340032
  s_mov_b32 s79, 0
Lwu_set:
  s_cmp_eq_u32 s82, 3
  s_cbranch_scc1 Lresume
  s_cmp_eq_u32 s82, 5
  s_cbranch_scc1 Lresume
  s_cmp_lg_u32 s76, 0
  s_cbranch_scc1 Lini_140
  s_mov_b32 s76, 1
  v_mov_b32 v24, 0
Lrole_141:
  global_load_dwordx4 v[16:19], v24, s[28:29] sc1
  global_load_dwordx4 v[20:23], v24, s[28:29] offset:16 sc1
Lrole_141_c:
  s_waitcnt vmcnt(0)
  s_cmp_eq_u32 s1, 8
  s_cbranch_scc1 Lrole_142
  v_pk_add_u16 v25, v16, v17
  v_pk_add_u16 v25, v25, v18
  v_pk_add_u16 v25, v25, v19
  v_sad_u16 v25, v25, 0, 0
  v_cmp_ne_u32 vcc, 0x100, v25
  s_cbranch_vccnz Lrole_141_w
  v_bcnt_u32_b32 v25, v16, 0
  v_bcnt_u32_b32 v25, v17, v25
  v_bcnt_u32_b32 v25, v18, v25
  v_bcnt_u32_b32 v25, v19, v25
  v_cmp_ne_u32 vcc, 1, v25
  s_cbranch_vccnz Lrestart
  s_branch Lrole_143
Lrole_141_w:
  s_sub_u32 s69, s69, 1
  s_cbranch_scc0 Lrole_141
  s_endpgm
Lrole_142:
  s_mov_b32 s66, 0
  v_cmp_eq_u32 vcc, 64, v20
  s_cbranch_vccz Lrole_141_w
Lrole_143:
Lini_140:
  s_waitcnt vmcnt(0)
  s_barrier
  s_cmp_lg_u32 s50, 0
  s_cbranch_scc1 Lresume
  v_mov_b32 v16, 0
  v_mov_b32 v17, 1
  s_mov_b64 exec, 1
  s_cmp_eq_u32 s82, 4
  s_cbranch_scc1 Lsig_h
  s_lshl_b32 s66, s84, 7
  s_lshr_b32 s67, s83, s85
  s_lshl_b32 s67, s67, 4
  s_add_u32 s66, s66, s67
  s_sub_u32 s67, s82, 1
  s_lshl_b32 s67, s67, 3
  s_add_u32 s66, s66, s67
  s_and_b32 s67, s83, s85
  s_lshl_b32 s67, s67, 2
  s_add_u32 s66, s66, s67
  s_add_u32 s66, s66, 142622720
  s_cmp_eq_u32 s85, 0
  s_cselect_b32 exec_lo, 3, 1
  v_lshlrev_b32 v16, 2, v0
  v_mov_b32 v17, 1
  buffer_store_dword v17, v16, s[32:35], s66 offen sc1
  s_add_u32 s66, s66, 8192
  buffer_store_dword v17, v16, s[32:35], s66 offen sc1
  s_mov_b64 exec, -1
  s_branch Lresume
Lsig_h:
  s_lshl_b32 s66, s83, 7
  s_add_u32 s66, s66, 99045376
  buffer_atomic_add v17, v16, s[32:35], s66 offen sc1
  s_mov_b64 exec, -1
Lresume:
  s_mov_b32 s82, 0
  s_cmp_lg_u32 s93, 0
  s_cbranch_scc1 Lrun
  s_branch Lsetup
Ltask_sig:
  s_waitcnt vmcnt(0)
  s_barrier
  s_cmp_lg_u32 s50, 0
  s_cbranch_scc1 Lnext
  v_mov_b32 v16, 0
  v_mov_b32 v17, 1
  s_mov_b32 s66, 99046528
  s_mov_b64 exec, 1
  buffer_atomic_add v17, v16, s[32:35], s66 offen sc1
  s_mov_b64 exec, -1
  s_branch Lnext
Ltask_wo:
  s_mov_b32 s51, 1
  s_waitcnt vmcnt(0)
  s_barrier
  s_mov_b32 s40, s14
  s_and_b32 s41, s15, 0xffff
  s_mov_b32 s42, 8388608
  s_mov_b32 s43, 0x20000
  v_lshrrev_b32 v16, 2, v0
  v_and_b32 v17, 3, v0
  v_lshlrev_b32 v18, 4, v17
  v_lshl_add_u32 v18, v16, 11, v18
  v_lshlrev_b32 v19, 3, v17
  v_lshl_add_u32 v19, v16, 6, v19
  s_lshl_b32 s66, s50, 15
  v_add_u32 v19, s66, v19
  s_lshl_b32 s67, s50, 21
  s_lshl_b32 s68, s49, 6
  s_add_u32 s67, s67, s68
  s_mov_b32 m0, s66
  s_nop 0
  buffer_load_dwordx4 v18, s[40:43], s67 offen  lds
  s_add_u32 m0, m0, 1024
  s_add_u32 s67, s67, 32768
  s_nop 0
  buffer_load_dwordx4 v18, s[40:43], s67 offen  lds
  s_add_u32 m0, m0, 1024
  s_add_u32 s67, s67, 32768
  s_nop 0
  buffer_load_dwordx4 v18, s[40:43], s67 offen  lds
  s_add_u32 m0, m0, 1024
  s_add_u32 s67, s67, 32768
  s_nop 0
  buffer_load_dwordx4 v18, s[40:43], s67 offen  lds
  s_add_u32 m0, m0, 1024
  s_add_u32 s67, s67, 32768
  s_nop 0
  buffer_load_dwordx4 v18, s[40:43], s67 offen  lds
  s_add_u32 m0, m0, 1024
  s_add_u32 s67, s67, 32768
  s_nop 0
  buffer_load_dwordx4 v18, s[40:43], s67 offen  lds
  s_add_u32 m0, m0, 1024
  s_add_u32 s67, s67, 32768
  s_nop 0
  buffer_load_dwordx4 v18, s[40:43], s67 offen  lds
  s_add_u32 m0, m0, 1024
  s_add_u32 s67, s67, 32768
  s_nop 0
  buffer_load_dwordx4 v18, s[40:43], s67 offen  lds
  s_add_u32 m0, m0, 1024
  s_add_u32 s67, s67, 32768
  s_nop 0
  buffer_load_dwordx4 v18, s[40:43], s67 offen  lds
  s_add_u32 m0, m0, 1024
  s_add_u32 s67, s67, 32768
  s_nop 0
  buffer_load_dwordx4 v18, s[40:43], s67 offen  lds
  s_add_u32 m0, m0, 1024
  s_add_u32 s67, s67, 32768
  s_nop 0
  buffer_load_dwordx4 v18, s[40:43], s67 offen  lds
  s_add_u32 m0, m0, 1024
  s_add_u32 s67, s67, 32768
  s_nop 0
  buffer_load_dwordx4 v18, s[40:43], s67 offen  lds
  s_add_u32 m0, m0, 1024
  s_add_u32 s67, s67, 32768
  s_nop 0
  buffer_load_dwordx4 v18, s[40:43], s67 offen  lds
  s_add_u32 m0, m0, 1024
  s_add_u32 s67, s67, 32768
  s_nop 0
  buffer_load_dwordx4 v18, s[40:43], s67 offen  lds
  s_add_u32 m0, m0, 1024
  s_add_u32 s67, s67, 32768
  s_nop 0
  buffer_load_dwordx4 v18, s[40:43], s67 offen  lds
  s_add_u32 m0, m0, 1024
  s_add_u32 s67, s67, 32768
  s_nop 0
  buffer_load_dwordx4 v18, s[40:43], s67 offen  lds
  s_add_u32 m0, m0, 1024
  s_add_u32 s67, s67, 32768
  s_nop 0
  buffer_load_dwordx4 v18, s[40:43], s67 offen  lds
  s_add_u32 m0, m0, 1024
  s_add_u32 s67, s67, 32768
  s_nop 0
  buffer_load_dwordx4 v18, s[40:43], s67 offen  lds
  s_add_u32 m0, m0, 1024
  s_add_u32 s67, s67, 32768
  s_nop 0
  buffer_load_dwordx4 v18, s[40:43], s67 offen  lds
  s_add_u32 m0, m0, 1024
  s_add_u32 s67, s67, 32768
  s_nop 0
  buffer_load_dwordx4 v18, s[40:43], s67 offen  lds
  s_add_u32 m0, m0, 1024
  s_add_u32 s67, s67, 32768
  s_nop 0
  buffer_load_dwordx4 v18, s[40:43], s67 offen  lds
  s_add_u32 m0, m0, 1024
  s_add_u32 s67, s67, 32768
  s_nop 0
  buffer_load_dwordx4 v18, s[40:43], s67 offen  lds
  s_add_u32 m0, m0, 1024
  s_add_u32 s67, s67, 32768
  s_nop 0
  buffer_load_dwordx4 v18, s[40:43], s67 offen  lds
  s_add_u32 m0, m0, 1024
  s_add_u32 s67, s67, 32768
  s_nop 0
  buffer_load_dwordx4 v18, s[40:43], s67 offen  lds
  s_add_u32 m0, m0, 1024
  s_add_u32 s67, s67, 32768
  s_nop 0
  buffer_load_dwordx4 v18, s[40:43], s67 offen  lds
  s_add_u32 m0, m0, 1024
  s_add_u32 s67, s67, 32768
  s_nop 0
  buffer_load_dwordx4 v18, s[40:43], s67 offen  lds
  s_add_u32 m0, m0, 1024
  s_add_u32 s67, s67, 32768
  s_nop 0
  buffer_load_dwordx4 v18, s[40:43], s67 offen  lds
  s_add_u32 m0, m0, 1024
  s_add_u32 s67, s67, 32768
  s_nop 0
  buffer_load_dwordx4 v18, s[40:43], s67 offen  lds
  s_add_u32 m0, m0, 1024
  s_add_u32 s67, s67, 32768
  s_nop 0
  buffer_load_dwordx4 v18, s[40:43], s67 offen  lds
  s_add_u32 m0, m0, 1024
  s_add_u32 s67, s67, 32768
  s_nop 0
  buffer_load_dwordx4 v18, s[40:43], s67 offen  lds
  s_add_u32 m0, m0, 1024
  s_add_u32 s67, s67, 32768
  s_nop 0
  buffer_load_dwordx4 v18, s[40:43], s67 offen  lds
  s_add_u32 m0, m0, 1024
  s_add_u32 s67, s67, 32768
  s_nop 0
  buffer_load_dwordx4 v18, s[40:43], s67 offen  lds
  s_add_u32 m0, m0, 1024
  s_add_u32 s67, s67, 32768
  s_waitcnt vmcnt(24)
  ds_read_b64_tr_b16 a[0:1], v19 offset:0
  ds_read_b64_tr_b16 a[2:3], v19 offset:1024
  ds_read_b64_tr_b16 a[4:5], v19 offset:32
  ds_read_b64_tr_b16 a[6:7], v19 offset:1056
  ds_read_b64_tr_b16 a[8:9], v19 offset:2048
  ds_read_b64_tr_b16 a[10:11], v19 offset:3072
  ds_read_b64_tr_b16 a[12:13], v19 offset:2080
  ds_read_b64_tr_b16 a[14:15], v19 offset:3104
  s_waitcnt lgkmcnt(4)
  ds_read_b64_tr_b16 a[16:17], v19 offset:4096
  ds_read_b64_tr_b16 a[18:19], v19 offset:5120
  ds_read_b64_tr_b16 a[20:21], v19 offset:4128
  ds_read_b64_tr_b16 a[22:23], v19 offset:5152
  ds_read_b64_tr_b16 a[24:25], v19 offset:6144
  ds_read_b64_tr_b16 a[26:27], v19 offset:7168
  ds_read_b64_tr_b16 a[28:29], v19 offset:6176
  ds_read_b64_tr_b16 a[30:31], v19 offset:7200
  s_waitcnt lgkmcnt(4)
  s_waitcnt vmcnt(16)
  ds_read_b64_tr_b16 a[32:33], v19 offset:8192
  ds_read_b64_tr_b16 a[34:35], v19 offset:9216
  ds_read_b64_tr_b16 a[36:37], v19 offset:8224
  ds_read_b64_tr_b16 a[38:39], v19 offset:9248
  ds_read_b64_tr_b16 a[40:41], v19 offset:10240
  ds_read_b64_tr_b16 a[42:43], v19 offset:11264
  ds_read_b64_tr_b16 a[44:45], v19 offset:10272
  ds_read_b64_tr_b16 a[46:47], v19 offset:11296
  s_waitcnt lgkmcnt(4)
  ds_read_b64_tr_b16 a[48:49], v19 offset:12288
  ds_read_b64_tr_b16 a[50:51], v19 offset:13312
  ds_read_b64_tr_b16 a[52:53], v19 offset:12320
  ds_read_b64_tr_b16 a[54:55], v19 offset:13344
  ds_read_b64_tr_b16 a[56:57], v19 offset:14336
  ds_read_b64_tr_b16 a[58:59], v19 offset:15360
  ds_read_b64_tr_b16 a[60:61], v19 offset:14368
  ds_read_b64_tr_b16 a[62:63], v19 offset:15392
  s_waitcnt lgkmcnt(4)
  s_waitcnt vmcnt(8)
  ds_read_b64_tr_b16 a[64:65], v19 offset:16384
  ds_read_b64_tr_b16 a[66:67], v19 offset:17408
  ds_read_b64_tr_b16 a[68:69], v19 offset:16416
  ds_read_b64_tr_b16 a[70:71], v19 offset:17440
  ds_read_b64_tr_b16 a[72:73], v19 offset:18432
  ds_read_b64_tr_b16 a[74:75], v19 offset:19456
  ds_read_b64_tr_b16 a[76:77], v19 offset:18464
  ds_read_b64_tr_b16 a[78:79], v19 offset:19488
  s_waitcnt lgkmcnt(4)
  ds_read_b64_tr_b16 a[80:81], v19 offset:20480
  ds_read_b64_tr_b16 a[82:83], v19 offset:21504
  ds_read_b64_tr_b16 a[84:85], v19 offset:20512
  ds_read_b64_tr_b16 a[86:87], v19 offset:21536
  ds_read_b64_tr_b16 a[88:89], v19 offset:22528
  ds_read_b64_tr_b16 a[90:91], v19 offset:23552
  ds_read_b64_tr_b16 a[92:93], v19 offset:22560
  ds_read_b64_tr_b16 a[94:95], v19 offset:23584
  s_waitcnt lgkmcnt(4)
  s_waitcnt vmcnt(0)
  ds_read_b64_tr_b16 a[96:97], v19 offset:24576
  ds_read_b64_tr_b16 a[98:99], v19 offset:25600
  ds_read_b64_tr_b16 a[100:101], v19 offset:24608
  ds_read_b64_tr_b16 a[102:103], v19 offset:25632
  ds_read_b64_tr_b16 a[104:105], v19 offset:26624
  ds_read_b64_tr_b16 a[106:107], v19 offset:27648
  ds_read_b64_tr_b16 a[108:109], v19 offset:26656
  ds_read_b64_tr_b16 a[110:111], v19 offset:27680
  s_waitcnt lgkmcnt(4)
  ds_read_b64_tr_b16 a[112:113], v19 offset:28672
  ds_read_b64_tr_b16 a[114:115], v19 offset:29696
  ds_read_b64_tr_b16 a[116:117], v19 offset:28704
  ds_read_b64_tr_b16 a[118:119], v19 offset:29728
  ds_read_b64_tr_b16 a[120:121], v19 offset:30720
  ds_read_b64_tr_b16 a[122:123], v19 offset:31744
  ds_read_b64_tr_b16 a[124:125], v19 offset:30752
  ds_read_b64_tr_b16 a[126:127], v19 offset:31776
  s_waitcnt lgkmcnt(4)
  s_waitcnt lgkmcnt(0)
  s_mov_b32 m0, s66
  s_nop 0
  buffer_load_dwordx4 v18, s[40:43], s67 offen  lds
  s_add_u32 m0, m0, 1024
  s_add_u32 s67, s67, 32768
  s_nop 0
  buffer_load_dwordx4 v18, s[40:43], s67 offen  lds
  s_add_u32 m0, m0, 1024
  s_add_u32 s67, s67, 32768
  s_nop 0
  buffer_load_dwordx4 v18, s[40:43], s67 offen  lds
  s_add_u32 m0, m0, 1024
  s_add_u32 s67, s67, 32768
  s_nop 0
  buffer_load_dwordx4 v18, s[40:43], s67 offen  lds
  s_add_u32 m0, m0, 1024
  s_add_u32 s67, s67, 32768
  s_nop 0
  buffer_load_dwordx4 v18, s[40:43], s67 offen  lds
  s_add_u32 m0, m0, 1024
  s_add_u32 s67, s67, 32768
  s_nop 0
  buffer_load_dwordx4 v18, s[40:43], s67 offen  lds
  s_add_u32 m0, m0, 1024
  s_add_u32 s67, s67, 32768
  s_nop 0
  buffer_load_dwordx4 v18, s[40:43], s67 offen  lds
  s_add_u32 m0, m0, 1024
  s_add_u32 s67, s67, 32768
  s_nop 0
  buffer_load_dwordx4 v18, s[40:43], s67 offen  lds
  s_add_u32 m0, m0, 1024
  s_add_u32 s67, s67, 32768
  s_nop 0
  buffer_load_dwordx4 v18, s[40:43], s67 offen  lds
  s_add_u32 m0, m0, 1024
  s_add_u32 s67, s67, 32768
  s_nop 0
  buffer_load_dwordx4 v18, s[40:43], s67 offen  lds
  s_add_u32 m0, m0, 1024
  s_add_u32 s67, s67, 32768
  s_nop 0
  buffer_load_dwordx4 v18, s[40:43], s67 offen  lds
  s_add_u32 m0, m0, 1024
  s_add_u32 s67, s67, 32768
  s_nop 0
  buffer_load_dwordx4 v18, s[40:43], s67 offen  lds
  s_add_u32 m0, m0, 1024
  s_add_u32 s67, s67, 32768
  s_nop 0
  buffer_load_dwordx4 v18, s[40:43], s67 offen  lds
  s_add_u32 m0, m0, 1024
  s_add_u32 s67, s67, 32768
  s_nop 0
  buffer_load_dwordx4 v18, s[40:43], s67 offen  lds
  s_add_u32 m0, m0, 1024
  s_add_u32 s67, s67, 32768
  s_nop 0
  buffer_load_dwordx4 v18, s[40:43], s67 offen  lds
  s_add_u32 m0, m0, 1024
  s_add_u32 s67, s67, 32768
  s_nop 0
  buffer_load_dwordx4 v18, s[40:43], s67 offen  lds
  s_add_u32 m0, m0, 1024
  s_add_u32 s67, s67, 32768
  s_nop 0
  buffer_load_dwordx4 v18, s[40:43], s67 offen  lds
  s_add_u32 m0, m0, 1024
  s_add_u32 s67, s67, 32768
  s_nop 0
  buffer_load_dwordx4 v18, s[40:43], s67 offen  lds
  s_add_u32 m0, m0, 1024
  s_add_u32 s67, s67, 32768
  s_nop 0
  buffer_load_dwordx4 v18, s[40:43], s67 offen  lds
  s_add_u32 m0, m0, 1024
  s_add_u32 s67, s67, 32768
  s_nop 0
  buffer_load_dwordx4 v18, s[40:43], s67 offen  lds
  s_add_u32 m0, m0, 1024
  s_add_u32 s67, s67, 32768
  s_nop 0
  buffer_load_dwordx4 v18, s[40:43], s67 offen  lds
  s_add_u32 m0, m0, 1024
  s_add_u32 s67, s67, 32768
  s_nop 0
  buffer_load_dwordx4 v18, s[40:43], s67 offen  lds
  s_add_u32 m0, m0, 1024
  s_add_u32 s67, s67, 32768
  s_nop 0
  buffer_load_dwordx4 v18, s[40:43], s67 offen  lds
  s_add_u32 m0, m0, 1024
  s_add_u32 s67, s67, 32768
  s_nop 0
  buffer_load_dwordx4 v18, s[40:43], s67 offen  lds
  s_add_u32 m0, m0, 1024
  s_add_u32 s67, s67, 32768
  s_nop 0
  buffer_load_dwordx4 v18, s[40:43], s67 offen  lds
  s_add_u32 m0, m0, 1024
  s_add_u32 s67, s67, 32768
  s_nop 0
  buffer_load_dwordx4 v18, s[40:43], s67 offen  lds
  s_add_u32 m0, m0, 1024
  s_add_u32 s67, s67, 32768
  s_nop 0
  buffer_load_dwordx4 v18, s[40:43], s67 offen  lds
  s_add_u32 m0, m0, 1024
  s_add_u32 s67, s67, 32768
  s_nop 0
  buffer_load_dwordx4 v18, s[40:43], s67 offen  lds
  s_add_u32 m0, m0, 1024
  s_add_u32 s67, s67, 32768
  s_nop 0
  buffer_load_dwordx4 v18, s[40:43], s67 offen  lds
  s_add_u32 m0, m0, 1024
  s_add_u32 s67, s67, 32768
  s_nop 0
  buffer_load_dwordx4 v18, s[40:43], s67 offen  lds
  s_add_u32 m0, m0, 1024
  s_add_u32 s67, s67, 32768
  s_nop 0
  buffer_load_dwordx4 v18, s[40:43], s67 offen  lds
  s_add_u32 m0, m0, 1024
  s_add_u32 s67, s67, 32768
  s_nop 0
  buffer_load_dwordx4 v18, s[40:43], s67 offen  lds
  s_add_u32 m0, m0, 1024
  s_add_u32 s67, s67, 32768
  s_waitcnt vmcnt(24)
  ds_read_b64_tr_b16 a[128:129], v19 offset:0
  ds_read_b64_tr_b16 a[130:131], v19 offset:1024
  ds_read_b64_tr_b16 a[132:133], v19 offset:32
  ds_read_b64_tr_b16 a[134:135], v19 offset:1056
  ds_read_b64_tr_b16 a[136:137], v19 offset:2048
  ds_read_b64_tr_b16 a[138:139], v19 offset:3072
  ds_read_b64_tr_b16 a[140:141], v19 offset:2080
  ds_read_b64_tr_b16 a[142:143], v19 offset:3104
  s_waitcnt lgkmcnt(4)
  ds_read_b64_tr_b16 a[144:145], v19 offset:4096
  ds_read_b64_tr_b16 a[146:147], v19 offset:5120
  ds_read_b64_tr_b16 a[148:149], v19 offset:4128
  ds_read_b64_tr_b16 a[150:151], v19 offset:5152
  ds_read_b64_tr_b16 a[152:153], v19 offset:6144
  ds_read_b64_tr_b16 a[154:155], v19 offset:7168
  ds_read_b64_tr_b16 a[156:157], v19 offset:6176
  ds_read_b64_tr_b16 a[158:159], v19 offset:7200
  s_waitcnt lgkmcnt(4)
  s_waitcnt vmcnt(16)
  ds_read_b64_tr_b16 a[160:161], v19 offset:8192
  ds_read_b64_tr_b16 a[162:163], v19 offset:9216
  ds_read_b64_tr_b16 a[164:165], v19 offset:8224
  ds_read_b64_tr_b16 a[166:167], v19 offset:9248
  ds_read_b64_tr_b16 a[168:169], v19 offset:10240
  ds_read_b64_tr_b16 a[170:171], v19 offset:11264
  ds_read_b64_tr_b16 a[172:173], v19 offset:10272
  ds_read_b64_tr_b16 a[174:175], v19 offset:11296
  s_waitcnt lgkmcnt(4)
  ds_read_b64_tr_b16 a[176:177], v19 offset:12288
  ds_read_b64_tr_b16 a[178:179], v19 offset:13312
  ds_read_b64_tr_b16 a[180:181], v19 offset:12320
  ds_read_b64_tr_b16 a[182:183], v19 offset:13344
  ds_read_b64_tr_b16 a[184:185], v19 offset:14336
  ds_read_b64_tr_b16 a[186:187], v19 offset:15360
  ds_read_b64_tr_b16 a[188:189], v19 offset:14368
  ds_read_b64_tr_b16 a[190:191], v19 offset:15392
  s_waitcnt lgkmcnt(4)
  s_waitcnt vmcnt(8)
  ds_read_b64_tr_b16 a[192:193], v19 offset:16384
  ds_read_b64_tr_b16 a[194:195], v19 offset:17408
  ds_read_b64_tr_b16 a[196:197], v19 offset:16416
  ds_read_b64_tr_b16 a[198:199], v19 offset:17440
  ds_read_b64_tr_b16 a[200:201], v19 offset:18432
  ds_read_b64_tr_b16 a[202:203], v19 offset:19456
  ds_read_b64_tr_b16 a[204:205], v19 offset:18464
  ds_read_b64_tr_b16 a[206:207], v19 offset:19488
  s_waitcnt lgkmcnt(4)
  ds_read_b64_tr_b16 a[208:209], v19 offset:20480
  ds_read_b64_tr_b16 a[210:211], v19 offset:21504
  ds_read_b64_tr_b16 a[212:213], v19 offset:20512
  ds_read_b64_tr_b16 a[214:215], v19 offset:21536
  ds_read_b64_tr_b16 a[216:217], v19 offset:22528
  ds_read_b64_tr_b16 a[218:219], v19 offset:23552
  ds_read_b64_tr_b16 a[220:221], v19 offset:22560
  ds_read_b64_tr_b16 a[222:223], v19 offset:23584
  s_waitcnt lgkmcnt(4)
  s_waitcnt vmcnt(0)
  ds_read_b64_tr_b16 a[224:225], v19 offset:24576
  ds_read_b64_tr_b16 a[226:227], v19 offset:25600
  ds_read_b64_tr_b16 a[228:229], v19 offset:24608
  ds_read_b64_tr_b16 a[230:231], v19 offset:25632
  ds_read_b64_tr_b16 a[232:233], v19 offset:26624
  ds_read_b64_tr_b16 a[234:235], v19 offset:27648
  ds_read_b64_tr_b16 a[236:237], v19 offset:26656
  ds_read_b64_tr_b16 a[238:239], v19 offset:27680
  s_waitcnt lgkmcnt(4)
  ds_read_b64_tr_b16 a[240:241], v19 offset:28672
  ds_read_b64_tr_b16 a[242:243], v19 offset:29696
  ds_read_b64_tr_b16 a[244:245], v19 offset:28704
  ds_read_b64_tr_b16 a[246:247], v19 offset:29728
  ds_read_b64_tr_b16 a[248:249], v19 offset:30720
  ds_read_b64_tr_b16 a[250:251], v19 offset:31744
  ds_read_b64_tr_b16 a[252:253], v19 offset:30752
  ds_read_b64_tr_b16 a[254:255], v19 offset:31776
  s_waitcnt lgkmcnt(4)
  s_waitcnt lgkmcnt(0)
  s_branch Lnext
Lphase_a_done:
  s_cmp_lg_u32 s76, 0
  s_cbranch_scc1 Lini_144
  s_mov_b32 s76, 1
  v_mov_b32 v24, 0
Lrole_145:
  global_load_dwordx4 v[16:19], v24, s[28:29] sc1
  global_load_dwordx4 v[20:23], v24, s[28:29] offset:16 sc1
Lrole_145_c:
  s_waitcnt vmcnt(0)
  s_cmp_eq_u32 s1, 8
  s_cbranch_scc1 Lrole_146
  v_pk_add_u16 v25, v16, v17
  v_pk_add_u16 v25, v25, v18
  v_pk_add_u16 v25, v25, v19
  v_sad_u16 v25, v25, 0, 0
  v_cmp_ne_u32 vcc, 0x100, v25
  s_cbranch_vccnz Lrole_145_w
  v_bcnt_u32_b32 v25, v16, 0
  v_bcnt_u32_b32 v25, v17, v25
  v_bcnt_u32_b32 v25, v18, v25
  v_bcnt_u32_b32 v25, v19, v25
  v_cmp_ne_u32 vcc, 1, v25
  s_cbranch_vccnz Lrestart
  s_branch Lrole_147
Lrole_145_w:
  s_sub_u32 s69, s69, 1
  s_cbranch_scc0 Lrole_145
  s_endpgm
Lrole_146:
  s_mov_b32 s66, 0
  v_cmp_eq_u32 vcc, 64, v20
  s_cbranch_vccz Lrole_145_w
Lrole_147:
Lini_144:
  s_waitcnt vmcnt(0)
  s_barrier
  s_cmp_lg_u32 s50, 0
  s_cbranch_scc1 Lpb_arr
  v_mov_b32 v16, 0
  v_mov_b32 v17, 1
  s_mov_b32 s66, 99046400
  s_mov_b64 exec, 1
  buffer_atomic_add v17, v16, s[32:35], s66 offen sc1
  s_mov_b64 exec, -1
Lpb_arr:
  s_mov_b32 s44, s26
  s_and_b32 s45, s27, 0xffff
  s_mov_b32 s46, 4194304
  s_mov_b32 s47, 0x20000
Lwo_done:
  v_lshrrev_b32 v16, 4, v0
  v_and_b32 v17, 7, v0
  v_lshl_add_u32 v17, v16, 3, v17
  v_lshlrev_b32 v2, 4, v17
  v_and_b32 v17, 31, v0
  v_lshlrev_b32 v3, 3, v17
  v_and_b32 v17, 1, v0
  v_lshlrev_b32 v4, 7, v17
  v_bfe_u32 v17, v0, 1, 0
  v_lshl_add_u32 v4, v17, 2, v4
  v_and_b32 v17, 15, v0
  v_lshlrev_b32 v7, 2, v17
  v_lshlrev_b32 v18, 11, v17
  v_and_b32 v19, 1, v16
  v_lshl_add_u32 v18, v19, 5, v18
  v_lshrrev_b32 v19, 1, v16
  v_lshl_add_u32 v5, v19, 4, v18
  v_lshlrev_b32 v16, 2, v16
  v_sub_u32 v9, v17, v16
  s_and_b32 s58, s50, 1
  s_lshl_b32 s66, s58, 4
  v_add_u32 v17, s66, v9
  v_cmp_le_i32 s[78:79], 0, v17
  v_cmp_le_i32 s[80:81], 1, v17
  v_cmp_le_i32 s[82:83], 2, v17
  v_cmp_le_i32 s[84:85], 3, v17
  v_cmp_le_i32 s[86:87], 16, v17
  v_cmp_le_i32 s[88:89], 17, v17
  v_cmp_le_i32 s[90:91], 18, v17
  v_cmp_le_i32 s[92:93], 19, v17
  v_mov_b32 v160, 0x3f803f80
  v_mov_b32 v161, 0x3f803f80
  v_mov_b32 v162, 0x3f803f80
  v_mov_b32 v163, 0x3f803f80
  s_mov_b32 s94, 0x3e0293ee
  s_mov_b32 s77, s48
  s_mov_b32 s66, 99046528
  s_cmp_lt_u32 s48, 3
  s_cselect_b32 s67, 0, 6
  s_add_u32 s77, s77, s67
  s_mov_b32 s64, 0
  v_mov_b32 v24, 0
Lrole_148:
  global_load_dwordx4 v[16:19], v24, s[28:29] sc1
  global_load_dwordx4 v[20:23], v24, s[28:29] offset:16 sc1
Lrole_148_c:
  s_waitcnt vmcnt(0)
  s_cmp_eq_u32 s1, 8
  s_cbranch_scc1 Lrole_149
  v_pk_add_u16 v25, v16, v17
  v_pk_add_u16 v25, v25, v18
  v_pk_add_u16 v25, v25, v19
  v_sad_u16 v25, v25, 0, 0
  v_cmp_ne_u32 vcc, 0x100, v25
  s_cbranch_vccnz Lrole_148_w
  v_bcnt_u32_b32 v25, v16, 0
  v_bcnt_u32_b32 v25, v17, v25
  v_bcnt_u32_b32 v25, v18, v25
  v_bcnt_u32_b32 v25, v19, v25
  v_cmp_ne_u32 vcc, 1, v25
  s_cbranch_vccnz Lrestart
  v_readfirstlane_b32 s67, v22
  s_cmp_ge_u32 s67, 0x1000
  s_cbranch_scc1 Lrole_150
Lrole_148_w:
  s_sub_u32 s69, s69, 1
  s_cbranch_scc0 Lrole_148
  s_endpgm
Lrole_149:
  s_mov_b32 s67, 0
  v_cmp_eq_u32 vcc, 64, v20
  s_cbranch_vccz Lrole_148_w
Lrole_150:
  s_and_b32 s67, s67, 0xff
  s_cmp_gt_u32 s67, 8
  s_cselect_b32 s67, 1, 0
  s_lshl_b32 s61, s67, 13
  s_cmp_lg_u32 s50, 0
  s_cbranch_scc1 Law_152
  v_mov_b32 v16, 0
Law_151:
  buffer_load_dword v17, v16, s[32:35], s66 offen sc1
  s_waitcnt vmcnt(0)
  v_cmp_le_u32 vcc, 0xc0, v17
  s_cbranch_vccnz Law_152
  s_sleep 2
  s_sub_u32 s69, s69, 1
  s_cbranch_scc0 Law_151
  s_endpgm
Law_152:
  s_barrier
  s_and_b32 s58, s50, 1
  s_lshr_b32 s59, s50, 1
  v_and_b32 v16, 31, v0
  v_lshlrev_b32 v16, 10, v16
  s_lshl_b32 s66, s50, 15
  s_add_u32 s66, s66, 1008
  v_add_u32 v8, s66, v16
  v_mov_b32 v120, -1
  v_mov_b32 v121, -1
  v_mov_b32 v122, -1
  v_mov_b32 v123, -1
  s_mov_b32 s60, s48
Lclr:
  s_lshr_b32 s62, s60, 1
  s_add_u32 s62, s62, 54
  s_and_b32 s58, s60, 1
  s_lshl_b32 s70, s62, 18
  s_lshl_b32 s66, s58, 17
  s_add_u32 s70, s70, s66
  s_lshl_b32 s66, s49, 12
  s_add_u32 s70, s70, s66
  s_lshl_b32 s66, s50, 10
  s_add_u32 s70, s70, s66
  s_add_u32 s70, s70, 67108864
  buffer_store_dwordx4 v[120:123], v1, s[32:35], s70 offen sc1
  s_add_u32 s60, s60, 6
  s_cmp_lt_u32 s60, 20
  s_cbranch_scc1 Lclr
  s_and_b32 s58, s50, 1
  s_lshl_b32 s70, s77, 18
  s_lshl_b32 s66, s49, 13
  s_add_u32 s70, s70, s66
  s_add_u32 s71, s70, 4096
  s_lshl_b32 s66, s58, 12
  s_add_u32 s72, s70, s66
  s_add_u32 s72, s72, 33554432
  s_lshl_b32 s66, s59, 12
  s_add_u32 s73, s70, s66
  s_add_u32 s73, s73, 16777216
  buffer_load_dwordx4 v[32:35], v1, s[32:35], s72 offen offset:0 sc1
  buffer_load_dwordx4 v[36:39], v1, s[32:35], s72 offen offset:1024 sc1
  buffer_load_dwordx4 v[40:43], v1, s[32:35], s72 offen offset:2048 sc1
  buffer_load_dwordx4 v[44:47], v1, s[32:35], s72 offen offset:3072 sc1
  buffer_load_dwordx4 v[48:51], v1, s[32:35], s70 offen offset:0 sc1
  buffer_load_dwordx4 v[52:55], v1, s[32:35], s70 offen offset:1024 sc1
  buffer_load_dwordx4 v[56:59], v1, s[32:35], s70 offen offset:2048 sc1
  buffer_load_dwordx4 v[60:63], v1, s[32:35], s70 offen offset:3072 sc1
  buffer_load_dwordx4 v[64:67], v1, s[32:35], s71 offen offset:0 sc1
  buffer_load_dwordx4 v[68:71], v1, s[32:35], s71 offen offset:1024 sc1
  buffer_load_dwordx4 v[72:75], v1, s[32:35], s71 offen offset:2048 sc1
  buffer_load_dwordx4 v[76:79], v1, s[32:35], s71 offen offset:3072 sc1
  buffer_load_dwordx4 v[96:99], v1, s[32:35], s73 offen offset:0 sc1
  buffer_load_dwordx4 v[100:103], v1, s[32:35], s73 offen offset:1024 sc1
  buffer_load_dwordx4 v[104:107], v1, s[32:35], s73 offen offset:2048 sc1
  buffer_load_dwordx4 v[108:111], v1, s[32:35], s73 offen offset:3072 sc1
  s_lshl_b32 s66, s49, 8
  s_add_u32 s66, s66, 142606336
  s_add_u32 s66, s66, s61
Lpw_153:
  buffer_load_dword v169, v4, s[32:35], s66 offen sc1
  s_waitcnt vmcnt(0)
  v_cmp_ge_u32 vcc, s77, v169
  s_cbranch_vccz Lpw_154
  s_sleep 2
  s_sub_u32 s69, s69, 1
  s_cbranch_scc0 Lpw_153
  s_endpgm
Lpw_154:
  s_lshl_b32 s70, s77, 18
  s_lshr_b32 s66, s49, 1
  s_lshl_b32 s66, s66, 14
  s_add_u32 s70, s70, s66
  s_and_b32 s66, s49, 1
  s_lshl_b32 s66, s66, 12
  s_add_u32 s70, s70, s66
  s_add_u32 s70, s70, 125829120
  s_lshr_b32 s66, s70, 8
  s_and_b32 s66, s66, 0x2000
  s_xor_b32 s66, s66, s61
  s_add_u32 s70, s70, s66
  s_lshl_b32 s66, s59, 11
  s_add_u32 s71, s70, s66
  buffer_load_dwordx4 v[80:83], v2, s[32:35], s70 offen offset:0 sc1
  buffer_load_dwordx4 v[84:87], v2, s[32:35], s70 offen offset:512 sc1
  buffer_load_dwordx4 v[88:91], v2, s[32:35], s70 offen offset:2048 sc1
  buffer_load_dwordx4 v[92:95], v2, s[32:35], s70 offen offset:2560 sc1
  buffer_load_dwordx2 v[112:113], v3, s[32:35], s71 offen offset:1024 sc1
  buffer_load_dwordx2 v[114:115], v3, s[32:35], s71 offen offset:1280 sc1
  buffer_load_dwordx2 v[116:117], v3, s[32:35], s71 offen offset:1536 sc1
  buffer_load_dwordx2 v[118:119], v3, s[32:35], s71 offen offset:1792 sc1
  v_mfma_f32_16x16x32_bf16 v[120:123], v[48:51], v[32:35], 0
  v_mfma_f32_16x16x32_bf16 v[124:127], v[64:67], v[32:35], 0
  v_mfma_f32_16x16x32_bf16 v[120:123], v[52:55], v[36:39], v[120:123]
  v_mfma_f32_16x16x32_bf16 v[124:127], v[68:71], v[36:39], v[124:127]
  v_mfma_f32_16x16x32_bf16 v[120:123], v[56:59], v[40:43], v[120:123]
  v_mfma_f32_16x16x32_bf16 v[124:127], v[72:75], v[40:43], v[124:127]
  v_mfma_f32_16x16x32_bf16 v[120:123], v[60:63], v[44:47], v[120:123]
  v_mfma_f32_16x16x32_bf16 v[124:127], v[76:79], v[44:47], v[124:127]
  s_waitcnt vmcnt(7)
  v_mfma_f32_16x16x32_bf16 v[128:131], v[80:83], v[32:35], 0
  s_waitcnt vmcnt(6)
  v_mfma_f32_16x16x32_bf16 v[128:131], v[84:87], v[36:39], v[128:131]
  s_waitcnt vmcnt(5)
  v_mfma_f32_16x16x32_bf16 v[128:131], v[88:91], v[40:43], v[128:131]
  s_waitcnt vmcnt(4)
  v_mfma_f32_16x16x32_bf16 v[128:131], v[92:95], v[44:47], v[128:131]
  v_mov_b32 v16, 0xff800000
  v_cndmask_b32 v120, v16, v120, s[78:79]
  v_cndmask_b32 v121, v16, v121, s[80:81]
  v_cndmask_b32 v122, v16, v122, s[82:83]
  v_cndmask_b32 v123, v16, v123, s[84:85]
  v_cndmask_b32 v124, v16, v124, s[86:87]
  v_cndmask_b32 v125, v16, v125, s[88:89]
  v_cndmask_b32 v126, v16, v126, s[90:91]
  v_cndmask_b32 v127, v16, v127, s[92:93]
  s_mov_b32 exec_lo, 0
  v_mov_b32 v128, v16
  v_mov_b32 v129, v16
  v_mov_b32 v130, v16
  v_mov_b32 v131, v16
  s_mov_b32 exec_lo, -1
  v_max3_f32 v16, v120, v121, v122
  v_max3_f32 v17, v123, v124, v125
  v_max3_f32 v16, v16, v126, v127
  v_max3_f32 v17, v17, v128, v129
  v_max3_f32 v16, v16, v130, v131
  v_max_f32 v16, v16, v17
  v_mov_b32 v17, v16
  s_nop 1
  v_permlane32_swap_b32 v16, v17
  v_max_f32 v16, v16, v17
  v_mov_b32 v17, v16
  s_nop 1
  v_permlane16_swap_b32 v16, v17
  v_max_f32 v16, v16, v17
  v_mul_f32 v16, s94, v16
  v_fma_f32 v120, v120, s94, -v16
  v_fma_f32 v121, v121, s94, -v16
  v_fma_f32 v122, v122, s94, -v16
  v_fma_f32 v123, v123, s94, -v16
  v_fma_f32 v124, v124, s94, -v16
  v_fma_f32 v125, v125, s94, -v16
  v_fma_f32 v126, v126, s94, -v16
  v_fma_f32 v127, v127, s94, -v16
  v_fma_f32 v128, v128, s94, -v16
  v_fma_f32 v129, v129, s94, -v16
  v_fma_f32 v130, v130, s94, -v16
  v_fma_f32 v131, v131, s94, -v16
  v_exp_f32 v120, v120
  v_exp_f32 v121, v121
  v_exp_f32 v122, v122
  v_exp_f32 v123, v123
  v_exp_f32 v124, v124
  v_exp_f32 v125, v125
  v_exp_f32 v126, v126
  v_exp_f32 v127, v127
  v_exp_f32 v128, v128
  v_exp_f32 v129, v129
  v_exp_f32 v130, v130
  v_exp_f32 v131, v131
  s_nop 0
  v_cvt_pk_bf16_f32 v132, v120, v121
  v_cvt_pk_bf16_f32 v133, v122, v123
  v_cvt_pk_bf16_f32 v134, v124, v125
  v_cvt_pk_bf16_f32 v135, v126, v127
  v_cvt_pk_bf16_f32 v136, v128, v129
  v_cvt_pk_bf16_f32 v137, v130, v131
  s_waitcnt vmcnt(0)
  s_nop 0
  v_mfma_f32_16x16x32_bf16 v[156:159], v[160:163], v[132:135], 0
  v_mfma_f32_16x16x32_bf16 v[140:143], v[96:99], v[132:135], 0
  v_mfma_f32_16x16x32_bf16 v[144:147], v[100:103], v[132:135], 0
  v_mfma_f32_16x16x32_bf16 v[148:151], v[104:107], v[132:135], 0
  v_mfma_f32_16x16x32_bf16 v[152:155], v[108:111], v[132:135], 0
  s_nop 1
  v_mfma_f32_16x16x16_bf16 v[156:159], v[160:161], v[136:137], v[156:159]
  v_mfma_f32_16x16x16_bf16 v[140:143], v[112:113], v[136:137], v[140:143]
  v_mfma_f32_16x16x16_bf16 v[144:147], v[114:115], v[136:137], v[144:147]
  v_mfma_f32_16x16x16_bf16 v[148:151], v[116:117], v[136:137], v[148:151]
  v_mfma_f32_16x16x16_bf16 v[152:155], v[118:119], v[136:137], v[152:155]
  s_lshl_b32 s70, s77, 18
  s_lshl_b32 s66, s58, 17
  s_add_u32 s70, s70, s66
  s_lshl_b32 s66, s49, 12
  s_add_u32 s70, s70, s66
  s_lshl_b32 s66, s59, 11
  s_add_u32 s70, s70, s66
  s_add_u32 s70, s70, 67108864
  v_rcp_f32 v16, v156
  s_nop 0
  v_pk_mul_f32 v[140:141], v[140:141], v[16:17] op_sel_hi:[1,0]
  v_pk_mul_f32 v[142:143], v[142:143], v[16:17] op_sel_hi:[1,0]
  v_pk_mul_f32 v[144:145], v[144:145], v[16:17] op_sel_hi:[1,0]
  v_pk_mul_f32 v[146:147], v[146:147], v[16:17] op_sel_hi:[1,0]
  v_pk_mul_f32 v[148:149], v[148:149], v[16:17] op_sel_hi:[1,0]
  v_pk_mul_f32 v[150:151], v[150:151], v[16:17] op_sel_hi:[1,0]
  v_pk_mul_f32 v[152:153], v[152:153], v[16:17] op_sel_hi:[1,0]
  v_pk_mul_f32 v[154:155], v[154:155], v[16:17] op_sel_hi:[1,0]
  v_cvt_pk_bf16_f32 v120, v140, v141
  v_cvt_pk_bf16_f32 v121, v142, v143
  v_cvt_pk_bf16_f32 v122, v144, v145
  v_cvt_pk_bf16_f32 v123, v146, v147
  v_cvt_pk_bf16_f32 v124, v148, v149
  v_cvt_pk_bf16_f32 v125, v150, v151
  v_cvt_pk_bf16_f32 v126, v152, v153
  v_cvt_pk_bf16_f32 v127, v154, v155
  buffer_store_dwordx4 v[120:123], v1, s[32:35], s70 offen offset:0 sc1
  buffer_store_dwordx4 v[124:127], v1, s[32:35], s70 offen offset:1024 sc1
  s_add_u32 s66, s48, 6
  s_add_u32 s62, s77, 3
  s_cmp_lt_u32 s62, 6
  s_cselect_b32 s66, s62, s66
  s_add_u32 s62, s62, 3
  s_cmp_lt_u32 s62, 12
  s_cselect_b32 s62, s66, s62
  v_cmp_ge_u32 vcc, s62, v169
  s_cbranch_vccz Lpw_156
  s_lshl_b32 s66, s49, 8
  s_add_u32 s66, s66, 142606336
  s_add_u32 s66, s66, s61
Lpw_155:
  buffer_load_dword v169, v4, s[32:35], s66 offen sc1
  s_waitcnt vmcnt(0)
  v_cmp_ge_u32 vcc, s62, v169
  s_cbranch_vccz Lpw_156
  s_sleep 2
  s_sub_u32 s69, s69, 1
  s_cbranch_scc0 Lpw_155
  s_endpgm
Lpw_156:
  s_lshl_b32 s70, s62, 18
  s_lshl_b32 s66, s49, 13
  s_add_u32 s70, s70, s66
  s_add_u32 s71, s70, 4096
  s_lshl_b32 s66, s58, 12
  s_add_u32 s72, s70, s66
  s_add_u32 s72, s72, 33554432
  s_lshl_b32 s66, s59, 12
  s_add_u32 s73, s70, s66
  s_add_u32 s73, s73, 16777216
  buffer_load_dwordx4 v[32:35], v1, s[32:35], s72 offen offset:0 sc1
  buffer_load_dwordx4 v[36:39], v1, s[32:35], s72 offen offset:1024 sc1
  buffer_load_dwordx4 v[40:43], v1, s[32:35], s72 offen offset:2048 sc1
  buffer_load_dwordx4 v[44:47], v1, s[32:35], s72 offen offset:3072 sc1
  buffer_load_dwordx4 v[48:51], v1, s[32:35], s70 offen offset:0 sc1
  buffer_load_dwordx4 v[52:55], v1, s[32:35], s70 offen offset:1024 sc1
  buffer_load_dwordx4 v[56:59], v1, s[32:35], s70 offen offset:2048 sc1
  buffer_load_dwordx4 v[60:63], v1, s[32:35], s70 offen offset:3072 sc1
  buffer_load_dwordx4 v[64:67], v1, s[32:35], s71 offen offset:0 sc1
  buffer_load_dwordx4 v[68:71], v1, s[32:35], s71 offen offset:1024 sc1
  buffer_load_dwordx4 v[72:75], v1, s[32:35], s71 offen offset:2048 sc1
  buffer_load_dwordx4 v[76:79], v1, s[32:35], s71 offen offset:3072 sc1
  buffer_load_dwordx4 v[96:99], v1, s[32:35], s73 offen offset:0 sc1
  buffer_load_dwordx4 v[100:103], v1, s[32:35], s73 offen offset:1024 sc1
  buffer_load_dwordx4 v[104:107], v1, s[32:35], s73 offen offset:2048 sc1
  buffer_load_dwordx4 v[108:111], v1, s[32:35], s73 offen offset:3072 sc1
  s_lshl_b32 s70, s62, 18
  s_lshr_b32 s66, s49, 1
  s_lshl_b32 s66, s66, 14
  s_add_u32 s70, s70, s66
  s_and_b32 s66, s49, 1
  s_lshl_b32 s66, s66, 12
  s_add_u32 s70, s70, s66
  s_add_u32 s70, s70, 125829120
  s_lshr_b32 s66, s70, 8
  s_and_b32 s66, s66, 0x2000
  s_xor_b32 s66, s66, s61
  s_add_u32 s70, s70, s66
  s_lshl_b32 s66, s59, 11
  s_add_u32 s71, s70, s66
  buffer_load_dwordx4 v[80:83], v2, s[32:35], s70 offen offset:0 sc1
  buffer_load_dwordx4 v[84:87], v2, s[32:35], s70 offen offset:512 sc1
  buffer_load_dwordx4 v[88:91], v2, s[32:35], s70 offen offset:2048 sc1
  buffer_load_dwordx4 v[92:95], v2, s[32:35], s70 offen offset:2560 sc1
  buffer_load_dwordx2 v[112:113], v3, s[32:35], s71 offen offset:1024 sc1
  buffer_load_dwordx2 v[114:115], v3, s[32:35], s71 offen offset:1280 sc1
  buffer_load_dwordx2 v[116:117], v3, s[32:35], s71 offen offset:1536 sc1
  buffer_load_dwordx2 v[118:119], v3, s[32:35], s71 offen offset:1792 sc1
  s_lshl_b32 s66, s49, 8
  s_add_u32 s66, s66, 142606336
  s_add_u32 s66, s66, s61
  buffer_load_dword v169, v4, s[32:35], s66 offen sc1
  s_waitcnt vmcnt(25)
  s_barrier
  s_cmp_lg_u32 s50, 0
  s_cbranch_scc1 Lan_157
  s_lshl_b32 s66, s77, 7
  s_add_u32 s66, s66, 99045440
  v_mov_b32 v16, 0
  v_mov_b32 v17, 1
  s_mov_b64 exec, 1
  buffer_atomic_add v17, v16, s[32:35], s66 offen sc1
  s_mov_b64 exec, -1
Lan_157:
  s_lshl_b32 s67, s77, 7
  s_add_u32 s67, s67, 99045440
  v_mov_b32 v16, 0
  buffer_load_dword v170, v16, s[32:35], s67 offen sc1
Lpipe:
  s_lshl_b32 s67, s77, 7
  s_add_u32 s67, s67, 99045440
  s_waitcnt vmcnt(0)
  v_cmp_le_u32 vcc, 32, v170
  s_cbranch_vccnz Lcn_158
  v_mov_b32 v16, 0
Lcn_159:
  buffer_load_dword v170, v16, s[32:35], s67 offen sc1
  s_waitcnt vmcnt(0)
  v_cmp_le_u32 vcc, 32, v170
  s_cbranch_vccnz Lcn_158
  s_sleep 2
  s_sub_u32 s69, s69, 1
  s_cbranch_scc0 Lcn_159
  s_endpgm
Lcn_158:
  s_lshl_b32 s72, s77, 7
  s_lshl_b32 s66, s58, 6
  s_add_u32 s72, s72, s66
  s_add_u32 s72, s72, 99024896
  s_lshl_b32 s73, s77, 16
  s_lshl_b32 s66, s49, 11
  s_add_u32 s73, s73, s66
  s_lshl_b32 s66, s58, 10
  s_add_u32 s73, s73, s66
  s_add_u32 s73, s73, 83886080
  buffer_load_dword v168, v7, s[32:35], s72 offen sc1
  buffer_load_dwordx4 v[164:167], v1, s[32:35], s73 offen sc1
  s_add_u32 s66, s48, 6
  s_add_u32 s68, s62, 3
  s_cmp_lt_u32 s68, 6
  s_cselect_b32 s66, s68, s66
  s_add_u32 s68, s68, 3
  s_cmp_lt_u32 s68, 12
  s_cselect_b32 s68, s66, s68
  s_cmp_lt_u32 s68, 32
  s_cbranch_scc1 Lall_160
  s_cmp_lg_u32 s64, 0
  s_cbranch_scc1 Lall_160
  s_mov_b32 s64, 1
  s_mov_b32 s67, 99046400
  s_cmp_lg_u32 s50, 0
  s_cbranch_scc1 Lbw_162
  v_mov_b32 v16, 0
Lbw_161:
  buffer_load_dword v17, v16, s[32:35], s67 offen sc1
  s_waitcnt vmcnt(0)
  v_cmp_le_u32 vcc, 0xc0, v17
  s_cbranch_vccnz Lbw_162
  s_sleep 2
  s_sub_u32 s69, s69, 1
  s_cbranch_scc0 Lbw_161
  s_endpgm
Lbw_162:
  s_barrier
Lall_160:
  s_cmp_ge_u32 s68, 54
  s_cbranch_scc1 Lpipe_last
  s_lshl_b32 s70, s77, 18
  s_lshl_b32 s66, s50, 15
  s_add_u32 s70, s70, s66
  s_add_u32 s70, s70, 67108864
  s_add_u32 s71, s70, 131072
  buffer_load_dwordx4 v[172:175], v1, s[32:35], s70 offen offset:0 sc1
  buffer_load_dwordx4 v[176:179], v1, s[32:35], s71 offen offset:0 sc1
  buffer_load_dwordx4 v[180:183], v1, s[32:35], s70 offen offset:1024 sc1
  buffer_load_dwordx4 v[184:187], v1, s[32:35], s71 offen offset:1024 sc1
  buffer_load_dwordx4 v[188:191], v1, s[32:35], s70 offen offset:2048 sc1
  buffer_load_dwordx4 v[192:195], v1, s[32:35], s71 offen offset:2048 sc1
  buffer_load_dwordx4 v[196:199], v1, s[32:35], s70 offen offset:3072 sc1
  buffer_load_dwordx4 v[200:203], v1, s[32:35], s71 offen offset:3072 sc1
  s_add_u32 s70, s70, 4096
  s_add_u32 s71, s71, 4096
  buffer_load_dwordx4 v[204:207], v1, s[32:35], s70 offen offset:0 sc1
  buffer_load_dwordx4 v[208:211], v1, s[32:35], s71 offen offset:0 sc1
  buffer_load_dwordx4 v[212:215], v1, s[32:35], s70 offen offset:1024 sc1
  buffer_load_dwordx4 v[216:219], v1, s[32:35], s71 offen offset:1024 sc1
  buffer_load_dwordx4 v[220:223], v1, s[32:35], s70 offen offset:2048 sc1
  buffer_load_dwordx4 v[224:227], v1, s[32:35], s71 offen offset:2048 sc1
  buffer_load_dwordx4 v[228:231], v1, s[32:35], s70 offen offset:3072 sc1
  buffer_load_dwordx4 v[232:235], v1, s[32:35], s71 offen offset:3072 sc1
  s_add_u32 s70, s70, 4096
  s_add_u32 s71, s71, 4096
  buffer_load_dwordx4 v[236:239], v1, s[32:35], s70 offen offset:0 sc1
  buffer_load_dwordx4 v[240:243], v1, s[32:35], s71 offen offset:0 sc1
  buffer_load_dwordx4 v[244:247], v1, s[32:35], s70 offen offset:1024 sc1
  s_mov_b32 s57, s70
  s_mov_b32 s63, s71
  s_waitcnt vmcnt(19)
  v_mfma_f32_16x16x32_bf16 v[120:123], v[48:51], v[32:35], 0
  v_mfma_f32_16x16x32_bf16 v[124:127], v[64:67], v[32:35], 0
  v_mfma_f32_16x16x32_bf16 v[120:123], v[52:55], v[36:39], v[120:123]
  v_mfma_f32_16x16x32_bf16 v[124:127], v[68:71], v[36:39], v[124:127]
  v_mfma_f32_16x16x32_bf16 v[120:123], v[56:59], v[40:43], v[120:123]
  v_mfma_f32_16x16x32_bf16 v[124:127], v[72:75], v[40:43], v[124:127]
  v_mfma_f32_16x16x32_bf16 v[120:123], v[60:63], v[44:47], v[120:123]
  v_mfma_f32_16x16x32_bf16 v[124:127], v[76:79], v[44:47], v[124:127]
  v_mfma_f32_16x16x32_bf16 v[128:131], v[80:83], v[32:35], 0
  v_mfma_f32_16x16x32_bf16 v[128:131], v[84:87], v[36:39], v[128:131]
  v_mfma_f32_16x16x32_bf16 v[128:131], v[88:91], v[40:43], v[128:131]
  v_mfma_f32_16x16x32_bf16 v[128:131], v[92:95], v[44:47], v[128:131]
  v_mov_b32 v16, 0xff800000
  v_cndmask_b32 v120, v16, v120, s[78:79]
  v_cndmask_b32 v121, v16, v121, s[80:81]
  v_cndmask_b32 v122, v16, v122, s[82:83]
  v_cndmask_b32 v123, v16, v123, s[84:85]
  v_cndmask_b32 v124, v16, v124, s[86:87]
  v_cndmask_b32 v125, v16, v125, s[88:89]
  v_cndmask_b32 v126, v16, v126, s[90:91]
  v_cndmask_b32 v127, v16, v127, s[92:93]
  s_mov_b32 exec_lo, 0
  v_mov_b32 v128, v16
  v_mov_b32 v129, v16
  v_mov_b32 v130, v16
  v_mov_b32 v131, v16
  s_mov_b32 exec_lo, -1
  v_max3_f32 v16, v120, v121, v122
  v_max3_f32 v17, v123, v124, v125
  v_max3_f32 v16, v16, v126, v127
  v_max3_f32 v17, v17, v128, v129
  v_max3_f32 v16, v16, v130, v131
  v_max_f32 v16, v16, v17
  v_mov_b32 v17, v16
  s_nop 1
  v_permlane32_swap_b32 v16, v17
  v_max_f32 v16, v16, v17
  v_mov_b32 v17, v16
  s_nop 1
  v_permlane16_swap_b32 v16, v17
  v_max_f32 v16, v16, v17
  v_mul_f32 v16, s94, v16
  v_fma_f32 v120, v120, s94, -v16
  v_fma_f32 v121, v121, s94, -v16
  v_fma_f32 v122, v122, s94, -v16
  v_fma_f32 v123, v123, s94, -v16
  v_fma_f32 v124, v124, s94, -v16
  v_fma_f32 v125, v125, s94, -v16
  v_fma_f32 v126, v126, s94, -v16
  v_fma_f32 v127, v127, s94, -v16
  v_fma_f32 v128, v128, s94, -v16
  v_fma_f32 v129, v129, s94, -v16
  v_fma_f32 v130, v130, s94, -v16
  v_fma_f32 v131, v131, s94, -v16
  v_exp_f32 v120, v120
  v_exp_f32 v121, v121
  v_exp_f32 v122, v122
  v_exp_f32 v123, v123
  v_exp_f32 v124, v124
  v_exp_f32 v125, v125
  v_exp_f32 v126, v126
  v_exp_f32 v127, v127
  v_exp_f32 v128, v128
  v_exp_f32 v129, v129
  v_exp_f32 v130, v130
  v_exp_f32 v131, v131
  s_nop 0
  v_cvt_pk_bf16_f32 v132, v120, v121
  v_cvt_pk_bf16_f32 v133, v122, v123
  v_cvt_pk_bf16_f32 v134, v124, v125
  v_cvt_pk_bf16_f32 v135, v126, v127
  v_cvt_pk_bf16_f32 v136, v128, v129
  v_cvt_pk_bf16_f32 v137, v130, v131
  s_nop 1
  v_mfma_f32_16x16x32_bf16 v[156:159], v[160:163], v[132:135], 0
  v_mfma_f32_16x16x32_bf16 v[140:143], v[96:99], v[132:135], 0
  v_mfma_f32_16x16x32_bf16 v[144:147], v[100:103], v[132:135], 0
  v_mfma_f32_16x16x32_bf16 v[148:151], v[104:107], v[132:135], 0
  v_mfma_f32_16x16x32_bf16 v[152:155], v[108:111], v[132:135], 0
  s_nop 1
  v_mfma_f32_16x16x16_bf16 v[156:159], v[160:161], v[136:137], v[156:159]
  v_mfma_f32_16x16x16_bf16 v[140:143], v[112:113], v[136:137], v[140:143]
  v_mfma_f32_16x16x16_bf16 v[144:147], v[114:115], v[136:137], v[144:147]
  v_mfma_f32_16x16x16_bf16 v[148:151], v[116:117], v[136:137], v[148:151]
  v_mfma_f32_16x16x16_bf16 v[152:155], v[118:119], v[136:137], v[152:155]
  s_lshl_b32 s70, s62, 18
  s_lshl_b32 s66, s58, 17
  s_add_u32 s70, s70, s66
  s_lshl_b32 s66, s49, 12
  s_add_u32 s70, s70, s66
  s_lshl_b32 s66, s59, 11
  s_add_u32 s70, s70, s66
  s_add_u32 s70, s70, 67108864
  v_rcp_f32 v16, v156
  s_nop 0
  v_pk_mul_f32 v[140:141], v[140:141], v[16:17] op_sel_hi:[1,0]
  v_pk_mul_f32 v[142:143], v[142:143], v[16:17] op_sel_hi:[1,0]
  v_pk_mul_f32 v[144:145], v[144:145], v[16:17] op_sel_hi:[1,0]
  v_pk_mul_f32 v[146:147], v[146:147], v[16:17] op_sel_hi:[1,0]
  v_pk_mul_f32 v[148:149], v[148:149], v[16:17] op_sel_hi:[1,0]
  v_pk_mul_f32 v[150:151], v[150:151], v[16:17] op_sel_hi:[1,0]
  v_pk_mul_f32 v[152:153], v[152:153], v[16:17] op_sel_hi:[1,0]
  v_pk_mul_f32 v[154:155], v[154:155], v[16:17] op_sel_hi:[1,0]
  v_cvt_pk_bf16_f32 v120, v140, v141
  v_cvt_pk_bf16_f32 v121, v142, v143
  v_cvt_pk_bf16_f32 v122, v144, v145
  v_cvt_pk_bf16_f32 v123, v146, v147
  v_cvt_pk_bf16_f32 v124, v148, v149
  v_cvt_pk_bf16_f32 v125, v150, v151
  v_cvt_pk_bf16_f32 v126, v152, v153
  v_cvt_pk_bf16_f32 v127, v154, v155
  buffer_store_dwordx4 v[120:123], v1, s[32:35], s70 offen offset:0 sc1
  buffer_store_dwordx4 v[124:127], v1, s[32:35], s70 offen offset:1024 sc1
  s_mov_b32 s70, s57
  s_mov_b32 s71, s63
  s_waitcnt vmcnt(20)
  v_mfma_f32_16x16x32_bf16 v[140:143], a[0:3], v[172:175], 0
  buffer_load_dwordx4 v[248:251], v1, s[32:35], s71 offen offset:1024 sc1
  v_mfma_f32_16x16x32_bf16 v[144:147], a[4:7], v[172:175], 0
  s_waitcnt vmcnt(20)
  v_mfma_f32_16x16x32_bf16 v[148:151], a[0:3], v[176:179], 0
  buffer_load_dwordx4 v[172:175], v1, s[32:35], s70 offen offset:2048 sc1
  v_mfma_f32_16x16x32_bf16 v[152:155], a[4:7], v[176:179], 0
  s_waitcnt vmcnt(20)
  v_mfma_f32_16x16x32_bf16 v[140:143], a[8:11], v[180:183], v[140:143]
  buffer_load_dwordx4 v[176:179], v1, s[32:35], s71 offen offset:2048 sc1
  v_mfma_f32_16x16x32_bf16 v[144:147], a[12:15], v[180:183], v[144:147]
  s_waitcnt vmcnt(20)
  v_mfma_f32_16x16x32_bf16 v[148:151], a[8:11], v[184:187], v[148:151]
  buffer_load_dwordx4 v[180:183], v1, s[32:35], s70 offen offset:3072 sc1
  v_mfma_f32_16x16x32_bf16 v[152:155], a[12:15], v[184:187], v[152:155]
  s_waitcnt vmcnt(20)
  v_mfma_f32_16x16x32_bf16 v[140:143], a[16:19], v[188:191], v[140:143]
  buffer_load_dwordx4 v[184:187], v1, s[32:35], s71 offen offset:3072 sc1
  v_mfma_f32_16x16x32_bf16 v[144:147], a[20:23], v[188:191], v[144:147]
  s_waitcnt vmcnt(20)
  v_mfma_f32_16x16x32_bf16 v[148:151], a[16:19], v[192:195], v[148:151]
  s_add_u32 s70, s70, 4096
  s_add_u32 s71, s71, 4096
  buffer_load_dwordx4 v[188:191], v1, s[32:35], s70 offen offset:0 sc1
  v_mfma_f32_16x16x32_bf16 v[152:155], a[20:23], v[192:195], v[152:155]
  s_waitcnt vmcnt(20)
  v_mfma_f32_16x16x32_bf16 v[140:143], a[24:27], v[196:199], v[140:143]
  buffer_load_dwordx4 v[192:195], v1, s[32:35], s71 offen offset:0 sc1
  v_mfma_f32_16x16x32_bf16 v[144:147], a[28:31], v[196:199], v[144:147]
  s_waitcnt vmcnt(20)
  v_mfma_f32_16x16x32_bf16 v[148:151], a[24:27], v[200:203], v[148:151]
  buffer_load_dwordx4 v[196:199], v1, s[32:35], s70 offen offset:1024 sc1
  v_mfma_f32_16x16x32_bf16 v[152:155], a[28:31], v[200:203], v[152:155]
  s_waitcnt vmcnt(20)
  v_mfma_f32_16x16x32_bf16 v[140:143], a[32:35], v[204:207], v[140:143]
  buffer_load_dwordx4 v[200:203], v1, s[32:35], s71 offen offset:1024 sc1
  v_mfma_f32_16x16x32_bf16 v[144:147], a[36:39], v[204:207], v[144:147]
  s_waitcnt vmcnt(20)
  v_mfma_f32_16x16x32_bf16 v[148:151], a[32:35], v[208:211], v[148:151]
  buffer_load_dwordx4 v[204:207], v1, s[32:35], s70 offen offset:2048 sc1
  v_mfma_f32_16x16x32_bf16 v[152:155], a[36:39], v[208:211], v[152:155]
  s_waitcnt vmcnt(20)
  v_mfma_f32_16x16x32_bf16 v[140:143], a[40:43], v[212:215], v[140:143]
  buffer_load_dwordx4 v[208:211], v1, s[32:35], s71 offen offset:2048 sc1
  v_mfma_f32_16x16x32_bf16 v[144:147], a[44:47], v[212:215], v[144:147]
  s_waitcnt vmcnt(20)
  v_mfma_f32_16x16x32_bf16 v[148:151], a[40:43], v[216:219], v[148:151]
  buffer_load_dwordx4 v[212:215], v1, s[32:35], s70 offen offset:3072 sc1
  v_mfma_f32_16x16x32_bf16 v[152:155], a[44:47], v[216:219], v[152:155]
  s_waitcnt vmcnt(20)
  v_mfma_f32_16x16x32_bf16 v[140:143], a[48:51], v[220:223], v[140:143]
  buffer_load_dwordx4 v[216:219], v1, s[32:35], s71 offen offset:3072 sc1
  v_mfma_f32_16x16x32_bf16 v[144:147], a[52:55], v[220:223], v[144:147]
  s_waitcnt vmcnt(20)
  v_mfma_f32_16x16x32_bf16 v[148:151], a[48:51], v[224:227], v[148:151]
  s_add_u32 s70, s70, 4096
  s_add_u32 s71, s71, 4096
  buffer_load_dwordx4 v[220:223], v1, s[32:35], s70 offen offset:0 sc1
  v_mfma_f32_16x16x32_bf16 v[152:155], a[52:55], v[224:227], v[152:155]
  s_waitcnt vmcnt(20)
  v_mfma_f32_16x16x32_bf16 v[140:143], a[56:59], v[228:231], v[140:143]
  buffer_load_dwordx4 v[224:227], v1, s[32:35], s71 offen offset:0 sc1
  v_mfma_f32_16x16x32_bf16 v[144:147], a[60:63], v[228:231], v[144:147]
  s_waitcnt vmcnt(20)
  v_mfma_f32_16x16x32_bf16 v[148:151], a[56:59], v[232:235], v[148:151]
  buffer_load_dwordx4 v[228:231], v1, s[32:35], s70 offen offset:1024 sc1
  v_mfma_f32_16x16x32_bf16 v[152:155], a[60:63], v[232:235], v[152:155]
  s_waitcnt vmcnt(20)
  v_mfma_f32_16x16x32_bf16 v[140:143], a[64:67], v[236:239], v[140:143]
  buffer_load_dwordx4 v[232:235], v1, s[32:35], s71 offen offset:1024 sc1
  v_mfma_f32_16x16x32_bf16 v[144:147], a[68:71], v[236:239], v[144:147]
  s_waitcnt vmcnt(20)
  v_mfma_f32_16x16x32_bf16 v[148:151], a[64:67], v[240:243], v[148:151]
  buffer_load_dwordx4 v[236:239], v1, s[32:35], s70 offen offset:2048 sc1
  v_mfma_f32_16x16x32_bf16 v[152:155], a[68:71], v[240:243], v[152:155]
  s_waitcnt vmcnt(20)
  v_mfma_f32_16x16x32_bf16 v[140:143], a[72:75], v[244:247], v[140:143]
  buffer_load_dwordx4 v[240:243], v1, s[32:35], s71 offen offset:2048 sc1
  v_mfma_f32_16x16x32_bf16 v[144:147], a[76:79], v[244:247], v[144:147]
  s_waitcnt vmcnt(18)
  s_barrier
  s_cmp_lg_u32 s50, 0
  s_cbranch_scc1 Lan_164
  s_lshl_b32 s66, s62, 7
  s_add_u32 s66, s66, 99045440
  v_mov_b32 v16, 0
  v_mov_b32 v17, 1
  s_mov_b64 exec, 1
  buffer_atomic_add v17, v16, s[32:35], s66 offen sc1
  s_mov_b64 exec, -1
Lan_164:
  s_waitcnt vmcnt(18)
  v_mfma_f32_16x16x32_bf16 v[148:151], a[72:75], v[248:251], v[148:151]
  buffer_load_dwordx4 v[244:247], v1, s[32:35], s70 offen offset:3072 sc1
  v_mfma_f32_16x16x32_bf16 v[152:155], a[76:79], v[248:251], v[152:155]
  s_waitcnt vmcnt(18)
  v_mfma_f32_16x16x32_bf16 v[140:143], a[80:83], v[172:175], v[140:143]
  buffer_load_dwordx4 v[248:251], v1, s[32:35], s71 offen offset:3072 sc1
  v_mfma_f32_16x16x32_bf16 v[144:147], a[84:87], v[172:175], v[144:147]
  s_waitcnt vmcnt(18)
  v_mfma_f32_16x16x32_bf16 v[148:151], a[80:83], v[176:179], v[148:151]
  s_add_u32 s70, s70, 4096
  s_add_u32 s71, s71, 4096
  buffer_load_dwordx4 v[172:175], v1, s[32:35], s70 offen offset:0 sc1
  v_mfma_f32_16x16x32_bf16 v[152:155], a[84:87], v[176:179], v[152:155]
  s_waitcnt vmcnt(18)
  v_mfma_f32_16x16x32_bf16 v[140:143], a[88:91], v[180:183], v[140:143]
  buffer_load_dwordx4 v[176:179], v1, s[32:35], s71 offen offset:0 sc1
  v_mfma_f32_16x16x32_bf16 v[144:147], a[92:95], v[180:183], v[144:147]
  s_waitcnt vmcnt(18)
  v_mfma_f32_16x16x32_bf16 v[148:151], a[88:91], v[184:187], v[148:151]
  buffer_load_dwordx4 v[180:183], v1, s[32:35], s70 offen offset:1024 sc1
  v_mfma_f32_16x16x32_bf16 v[152:155], a[92:95], v[184:187], v[152:155]
  s_waitcnt vmcnt(18)
  v_mfma_f32_16x16x32_bf16 v[140:143], a[96:99], v[188:191], v[140:143]
  buffer_load_dwordx4 v[184:187], v1, s[32:35], s71 offen offset:1024 sc1
  v_mfma_f32_16x16x32_bf16 v[144:147], a[100:103], v[188:191], v[144:147]
  s_waitcnt vmcnt(18)
  v_mfma_f32_16x16x32_bf16 v[148:151], a[96:99], v[192:195], v[148:151]
  buffer_load_dwordx4 v[188:191], v1, s[32:35], s70 offen offset:2048 sc1
  v_mfma_f32_16x16x32_bf16 v[152:155], a[100:103], v[192:195], v[152:155]
  s_waitcnt vmcnt(18)
  v_mfma_f32_16x16x32_bf16 v[140:143], a[104:107], v[196:199], v[140:143]
  buffer_load_dwordx4 v[192:195], v1, s[32:35], s71 offen offset:2048 sc1
  v_mfma_f32_16x16x32_bf16 v[144:147], a[108:111], v[196:199], v[144:147]
  s_waitcnt vmcnt(18)
  v_mfma_f32_16x16x32_bf16 v[148:151], a[104:107], v[200:203], v[148:151]
  buffer_load_dwordx4 v[196:199], v1, s[32:35], s70 offen offset:3072 sc1
  v_mfma_f32_16x16x32_bf16 v[152:155], a[108:111], v[200:203], v[152:155]
  s_waitcnt vmcnt(18)
  v_mfma_f32_16x16x32_bf16 v[140:143], a[112:115], v[204:207], v[140:143]
  buffer_load_dwordx4 v[200:203], v1, s[32:35], s71 offen offset:3072 sc1
  v_mfma_f32_16x16x32_bf16 v[144:147], a[116:119], v[204:207], v[144:147]
  s_waitcnt vmcnt(18)
  v_mfma_f32_16x16x32_bf16 v[148:151], a[112:115], v[208:211], v[148:151]
  s_add_u32 s70, s70, 4096
  s_add_u32 s71, s71, 4096
  buffer_load_dwordx4 v[204:207], v1, s[32:35], s70 offen offset:0 sc1
  v_mfma_f32_16x16x32_bf16 v[152:155], a[116:119], v[208:211], v[152:155]
  s_waitcnt vmcnt(18)
  v_mfma_f32_16x16x32_bf16 v[140:143], a[120:123], v[212:215], v[140:143]
  buffer_load_dwordx4 v[208:211], v1, s[32:35], s71 offen offset:0 sc1
  v_mfma_f32_16x16x32_bf16 v[144:147], a[124:127], v[212:215], v[144:147]
  s_waitcnt vmcnt(18)
  v_mfma_f32_16x16x32_bf16 v[148:151], a[120:123], v[216:219], v[148:151]
  buffer_load_dwordx4 v[212:215], v1, s[32:35], s70 offen offset:1024 sc1
  v_mfma_f32_16x16x32_bf16 v[152:155], a[124:127], v[216:219], v[152:155]
  s_waitcnt vmcnt(18)
  v_mfma_f32_16x16x32_bf16 v[140:143], a[128:131], v[220:223], v[140:143]
  buffer_load_dwordx4 v[216:219], v1, s[32:35], s71 offen offset:1024 sc1
  v_mfma_f32_16x16x32_bf16 v[144:147], a[132:135], v[220:223], v[144:147]
  s_waitcnt vmcnt(18)
  v_mfma_f32_16x16x32_bf16 v[148:151], a[128:131], v[224:227], v[148:151]
  buffer_load_dwordx4 v[220:223], v1, s[32:35], s70 offen offset:2048 sc1
  v_mfma_f32_16x16x32_bf16 v[152:155], a[132:135], v[224:227], v[152:155]
  s_waitcnt vmcnt(18)
  v_mfma_f32_16x16x32_bf16 v[140:143], a[136:139], v[228:231], v[140:143]
  buffer_load_dwordx4 v[224:227], v1, s[32:35], s71 offen offset:2048 sc1
  v_mfma_f32_16x16x32_bf16 v[144:147], a[140:143], v[228:231], v[144:147]
  s_waitcnt vmcnt(18)
  v_mfma_f32_16x16x32_bf16 v[148:151], a[136:139], v[232:235], v[148:151]
  buffer_load_dwordx4 v[228:231], v1, s[32:35], s70 offen offset:3072 sc1
  v_mfma_f32_16x16x32_bf16 v[152:155], a[140:143], v[232:235], v[152:155]
  s_waitcnt vmcnt(18)
  v_mfma_f32_16x16x32_bf16 v[140:143], a[144:147], v[236:239], v[140:143]
  buffer_load_dwordx4 v[232:235], v1, s[32:35], s71 offen offset:3072 sc1
  v_mfma_f32_16x16x32_bf16 v[144:147], a[148:151], v[236:239], v[144:147]
  s_waitcnt vmcnt(18)
  v_mfma_f32_16x16x32_bf16 v[148:151], a[144:147], v[240:243], v[148:151]
  s_add_u32 s70, s70, 4096
  s_add_u32 s71, s71, 4096
  buffer_load_dwordx4 v[236:239], v1, s[32:35], s70 offen offset:0 sc1
  v_mfma_f32_16x16x32_bf16 v[152:155], a[148:151], v[240:243], v[152:155]
  s_waitcnt vmcnt(18)
  v_mfma_f32_16x16x32_bf16 v[140:143], a[152:155], v[244:247], v[140:143]
  buffer_load_dwordx4 v[240:243], v1, s[32:35], s71 offen offset:0 sc1
  v_mfma_f32_16x16x32_bf16 v[144:147], a[156:159], v[244:247], v[144:147]
  s_waitcnt vmcnt(18)
  v_mfma_f32_16x16x32_bf16 v[148:151], a[152:155], v[248:251], v[148:151]
  buffer_load_dwordx4 v[244:247], v1, s[32:35], s70 offen offset:1024 sc1
  v_mfma_f32_16x16x32_bf16 v[152:155], a[156:159], v[248:251], v[152:155]
  s_waitcnt vmcnt(18)
  v_mfma_f32_16x16x32_bf16 v[140:143], a[160:163], v[172:175], v[140:143]
  buffer_load_dwordx4 v[248:251], v1, s[32:35], s71 offen offset:1024 sc1
  v_mfma_f32_16x16x32_bf16 v[144:147], a[164:167], v[172:175], v[144:147]
  s_waitcnt vmcnt(18)
  v_mfma_f32_16x16x32_bf16 v[148:151], a[160:163], v[176:179], v[148:151]
  buffer_load_dwordx4 v[172:175], v1, s[32:35], s70 offen offset:2048 sc1
  v_mfma_f32_16x16x32_bf16 v[152:155], a[164:167], v[176:179], v[152:155]
  s_waitcnt vmcnt(18)
  v_mfma_f32_16x16x32_bf16 v[140:143], a[168:171], v[180:183], v[140:143]
  buffer_load_dwordx4 v[176:179], v1, s[32:35], s71 offen offset:2048 sc1
  v_mfma_f32_16x16x32_bf16 v[144:147], a[172:175], v[180:183], v[144:147]
  s_waitcnt vmcnt(18)
  v_mfma_f32_16x16x32_bf16 v[148:151], a[168:171], v[184:187], v[148:151]
  buffer_load_dwordx4 v[180:183], v1, s[32:35], s70 offen offset:3072 sc1
  v_mfma_f32_16x16x32_bf16 v[152:155], a[172:175], v[184:187], v[152:155]
  s_waitcnt vmcnt(18)
  v_mfma_f32_16x16x32_bf16 v[140:143], a[176:179], v[188:191], v[140:143]
  buffer_load_dwordx4 v[184:187], v1, s[32:35], s71 offen offset:3072 sc1
  v_mfma_f32_16x16x32_bf16 v[144:147], a[180:183], v[188:191], v[144:147]
  v_cmp_ge_u32 vcc, s68, v169
  s_cbranch_vccz Lpw_166
  s_lshl_b32 s66, s49, 8
  s_add_u32 s66, s66, 142606336
  s_add_u32 s66, s66, s61
Lpw_165:
  buffer_load_dword v169, v4, s[32:35], s66 offen sc1
  s_waitcnt vmcnt(0)
  v_cmp_ge_u32 vcc, s68, v169
  s_cbranch_vccz Lpw_166
  s_sleep 2
  s_sub_u32 s69, s69, 1
  s_cbranch_scc0 Lpw_165
  s_endpgm
Lpw_166:
  s_lshl_b32 s70, s68, 18
  s_lshl_b32 s66, s49, 13
  s_add_u32 s70, s70, s66
  s_add_u32 s71, s70, 4096
  s_lshl_b32 s66, s58, 12
  s_add_u32 s72, s70, s66
  s_add_u32 s72, s72, 33554432
  s_lshl_b32 s66, s59, 12
  s_add_u32 s73, s70, s66
  s_add_u32 s73, s73, 16777216
  buffer_load_dwordx4 v[32:35], v1, s[32:35], s72 offen offset:0 sc1
  buffer_load_dwordx4 v[36:39], v1, s[32:35], s72 offen offset:1024 sc1
  buffer_load_dwordx4 v[40:43], v1, s[32:35], s72 offen offset:2048 sc1
  buffer_load_dwordx4 v[44:47], v1, s[32:35], s72 offen offset:3072 sc1
  buffer_load_dwordx4 v[48:51], v1, s[32:35], s70 offen offset:0 sc1
  buffer_load_dwordx4 v[52:55], v1, s[32:35], s70 offen offset:1024 sc1
  buffer_load_dwordx4 v[56:59], v1, s[32:35], s70 offen offset:2048 sc1
  buffer_load_dwordx4 v[60:63], v1, s[32:35], s70 offen offset:3072 sc1
  buffer_load_dwordx4 v[64:67], v1, s[32:35], s71 offen offset:0 sc1
  buffer_load_dwordx4 v[68:71], v1, s[32:35], s71 offen offset:1024 sc1
  buffer_load_dwordx4 v[72:75], v1, s[32:35], s71 offen offset:2048 sc1
  buffer_load_dwordx4 v[76:79], v1, s[32:35], s71 offen offset:3072 sc1
  buffer_load_dwordx4 v[96:99], v1, s[32:35], s73 offen offset:0 sc1
  buffer_load_dwordx4 v[100:103], v1, s[32:35], s73 offen offset:1024 sc1
  buffer_load_dwordx4 v[104:107], v1, s[32:35], s73 offen offset:2048 sc1
  buffer_load_dwordx4 v[108:111], v1, s[32:35], s73 offen offset:3072 sc1
  s_lshl_b32 s70, s68, 18
  s_lshr_b32 s66, s49, 1
  s_lshl_b32 s66, s66, 14
  s_add_u32 s70, s70, s66
  s_and_b32 s66, s49, 1
  s_lshl_b32 s66, s66, 12
  s_add_u32 s70, s70, s66
  s_add_u32 s70, s70, 125829120
  s_lshr_b32 s66, s70, 8
  s_and_b32 s66, s66, 0x2000
  s_xor_b32 s66, s66, s61
  s_add_u32 s70, s70, s66
  s_lshl_b32 s66, s59, 11
  s_add_u32 s71, s70, s66
  buffer_load_dwordx4 v[80:83], v2, s[32:35], s70 offen offset:0 sc1
  buffer_load_dwordx4 v[84:87], v2, s[32:35], s70 offen offset:512 sc1
  buffer_load_dwordx4 v[88:91], v2, s[32:35], s70 offen offset:2048 sc1
  buffer_load_dwordx4 v[92:95], v2, s[32:35], s70 offen offset:2560 sc1
  buffer_load_dwordx2 v[112:113], v3, s[32:35], s71 offen offset:1024 sc1
  buffer_load_dwordx2 v[114:115], v3, s[32:35], s71 offen offset:1280 sc1
  buffer_load_dwordx2 v[116:117], v3, s[32:35], s71 offen offset:1536 sc1
  buffer_load_dwordx2 v[118:119], v3, s[32:35], s71 offen offset:1792 sc1
  s_lshl_b32 s66, s49, 8
  s_add_u32 s66, s66, 142606336
  s_add_u32 s66, s66, s61
  buffer_load_dword v169, v4, s[32:35], s66 offen sc1
  s_lshl_b32 s67, s62, 7
  s_add_u32 s67, s67, 99045440
  v_mov_b32 v16, 0
  buffer_load_dword v170, v16, s[32:35], s67 offen sc1
  s_waitcnt vmcnt(44)
  v_mfma_f32_16x16x32_bf16 v[148:151], a[176:179], v[192:195], v[148:151]
  v_mfma_f32_16x16x32_bf16 v[152:155], a[180:183], v[192:195], v[152:155]
  s_waitcnt vmcnt(43)
  v_mfma_f32_16x16x32_bf16 v[140:143], a[184:187], v[196:199], v[140:143]
  v_mfma_f32_16x16x32_bf16 v[144:147], a[188:191], v[196:199], v[144:147]
  s_waitcnt vmcnt(42)
  v_mfma_f32_16x16x32_bf16 v[148:151], a[184:187], v[200:203], v[148:151]
  v_mfma_f32_16x16x32_bf16 v[152:155], a[188:191], v[200:203], v[152:155]
  s_waitcnt vmcnt(41)
  v_mfma_f32_16x16x32_bf16 v[140:143], a[192:195], v[204:207], v[140:143]
  v_mfma_f32_16x16x32_bf16 v[144:147], a[196:199], v[204:207], v[144:147]
  s_waitcnt vmcnt(40)
  v_mfma_f32_16x16x32_bf16 v[148:151], a[192:195], v[208:211], v[148:151]
  v_mfma_f32_16x16x32_bf16 v[152:155], a[196:199], v[208:211], v[152:155]
  s_waitcnt vmcnt(39)
  v_mfma_f32_16x16x32_bf16 v[140:143], a[200:203], v[212:215], v[140:143]
  v_mfma_f32_16x16x32_bf16 v[144:147], a[204:207], v[212:215], v[144:147]
  s_waitcnt vmcnt(38)
  v_mfma_f32_16x16x32_bf16 v[148:151], a[200:203], v[216:219], v[148:151]
  v_mfma_f32_16x16x32_bf16 v[152:155], a[204:207], v[216:219], v[152:155]
  s_waitcnt vmcnt(37)
  v_mfma_f32_16x16x32_bf16 v[140:143], a[208:211], v[220:223], v[140:143]
  v_mfma_f32_16x16x32_bf16 v[144:147], a[212:215], v[220:223], v[144:147]
  s_waitcnt vmcnt(36)
  v_mfma_f32_16x16x32_bf16 v[148:151], a[208:211], v[224:227], v[148:151]
  v_mfma_f32_16x16x32_bf16 v[152:155], a[212:215], v[224:227], v[152:155]
  s_waitcnt vmcnt(35)
  v_mfma_f32_16x16x32_bf16 v[140:143], a[216:219], v[228:231], v[140:143]
  v_mfma_f32_16x16x32_bf16 v[144:147], a[220:223], v[228:231], v[144:147]
  s_waitcnt vmcnt(34)
  v_mfma_f32_16x16x32_bf16 v[148:151], a[216:219], v[232:235], v[148:151]
  v_mfma_f32_16x16x32_bf16 v[152:155], a[220:223], v[232:235], v[152:155]
  s_waitcnt vmcnt(33)
  v_mfma_f32_16x16x32_bf16 v[140:143], a[224:227], v[236:239], v[140:143]
  v_mfma_f32_16x16x32_bf16 v[144:147], a[228:231], v[236:239], v[144:147]
  s_waitcnt vmcnt(32)
  v_mfma_f32_16x16x32_bf16 v[148:151], a[224:227], v[240:243], v[148:151]
  v_mfma_f32_16x16x32_bf16 v[152:155], a[228:231], v[240:243], v[152:155]
  s_waitcnt vmcnt(31)
  v_mfma_f32_16x16x32_bf16 v[140:143], a[232:235], v[244:247], v[140:143]
  v_mfma_f32_16x16x32_bf16 v[144:147], a[236:239], v[244:247], v[144:147]
  s_waitcnt vmcnt(30)
  v_mfma_f32_16x16x32_bf16 v[148:151], a[232:235], v[248:251], v[148:151]
  v_mfma_f32_16x16x32_bf16 v[152:155], a[236:239], v[248:251], v[152:155]
  s_waitcnt vmcnt(29)
  v_mfma_f32_16x16x32_bf16 v[140:143], a[240:243], v[172:175], v[140:143]
  v_mfma_f32_16x16x32_bf16 v[144:147], a[244:247], v[172:175], v[144:147]
  s_waitcnt vmcnt(28)
  v_mfma_f32_16x16x32_bf16 v[148:151], a[240:243], v[176:179], v[148:151]
  v_mfma_f32_16x16x32_bf16 v[152:155], a[244:247], v[176:179], v[152:155]
  s_waitcnt vmcnt(27)
  v_mfma_f32_16x16x32_bf16 v[140:143], a[248:251], v[180:183], v[140:143]
  v_mfma_f32_16x16x32_bf16 v[144:147], a[252:255], v[180:183], v[144:147]
  s_waitcnt vmcnt(26)
  v_mfma_f32_16x16x32_bf16 v[148:151], a[248:251], v[184:187], v[148:151]
  v_mfma_f32_16x16x32_bf16 v[152:155], a[252:255], v[184:187], v[152:155]
  s_lshl_b32 s66, s50, 12
  v_add_u32 v16, s66, v1
  s_lshl_b32 s66, s50, 11
  v_add_u32 v17, s66, v1
  s_nop 3
  ds_write_b128 v16, v[140:143] offset:0
  ds_write_b128 v16, v[144:147] offset:1024
  ds_write_b128 v16, v[148:151] offset:2048
  ds_write_b128 v16, v[152:155] offset:3072
  s_waitcnt lgkmcnt(0)
  s_barrier
  s_cmp_ge_u32 s50, 2
  s_cbranch_scc1 Lep_167
  ds_read_b128 v[172:175], v17 offset:0
  ds_read_b128 v[176:179], v17 offset:1024
  ds_read_b128 v[180:183], v17 offset:4096
  ds_read_b128 v[184:187], v17 offset:5120
  ds_read_b128 v[188:191], v17 offset:8192
  ds_read_b128 v[192:195], v17 offset:9216
  ds_read_b128 v[196:199], v17 offset:12288
  ds_read_b128 v[200:203], v17 offset:13312
  v_sub_f32 v18, 1.0, v168
  v_cvt_pk_bf16_f32 v18, v18, v18
  v_lshlrev_b32 v18, 16, v18
  s_lshl_b32 s70, s77, 16
  s_lshl_b32 s66, s58, 15
  s_add_u32 s70, s70, s66
  s_lshl_b32 s66, s49, 6
  s_add_u32 s70, s70, s66
  v_lshlrev_b32 v204, 16, v164
  v_and_b32 v205, 0xffff0000, v164
  v_mul_f32 v204, v18, v204
  v_mul_f32 v205, v18, v205
  v_cvt_pk_bf16_f32 v164, v204, v205
  v_lshlrev_b32 v206, 16, v165
  v_and_b32 v207, 0xffff0000, v165
  v_mul_f32 v206, v18, v206
  v_mul_f32 v207, v18, v207
  v_cvt_pk_bf16_f32 v165, v206, v207
  v_lshlrev_b32 v208, 16, v166
  v_and_b32 v209, 0xffff0000, v166
  v_mul_f32 v208, v18, v208
  v_mul_f32 v209, v18, v209
  v_cvt_pk_bf16_f32 v166, v208, v209
  v_lshlrev_b32 v210, 16, v167
  v_and_b32 v211, 0xffff0000, v167
  v_mul_f32 v210, v18, v210
  v_mul_f32 v211, v18, v211
  v_cvt_pk_bf16_f32 v167, v210, v211
  s_waitcnt lgkmcnt(0)
  v_pk_add_f32 v[172:173], v[172:173], v[180:181]
  v_pk_add_f32 v[188:189], v[188:189], v[196:197]
  v_pk_add_f32 v[174:175], v[174:175], v[182:183]
  v_pk_add_f32 v[190:191], v[190:191], v[198:199]
  v_pk_add_f32 v[176:177], v[176:177], v[184:185]
  v_pk_add_f32 v[192:193], v[192:193], v[200:201]
  v_pk_add_f32 v[178:179], v[178:179], v[186:187]
  v_pk_add_f32 v[194:195], v[194:195], v[202:203]
  v_pk_add_f32 v[172:173], v[172:173], v[188:189]
  v_cvt_pk_bf16_f32 v19, v172, v173
  v_lshlrev_b32 v172, 16, v19
  v_and_b32 v173, 0xffff0000, v19
  v_mul_f32 v172, v168, v172
  v_mul_f32 v173, v168, v173
  v_cvt_pk_bf16_f32 v19, v172, v173
  v_lshlrev_b32 v172, 16, v19
  v_and_b32 v173, 0xffff0000, v19
  v_lshlrev_b32 v20, 16, v164
  v_and_b32 v21, 0xffff0000, v164
  v_add_f32 v172, v172, v20
  v_add_f32 v173, v173, v21
  v_cvt_pk_bf16_f32 v204, v172, v173
  v_pk_add_f32 v[174:175], v[174:175], v[190:191]
  v_cvt_pk_bf16_f32 v19, v174, v175
  v_lshlrev_b32 v174, 16, v19
  v_and_b32 v175, 0xffff0000, v19
  v_mul_f32 v174, v168, v174
  v_mul_f32 v175, v168, v175
  v_cvt_pk_bf16_f32 v19, v174, v175
  v_lshlrev_b32 v174, 16, v19
  v_and_b32 v175, 0xffff0000, v19
  v_lshlrev_b32 v20, 16, v165
  v_and_b32 v21, 0xffff0000, v165
  v_add_f32 v174, v174, v20
  v_add_f32 v175, v175, v21
  v_cvt_pk_bf16_f32 v205, v174, v175
  v_pk_add_f32 v[176:177], v[176:177], v[192:193]
  v_cvt_pk_bf16_f32 v19, v176, v177
  v_lshlrev_b32 v176, 16, v19
  v_and_b32 v177, 0xffff0000, v19
  v_mul_f32 v176, v168, v176
  v_mul_f32 v177, v168, v177
  v_cvt_pk_bf16_f32 v19, v176, v177
  v_lshlrev_b32 v176, 16, v19
  v_and_b32 v177, 0xffff0000, v19
  v_lshlrev_b32 v20, 16, v166
  v_and_b32 v21, 0xffff0000, v166
  v_add_f32 v176, v176, v20
  v_add_f32 v177, v177, v21
  v_cvt_pk_bf16_f32 v206, v176, v177
  v_pk_add_f32 v[178:179], v[178:179], v[194:195]
  v_cvt_pk_bf16_f32 v19, v178, v179
  v_lshlrev_b32 v178, 16, v19
  v_and_b32 v179, 0xffff0000, v19
  v_mul_f32 v178, v168, v178
  v_mul_f32 v179, v168, v179
  v_cvt_pk_bf16_f32 v19, v178, v179
  v_lshlrev_b32 v178, 16, v19
  v_and_b32 v179, 0xffff0000, v19
  v_lshlrev_b32 v20, 16, v167
  v_and_b32 v21, 0xffff0000, v167
  v_add_f32 v178, v178, v20
  v_add_f32 v179, v179, v21
  v_cvt_pk_bf16_f32 v207, v178, v179
  s_nop 1
  v_permlane16_swap_b32 v204, v206
  v_permlane16_swap_b32 v205, v207
  buffer_store_dwordx4 v[204:207], v5, s[44:47], s70 offen
Lep_167:
  s_mov_b32 s77, s62
  s_mov_b32 s62, s68
  s_branch Lpipe
Lpipe_last:
  s_lshl_b32 s70, s77, 18
  s_lshl_b32 s66, s50, 15
  s_add_u32 s70, s70, s66
  s_add_u32 s70, s70, 67108864
  s_add_u32 s71, s70, 131072
  buffer_load_dwordx4 v[172:175], v1, s[32:35], s70 offen offset:0 sc1
  buffer_load_dwordx4 v[176:179], v1, s[32:35], s71 offen offset:0 sc1
  buffer_load_dwordx4 v[180:183], v1, s[32:35], s70 offen offset:1024 sc1
  buffer_load_dwordx4 v[184:187], v1, s[32:35], s71 offen offset:1024 sc1
  buffer_load_dwordx4 v[188:191], v1, s[32:35], s70 offen offset:2048 sc1
  buffer_load_dwordx4 v[192:195], v1, s[32:35], s71 offen offset:2048 sc1
  buffer_load_dwordx4 v[196:199], v1, s[32:35], s70 offen offset:3072 sc1
  buffer_load_dwordx4 v[200:203], v1, s[32:35], s71 offen offset:3072 sc1
  s_add_u32 s70, s70, 4096
  s_add_u32 s71, s71, 4096
  buffer_load_dwordx4 v[204:207], v1, s[32:35], s70 offen offset:0 sc1
  buffer_load_dwordx4 v[208:211], v1, s[32:35], s71 offen offset:0 sc1
  buffer_load_dwordx4 v[212:215], v1, s[32:35], s70 offen offset:1024 sc1
  buffer_load_dwordx4 v[216:219], v1, s[32:35], s71 offen offset:1024 sc1
  buffer_load_dwordx4 v[220:223], v1, s[32:35], s70 offen offset:2048 sc1
  buffer_load_dwordx4 v[224:227], v1, s[32:35], s71 offen offset:2048 sc1
  buffer_load_dwordx4 v[228:231], v1, s[32:35], s70 offen offset:3072 sc1
  buffer_load_dwordx4 v[232:235], v1, s[32:35], s71 offen offset:3072 sc1
  s_add_u32 s70, s70, 4096
  s_add_u32 s71, s71, 4096
  buffer_load_dwordx4 v[236:239], v1, s[32:35], s70 offen offset:0 sc1
  buffer_load_dwordx4 v[240:243], v1, s[32:35], s71 offen offset:0 sc1
  buffer_load_dwordx4 v[244:247], v1, s[32:35], s70 offen offset:1024 sc1
  s_mov_b32 s57, s70
  s_mov_b32 s63, s71
  s_waitcnt vmcnt(19)
  v_mfma_f32_16x16x32_bf16 v[120:123], v[48:51], v[32:35], 0
  v_mfma_f32_16x16x32_bf16 v[124:127], v[64:67], v[32:35], 0
  v_mfma_f32_16x16x32_bf16 v[120:123], v[52:55], v[36:39], v[120:123]
  v_mfma_f32_16x16x32_bf16 v[124:127], v[68:71], v[36:39], v[124:127]
  v_mfma_f32_16x16x32_bf16 v[120:123], v[56:59], v[40:43], v[120:123]
  v_mfma_f32_16x16x32_bf16 v[124:127], v[72:75], v[40:43], v[124:127]
  v_mfma_f32_16x16x32_bf16 v[120:123], v[60:63], v[44:47], v[120:123]
  v_mfma_f32_16x16x32_bf16 v[124:127], v[76:79], v[44:47], v[124:127]
  v_mfma_f32_16x16x32_bf16 v[128:131], v[80:83], v[32:35], 0
  v_mfma_f32_16x16x32_bf16 v[128:131], v[84:87], v[36:39], v[128:131]
  v_mfma_f32_16x16x32_bf16 v[128:131], v[88:91], v[40:43], v[128:131]
  v_mfma_f32_16x16x32_bf16 v[128:131], v[92:95], v[44:47], v[128:131]
  v_mov_b32 v16, 0xff800000
  v_cndmask_b32 v120, v16, v120, s[78:79]
  v_cndmask_b32 v121, v16, v121, s[80:81]
  v_cndmask_b32 v122, v16, v122, s[82:83]
  v_cndmask_b32 v123, v16, v123, s[84:85]
  v_cndmask_b32 v124, v16, v124, s[86:87]
  v_cndmask_b32 v125, v16, v125, s[88:89]
  v_cndmask_b32 v126, v16, v126, s[90:91]
  v_cndmask_b32 v127, v16, v127, s[92:93]
  s_mov_b32 exec_lo, 0
  v_mov_b32 v128, v16
  v_mov_b32 v129, v16
  v_mov_b32 v130, v16
  v_mov_b32 v131, v16
  s_mov_b32 exec_lo, -1
  v_max3_f32 v16, v120, v121, v122
  v_max3_f32 v17, v123, v124, v125
  v_max3_f32 v16, v16, v126, v127
  v_max3_f32 v17, v17, v128, v129
  v_max3_f32 v16, v16, v130, v131
  v_max_f32 v16, v16, v17
  v_mov_b32 v17, v16
  s_nop 1
  v_permlane32_swap_b32 v16, v17
  v_max_f32 v16, v16, v17
  v_mov_b32 v17, v16
  s_nop 1
  v_permlane16_swap_b32 v16, v17
  v_max_f32 v16, v16, v17
  v_mul_f32 v16, s94, v16
  v_fma_f32 v120, v120, s94, -v16
  v_fma_f32 v121, v121, s94, -v16
  v_fma_f32 v122, v122, s94, -v16
  v_fma_f32 v123, v123, s94, -v16
  v_fma_f32 v124, v124, s94, -v16
  v_fma_f32 v125, v125, s94, -v16
  v_fma_f32 v126, v126, s94, -v16
  v_fma_f32 v127, v127, s94, -v16
  v_fma_f32 v128, v128, s94, -v16
  v_fma_f32 v129, v129, s94, -v16
  v_fma_f32 v130, v130, s94, -v16
  v_fma_f32 v131, v131, s94, -v16
  v_exp_f32 v120, v120
  v_exp_f32 v121, v121
  v_exp_f32 v122, v122
  v_exp_f32 v123, v123
  v_exp_f32 v124, v124
  v_exp_f32 v125, v125
  v_exp_f32 v126, v126
  v_exp_f32 v127, v127
  v_exp_f32 v128, v128
  v_exp_f32 v129, v129
  v_exp_f32 v130, v130
  v_exp_f32 v131, v131
  s_nop 0
  v_cvt_pk_bf16_f32 v132, v120, v121
  v_cvt_pk_bf16_f32 v133, v122, v123
  v_cvt_pk_bf16_f32 v134, v124, v125
  v_cvt_pk_bf16_f32 v135, v126, v127
  v_cvt_pk_bf16_f32 v136, v128, v129
  v_cvt_pk_bf16_f32 v137, v130, v131
  s_nop 1
  v_mfma_f32_16x16x32_bf16 v[156:159], v[160:163], v[132:135], 0
  v_mfma_f32_16x16x32_bf16 v[140:143], v[96:99], v[132:135], 0
  v_mfma_f32_16x16x32_bf16 v[144:147], v[100:103], v[132:135], 0
  v_mfma_f32_16x16x32_bf16 v[148:151], v[104:107], v[132:135], 0
  v_mfma_f32_16x16x32_bf16 v[152:155], v[108:111], v[132:135], 0
  s_nop 1
  v_mfma_f32_16x16x16_bf16 v[156:159], v[160:161], v[136:137], v[156:159]
  v_mfma_f32_16x16x16_bf16 v[140:143], v[112:113], v[136:137], v[140:143]
  v_mfma_f32_16x16x16_bf16 v[144:147], v[114:115], v[136:137], v[144:147]
  v_mfma_f32_16x16x16_bf16 v[148:151], v[116:117], v[136:137], v[148:151]
  v_mfma_f32_16x16x16_bf16 v[152:155], v[118:119], v[136:137], v[152:155]
  s_lshl_b32 s70, s62, 18
  s_lshl_b32 s66, s58, 17
  s_add_u32 s70, s70, s66
  s_lshl_b32 s66, s49, 12
  s_add_u32 s70, s70, s66
  s_lshl_b32 s66, s59, 11
  s_add_u32 s70, s70, s66
  s_add_u32 s70, s70, 67108864
  v_rcp_f32 v16, v156
  s_nop 0
  v_pk_mul_f32 v[140:141], v[140:141], v[16:17] op_sel_hi:[1,0]
  v_pk_mul_f32 v[142:143], v[142:143], v[16:17] op_sel_hi:[1,0]
  v_pk_mul_f32 v[144:145], v[144:145], v[16:17] op_sel_hi:[1,0]
  v_pk_mul_f32 v[146:147], v[146:147], v[16:17] op_sel_hi:[1,0]
  v_pk_mul_f32 v[148:149], v[148:149], v[16:17] op_sel_hi:[1,0]
  v_pk_mul_f32 v[150:151], v[150:151], v[16:17] op_sel_hi:[1,0]
  v_pk_mul_f32 v[152:153], v[152:153], v[16:17] op_sel_hi:[1,0]
  v_pk_mul_f32 v[154:155], v[154:155], v[16:17] op_sel_hi:[1,0]
  v_cvt_pk_bf16_f32 v120, v140, v141
  v_cvt_pk_bf16_f32 v121, v142, v143
  v_cvt_pk_bf16_f32 v122, v144, v145
  v_cvt_pk_bf16_f32 v123, v146, v147
  v_cvt_pk_bf16_f32 v124, v148, v149
  v_cvt_pk_bf16_f32 v125, v150, v151
  v_cvt_pk_bf16_f32 v126, v152, v153
  v_cvt_pk_bf16_f32 v127, v154, v155
  buffer_store_dwordx4 v[120:123], v1, s[32:35], s70 offen offset:0 sc1
  buffer_store_dwordx4 v[124:127], v1, s[32:35], s70 offen offset:1024 sc1
  s_mov_b32 s70, s57
  s_mov_b32 s71, s63
  s_waitcnt vmcnt(20)
  v_mfma_f32_16x16x32_bf16 v[140:143], a[0:3], v[172:175], 0
  buffer_load_dwordx4 v[248:251], v1, s[32:35], s71 offen offset:1024 sc1
  v_mfma_f32_16x16x32_bf16 v[144:147], a[4:7], v[172:175], 0
  s_waitcnt vmcnt(20)
  v_mfma_f32_16x16x32_bf16 v[148:151], a[0:3], v[176:179], 0
  buffer_load_dwordx4 v[172:175], v1, s[32:35], s70 offen offset:2048 sc1
  v_mfma_f32_16x16x32_bf16 v[152:155], a[4:7], v[176:179], 0
  s_waitcnt vmcnt(20)
  v_mfma_f32_16x16x32_bf16 v[140:143], a[8:11], v[180:183], v[140:143]
  buffer_load_dwordx4 v[176:179], v1, s[32:35], s71 offen offset:2048 sc1
  v_mfma_f32_16x16x32_bf16 v[144:147], a[12:15], v[180:183], v[144:147]
  s_waitcnt vmcnt(20)
  v_mfma_f32_16x16x32_bf16 v[148:151], a[8:11], v[184:187], v[148:151]
  buffer_load_dwordx4 v[180:183], v1, s[32:35], s70 offen offset:3072 sc1
  v_mfma_f32_16x16x32_bf16 v[152:155], a[12:15], v[184:187], v[152:155]
  s_waitcnt vmcnt(20)
  v_mfma_f32_16x16x32_bf16 v[140:143], a[16:19], v[188:191], v[140:143]
  buffer_load_dwordx4 v[184:187], v1, s[32:35], s71 offen offset:3072 sc1
  v_mfma_f32_16x16x32_bf16 v[144:147], a[20:23], v[188:191], v[144:147]
  s_waitcnt vmcnt(20)
  v_mfma_f32_16x16x32_bf16 v[148:151], a[16:19], v[192:195], v[148:151]
  s_add_u32 s70, s70, 4096
  s_add_u32 s71, s71, 4096
  buffer_load_dwordx4 v[188:191], v1, s[32:35], s70 offen offset:0 sc1
  v_mfma_f32_16x16x32_bf16 v[152:155], a[20:23], v[192:195], v[152:155]
  s_waitcnt vmcnt(20)
  v_mfma_f32_16x16x32_bf16 v[140:143], a[24:27], v[196:199], v[140:143]
  buffer_load_dwordx4 v[192:195], v1, s[32:35], s71 offen offset:0 sc1
  v_mfma_f32_16x16x32_bf16 v[144:147], a[28:31], v[196:199], v[144:147]
  s_waitcnt vmcnt(20)
  v_mfma_f32_16x16x32_bf16 v[148:151], a[24:27], v[200:203], v[148:151]
  buffer_load_dwordx4 v[196:199], v1, s[32:35], s70 offen offset:1024 sc1
  v_mfma_f32_16x16x32_bf16 v[152:155], a[28:31], v[200:203], v[152:155]
  s_waitcnt vmcnt(20)
  v_mfma_f32_16x16x32_bf16 v[140:143], a[32:35], v[204:207], v[140:143]
  buffer_load_dwordx4 v[200:203], v1, s[32:35], s71 offen offset:1024 sc1
  v_mfma_f32_16x16x32_bf16 v[144:147], a[36:39], v[204:207], v[144:147]
  s_waitcnt vmcnt(20)
  v_mfma_f32_16x16x32_bf16 v[148:151], a[32:35], v[208:211], v[148:151]
  buffer_load_dwordx4 v[204:207], v1, s[32:35], s70 offen offset:2048 sc1
  v_mfma_f32_16x16x32_bf16 v[152:155], a[36:39], v[208:211], v[152:155]
  s_waitcnt vmcnt(20)
  v_mfma_f32_16x16x32_bf16 v[140:143], a[40:43], v[212:215], v[140:143]
  buffer_load_dwordx4 v[208:211], v1, s[32:35], s71 offen offset:2048 sc1
  v_mfma_f32_16x16x32_bf16 v[144:147], a[44:47], v[212:215], v[144:147]
  s_waitcnt vmcnt(20)
  v_mfma_f32_16x16x32_bf16 v[148:151], a[40:43], v[216:219], v[148:151]
  buffer_load_dwordx4 v[212:215], v1, s[32:35], s70 offen offset:3072 sc1
  v_mfma_f32_16x16x32_bf16 v[152:155], a[44:47], v[216:219], v[152:155]
  s_waitcnt vmcnt(20)
  v_mfma_f32_16x16x32_bf16 v[140:143], a[48:51], v[220:223], v[140:143]
  buffer_load_dwordx4 v[216:219], v1, s[32:35], s71 offen offset:3072 sc1
  v_mfma_f32_16x16x32_bf16 v[144:147], a[52:55], v[220:223], v[144:147]
  s_waitcnt vmcnt(20)
  v_mfma_f32_16x16x32_bf16 v[148:151], a[48:51], v[224:227], v[148:151]
  s_add_u32 s70, s70, 4096
  s_add_u32 s71, s71, 4096
  buffer_load_dwordx4 v[220:223], v1, s[32:35], s70 offen offset:0 sc1
  v_mfma_f32_16x16x32_bf16 v[152:155], a[52:55], v[224:227], v[152:155]
  s_waitcnt vmcnt(20)
  v_mfma_f32_16x16x32_bf16 v[140:143], a[56:59], v[228:231], v[140:143]
  buffer_load_dwordx4 v[224:227], v1, s[32:35], s71 offen offset:0 sc1
  v_mfma_f32_16x16x32_bf16 v[144:147], a[60:63], v[228:231], v[144:147]
  s_waitcnt vmcnt(20)
  v_mfma_f32_16x16x32_bf16 v[148:151], a[56:59], v[232:235], v[148:151]
  buffer_load_dwordx4 v[228:231], v1, s[32:35], s70 offen offset:1024 sc1
  v_mfma_f32_16x16x32_bf16 v[152:155], a[60:63], v[232:235], v[152:155]
  s_waitcnt vmcnt(20)
  v_mfma_f32_16x16x32_bf16 v[140:143], a[64:67], v[236:239], v[140:143]
  buffer_load_dwordx4 v[232:235], v1, s[32:35], s71 offen offset:1024 sc1
  v_mfma_f32_16x16x32_bf16 v[144:147], a[68:71], v[236:239], v[144:147]
  s_waitcnt vmcnt(20)
  v_mfma_f32_16x16x32_bf16 v[148:151], a[64:67], v[240:243], v[148:151]
  buffer_load_dwordx4 v[236:239], v1, s[32:35], s70 offen offset:2048 sc1
  v_mfma_f32_16x16x32_bf16 v[152:155], a[68:71], v[240:243], v[152:155]
  s_waitcnt vmcnt(20)
  v_mfma_f32_16x16x32_bf16 v[140:143], a[72:75], v[244:247], v[140:143]
  buffer_load_dwordx4 v[240:243], v1, s[32:35], s71 offen offset:2048 sc1
  v_mfma_f32_16x16x32_bf16 v[144:147], a[76:79], v[244:247], v[144:147]
  s_waitcnt vmcnt(18)
  s_barrier
  s_cmp_lg_u32 s50, 0
  s_cbranch_scc1 Lan_169
  s_lshl_b32 s66, s62, 7
  s_add_u32 s66, s66, 99045440
  v_mov_b32 v16, 0
  v_mov_b32 v17, 1
  s_mov_b64 exec, 1
  buffer_atomic_add v17, v16, s[32:35], s66 offen sc1
  s_mov_b64 exec, -1
Lan_169:
  s_waitcnt vmcnt(18)
  v_mfma_f32_16x16x32_bf16 v[148:151], a[72:75], v[248:251], v[148:151]
  buffer_load_dwordx4 v[244:247], v1, s[32:35], s70 offen offset:3072 sc1
  v_mfma_f32_16x16x32_bf16 v[152:155], a[76:79], v[248:251], v[152:155]
  s_waitcnt vmcnt(18)
  v_mfma_f32_16x16x32_bf16 v[140:143], a[80:83], v[172:175], v[140:143]
  buffer_load_dwordx4 v[248:251], v1, s[32:35], s71 offen offset:3072 sc1
  v_mfma_f32_16x16x32_bf16 v[144:147], a[84:87], v[172:175], v[144:147]
  s_waitcnt vmcnt(18)
  v_mfma_f32_16x16x32_bf16 v[148:151], a[80:83], v[176:179], v[148:151]
  s_add_u32 s70, s70, 4096
  s_add_u32 s71, s71, 4096
  buffer_load_dwordx4 v[172:175], v1, s[32:35], s70 offen offset:0 sc1
  v_mfma_f32_16x16x32_bf16 v[152:155], a[84:87], v[176:179], v[152:155]
  s_waitcnt vmcnt(18)
  v_mfma_f32_16x16x32_bf16 v[140:143], a[88:91], v[180:183], v[140:143]
  buffer_load_dwordx4 v[176:179], v1, s[32:35], s71 offen offset:0 sc1
  v_mfma_f32_16x16x32_bf16 v[144:147], a[92:95], v[180:183], v[144:147]
  s_waitcnt vmcnt(18)
  v_mfma_f32_16x16x32_bf16 v[148:151], a[88:91], v[184:187], v[148:151]
  buffer_load_dwordx4 v[180:183], v1, s[32:35], s70 offen offset:1024 sc1
  v_mfma_f32_16x16x32_bf16 v[152:155], a[92:95], v[184:187], v[152:155]
  s_waitcnt vmcnt(18)
  v_mfma_f32_16x16x32_bf16 v[140:143], a[96:99], v[188:191], v[140:143]
  buffer_load_dwordx4 v[184:187], v1, s[32:35], s71 offen offset:1024 sc1
  v_mfma_f32_16x16x32_bf16 v[144:147], a[100:103], v[188:191], v[144:147]
  s_waitcnt vmcnt(18)
  v_mfma_f32_16x16x32_bf16 v[148:151], a[96:99], v[192:195], v[148:151]
  buffer_load_dwordx4 v[188:191], v1, s[32:35], s70 offen offset:2048 sc1
  v_mfma_f32_16x16x32_bf16 v[152:155], a[100:103], v[192:195], v[152:155]
  s_waitcnt vmcnt(18)
  v_mfma_f32_16x16x32_bf16 v[140:143], a[104:107], v[196:199], v[140:143]
  buffer_load_dwordx4 v[192:195], v1, s[32:35], s71 offen offset:2048 sc1
  v_mfma_f32_16x16x32_bf16 v[144:147], a[108:111], v[196:199], v[144:147]
  s_waitcnt vmcnt(18)
  v_mfma_f32_16x16x32_bf16 v[148:151], a[104:107], v[200:203], v[148:151]
  buffer_load_dwordx4 v[196:199], v1, s[32:35], s70 offen offset:3072 sc1
  v_mfma_f32_16x16x32_bf16 v[152:155], a[108:111], v[200:203], v[152:155]
  s_waitcnt vmcnt(18)
  v_mfma_f32_16x16x32_bf16 v[140:143], a[112:115], v[204:207], v[140:143]
  buffer_load_dwordx4 v[200:203], v1, s[32:35], s71 offen offset:3072 sc1
  v_mfma_f32_16x16x32_bf16 v[144:147], a[116:119], v[204:207], v[144:147]
  s_waitcnt vmcnt(18)
  v_mfma_f32_16x16x32_bf16 v[148:151], a[112:115], v[208:211], v[148:151]
  s_add_u32 s70, s70, 4096
  s_add_u32 s71, s71, 4096
  buffer_load_dwordx4 v[204:207], v1, s[32:35], s70 offen offset:0 sc1
  v_mfma_f32_16x16x32_bf16 v[152:155], a[116:119], v[208:211], v[152:155]
  s_waitcnt vmcnt(18)
  v_mfma_f32_16x16x32_bf16 v[140:143], a[120:123], v[212:215], v[140:143]
  buffer_load_dwordx4 v[208:211], v1, s[32:35], s71 offen offset:0 sc1
  v_mfma_f32_16x16x32_bf16 v[144:147], a[124:127], v[212:215], v[144:147]
  s_waitcnt vmcnt(18)
  v_mfma_f32_16x16x32_bf16 v[148:151], a[120:123], v[216:219], v[148:151]
  buffer_load_dwordx4 v[212:215], v1, s[32:35], s70 offen offset:1024 sc1
  v_mfma_f32_16x16x32_bf16 v[152:155], a[124:127], v[216:219], v[152:155]
  s_waitcnt vmcnt(18)
  v_mfma_f32_16x16x32_bf16 v[140:143], a[128:131], v[220:223], v[140:143]
  buffer_load_dwordx4 v[216:219], v1, s[32:35], s71 offen offset:1024 sc1
  v_mfma_f32_16x16x32_bf16 v[144:147], a[132:135], v[220:223], v[144:147]
  s_waitcnt vmcnt(18)
  v_mfma_f32_16x16x32_bf16 v[148:151], a[128:131], v[224:227], v[148:151]
  buffer_load_dwordx4 v[220:223], v1, s[32:35], s70 offen offset:2048 sc1
  v_mfma_f32_16x16x32_bf16 v[152:155], a[132:135], v[224:227], v[152:155]
  s_waitcnt vmcnt(18)
  v_mfma_f32_16x16x32_bf16 v[140:143], a[136:139], v[228:231], v[140:143]
  buffer_load_dwordx4 v[224:227], v1, s[32:35], s71 offen offset:2048 sc1
  v_mfma_f32_16x16x32_bf16 v[144:147], a[140:143], v[228:231], v[144:147]
  s_waitcnt vmcnt(18)
  v_mfma_f32_16x16x32_bf16 v[148:151], a[136:139], v[232:235], v[148:151]
  buffer_load_dwordx4 v[228:231], v1, s[32:35], s70 offen offset:3072 sc1
  v_mfma_f32_16x16x32_bf16 v[152:155], a[140:143], v[232:235], v[152:155]
  s_waitcnt vmcnt(18)
  v_mfma_f32_16x16x32_bf16 v[140:143], a[144:147], v[236:239], v[140:143]
  buffer_load_dwordx4 v[232:235], v1, s[32:35], s71 offen offset:3072 sc1
  v_mfma_f32_16x16x32_bf16 v[144:147], a[148:151], v[236:239], v[144:147]
  s_waitcnt vmcnt(18)
  v_mfma_f32_16x16x32_bf16 v[148:151], a[144:147], v[240:243], v[148:151]
  s_add_u32 s70, s70, 4096
  s_add_u32 s71, s71, 4096
  buffer_load_dwordx4 v[236:239], v1, s[32:35], s70 offen offset:0 sc1
  v_mfma_f32_16x16x32_bf16 v[152:155], a[148:151], v[240:243], v[152:155]
  s_waitcnt vmcnt(18)
  v_mfma_f32_16x16x32_bf16 v[140:143], a[152:155], v[244:247], v[140:143]
  buffer_load_dwordx4 v[240:243], v1, s[32:35], s71 offen offset:0 sc1
  v_mfma_f32_16x16x32_bf16 v[144:147], a[156:159], v[244:247], v[144:147]
  s_waitcnt vmcnt(18)
  v_mfma_f32_16x16x32_bf16 v[148:151], a[152:155], v[248:251], v[148:151]
  buffer_load_dwordx4 v[244:247], v1, s[32:35], s70 offen offset:1024 sc1
  v_mfma_f32_16x16x32_bf16 v[152:155], a[156:159], v[248:251], v[152:155]
  s_waitcnt vmcnt(18)
  v_mfma_f32_16x16x32_bf16 v[140:143], a[160:163], v[172:175], v[140:143]
  buffer_load_dwordx4 v[248:251], v1, s[32:35], s71 offen offset:1024 sc1
  v_mfma_f32_16x16x32_bf16 v[144:147], a[164:167], v[172:175], v[144:147]
  s_waitcnt vmcnt(18)
  v_mfma_f32_16x16x32_bf16 v[148:151], a[160:163], v[176:179], v[148:151]
  buffer_load_dwordx4 v[172:175], v1, s[32:35], s70 offen offset:2048 sc1
  v_mfma_f32_16x16x32_bf16 v[152:155], a[164:167], v[176:179], v[152:155]
  s_waitcnt vmcnt(18)
  v_mfma_f32_16x16x32_bf16 v[140:143], a[168:171], v[180:183], v[140:143]
  buffer_load_dwordx4 v[176:179], v1, s[32:35], s71 offen offset:2048 sc1
  v_mfma_f32_16x16x32_bf16 v[144:147], a[172:175], v[180:183], v[144:147]
  s_waitcnt vmcnt(18)
  v_mfma_f32_16x16x32_bf16 v[148:151], a[168:171], v[184:187], v[148:151]
  buffer_load_dwordx4 v[180:183], v1, s[32:35], s70 offen offset:3072 sc1
  v_mfma_f32_16x16x32_bf16 v[152:155], a[172:175], v[184:187], v[152:155]
  s_waitcnt vmcnt(18)
  v_mfma_f32_16x16x32_bf16 v[140:143], a[176:179], v[188:191], v[140:143]
  buffer_load_dwordx4 v[184:187], v1, s[32:35], s71 offen offset:3072 sc1
  v_mfma_f32_16x16x32_bf16 v[144:147], a[180:183], v[188:191], v[144:147]
  s_waitcnt vmcnt(18)
  v_mfma_f32_16x16x32_bf16 v[148:151], a[176:179], v[192:195], v[148:151]
  v_mfma_f32_16x16x32_bf16 v[152:155], a[180:183], v[192:195], v[152:155]
  s_waitcnt vmcnt(17)
  v_mfma_f32_16x16x32_bf16 v[140:143], a[184:187], v[196:199], v[140:143]
  v_mfma_f32_16x16x32_bf16 v[144:147], a[188:191], v[196:199], v[144:147]
  s_waitcnt vmcnt(16)
  v_mfma_f32_16x16x32_bf16 v[148:151], a[184:187], v[200:203], v[148:151]
  v_mfma_f32_16x16x32_bf16 v[152:155], a[188:191], v[200:203], v[152:155]
  s_waitcnt vmcnt(15)
  v_mfma_f32_16x16x32_bf16 v[140:143], a[192:195], v[204:207], v[140:143]
  v_mfma_f32_16x16x32_bf16 v[144:147], a[196:199], v[204:207], v[144:147]
  s_waitcnt vmcnt(14)
  v_mfma_f32_16x16x32_bf16 v[148:151], a[192:195], v[208:211], v[148:151]
  v_mfma_f32_16x16x32_bf16 v[152:155], a[196:199], v[208:211], v[152:155]
  s_waitcnt vmcnt(13)
  v_mfma_f32_16x16x32_bf16 v[140:143], a[200:203], v[212:215], v[140:143]
  v_mfma_f32_16x16x32_bf16 v[144:147], a[204:207], v[212:215], v[144:147]
  s_waitcnt vmcnt(12)
  v_mfma_f32_16x16x32_bf16 v[148:151], a[200:203], v[216:219], v[148:151]
  v_mfma_f32_16x16x32_bf16 v[152:155], a[204:207], v[216:219], v[152:155]
  s_waitcnt vmcnt(11)
  v_mfma_f32_16x16x32_bf16 v[140:143], a[208:211], v[220:223], v[140:143]
  v_mfma_f32_16x16x32_bf16 v[144:147], a[212:215], v[220:223], v[144:147]
  s_waitcnt vmcnt(10)
  v_mfma_f32_16x16x32_bf16 v[148:151], a[208:211], v[224:227], v[148:151]
  v_mfma_f32_16x16x32_bf16 v[152:155], a[212:215], v[224:227], v[152:155]
  s_waitcnt vmcnt(9)
  v_mfma_f32_16x16x32_bf16 v[140:143], a[216:219], v[228:231], v[140:143]
  v_mfma_f32_16x16x32_bf16 v[144:147], a[220:223], v[228:231], v[144:147]
  s_waitcnt vmcnt(8)
  v_mfma_f32_16x16x32_bf16 v[148:151], a[216:219], v[232:235], v[148:151]
  v_mfma_f32_16x16x32_bf16 v[152:155], a[220:223], v[232:235], v[152:155]
  s_waitcnt vmcnt(7)
  v_mfma_f32_16x16x32_bf16 v[140:143], a[224:227], v[236:239], v[140:143]
  v_mfma_f32_16x16x32_bf16 v[144:147], a[228:231], v[236:239], v[144:147]
  s_waitcnt vmcnt(6)
  v_mfma_f32_16x16x32_bf16 v[148:151], a[224:227], v[240:243], v[148:151]
  v_mfma_f32_16x16x32_bf16 v[152:155], a[228:231], v[240:243], v[152:155]
  s_waitcnt vmcnt(5)
  v_mfma_f32_16x16x32_bf16 v[140:143], a[232:235], v[244:247], v[140:143]
  v_mfma_f32_16x16x32_bf16 v[144:147], a[236:239], v[244:247], v[144:147]
  s_waitcnt vmcnt(4)
  v_mfma_f32_16x16x32_bf16 v[148:151], a[232:235], v[248:251], v[148:151]
  v_mfma_f32_16x16x32_bf16 v[152:155], a[236:239], v[248:251], v[152:155]
  s_waitcnt vmcnt(3)
  v_mfma_f32_16x16x32_bf16 v[140:143], a[240:243], v[172:175], v[140:143]
  v_mfma_f32_16x16x32_bf16 v[144:147], a[244:247], v[172:175], v[144:147]
  s_waitcnt vmcnt(2)
  v_mfma_f32_16x16x32_bf16 v[148:151], a[240:243], v[176:179], v[148:151]
  v_mfma_f32_16x16x32_bf16 v[152:155], a[244:247], v[176:179], v[152:155]
  s_waitcnt vmcnt(1)
  v_mfma_f32_16x16x32_bf16 v[140:143], a[248:251], v[180:183], v[140:143]
  v_mfma_f32_16x16x32_bf16 v[144:147], a[252:255], v[180:183], v[144:147]
  s_waitcnt vmcnt(0)
  v_mfma_f32_16x16x32_bf16 v[148:151], a[248:251], v[184:187], v[148:151]
  v_mfma_f32_16x16x32_bf16 v[152:155], a[252:255], v[184:187], v[152:155]
  s_lshl_b32 s66, s50, 12
  v_add_u32 v16, s66, v1
  s_lshl_b32 s66, s50, 11
  v_add_u32 v17, s66, v1
  s_nop 3
  ds_write_b128 v16, v[140:143] offset:0
  ds_write_b128 v16, v[144:147] offset:1024
  ds_write_b128 v16, v[148:151] offset:2048
  ds_write_b128 v16, v[152:155] offset:3072
  s_waitcnt lgkmcnt(0)
  s_barrier
  s_cmp_ge_u32 s50, 2
  s_cbranch_scc1 Lep_170
  ds_read_b128 v[172:175], v17 offset:0
  ds_read_b128 v[176:179], v17 offset:1024
  ds_read_b128 v[180:183], v17 offset:4096
  ds_read_b128 v[184:187], v17 offset:5120
  ds_read_b128 v[188:191], v17 offset:8192
  ds_read_b128 v[192:195], v17 offset:9216
  ds_read_b128 v[196:199], v17 offset:12288
  ds_read_b128 v[200:203], v17 offset:13312
  v_sub_f32 v18, 1.0, v168
  v_cvt_pk_bf16_f32 v18, v18, v18
  v_lshlrev_b32 v18, 16, v18
  s_lshl_b32 s70, s77, 16
  s_lshl_b32 s66, s58, 15
  s_add_u32 s70, s70, s66
  s_lshl_b32 s66, s49, 6
  s_add_u32 s70, s70, s66
  v_lshlrev_b32 v204, 16, v164
  v_and_b32 v205, 0xffff0000, v164
  v_mul_f32 v204, v18, v204
  v_mul_f32 v205, v18, v205
  v_cvt_pk_bf16_f32 v164, v204, v205
  v_lshlrev_b32 v206, 16, v165
  v_and_b32 v207, 0xffff0000, v165
  v_mul_f32 v206, v18, v206
  v_mul_f32 v207, v18, v207
  v_cvt_pk_bf16_f32 v165, v206, v207
  v_lshlrev_b32 v208, 16, v166
  v_and_b32 v209, 0xffff0000, v166
  v_mul_f32 v208, v18, v208
  v_mul_f32 v209, v18, v209
  v_cvt_pk_bf16_f32 v166, v208, v209
  v_lshlrev_b32 v210, 16, v167
  v_and_b32 v211, 0xffff0000, v167
  v_mul_f32 v210, v18, v210
  v_mul_f32 v211, v18, v211
  v_cvt_pk_bf16_f32 v167, v210, v211
  s_waitcnt lgkmcnt(0)
  v_pk_add_f32 v[172:173], v[172:173], v[180:181]
  v_pk_add_f32 v[188:189], v[188:189], v[196:197]
  v_pk_add_f32 v[174:175], v[174:175], v[182:183]
  v_pk_add_f32 v[190:191], v[190:191], v[198:199]
  v_pk_add_f32 v[176:177], v[176:177], v[184:185]
  v_pk_add_f32 v[192:193], v[192:193], v[200:201]
  v_pk_add_f32 v[178:179], v[178:179], v[186:187]
  v_pk_add_f32 v[194:195], v[194:195], v[202:203]
  v_pk_add_f32 v[172:173], v[172:173], v[188:189]
  v_cvt_pk_bf16_f32 v19, v172, v173
  v_lshlrev_b32 v172, 16, v19
  v_and_b32 v173, 0xffff0000, v19
  v_mul_f32 v172, v168, v172
  v_mul_f32 v173, v168, v173
  v_cvt_pk_bf16_f32 v19, v172, v173
  v_lshlrev_b32 v172, 16, v19
  v_and_b32 v173, 0xffff0000, v19
  v_lshlrev_b32 v20, 16, v164
  v_and_b32 v21, 0xffff0000, v164
  v_add_f32 v172, v172, v20
  v_add_f32 v173, v173, v21
  v_cvt_pk_bf16_f32 v204, v172, v173
  v_pk_add_f32 v[174:175], v[174:175], v[190:191]
  v_cvt_pk_bf16_f32 v19, v174, v175
  v_lshlrev_b32 v174, 16, v19
  v_and_b32 v175, 0xffff0000, v19
  v_mul_f32 v174, v168, v174
  v_mul_f32 v175, v168, v175
  v_cvt_pk_bf16_f32 v19, v174, v175
  v_lshlrev_b32 v174, 16, v19
  v_and_b32 v175, 0xffff0000, v19
  v_lshlrev_b32 v20, 16, v165
  v_and_b32 v21, 0xffff0000, v165
  v_add_f32 v174, v174, v20
  v_add_f32 v175, v175, v21
  v_cvt_pk_bf16_f32 v205, v174, v175
  v_pk_add_f32 v[176:177], v[176:177], v[192:193]
  v_cvt_pk_bf16_f32 v19, v176, v177
  v_lshlrev_b32 v176, 16, v19
  v_and_b32 v177, 0xffff0000, v19
  v_mul_f32 v176, v168, v176
  v_mul_f32 v177, v168, v177
  v_cvt_pk_bf16_f32 v19, v176, v177
  v_lshlrev_b32 v176, 16, v19
  v_and_b32 v177, 0xffff0000, v19
  v_lshlrev_b32 v20, 16, v166
  v_and_b32 v21, 0xffff0000, v166
  v_add_f32 v176, v176, v20
  v_add_f32 v177, v177, v21
  v_cvt_pk_bf16_f32 v206, v176, v177
  v_pk_add_f32 v[178:179], v[178:179], v[194:195]
  v_cvt_pk_bf16_f32 v19, v178, v179
  v_lshlrev_b32 v178, 16, v19
  v_and_b32 v179, 0xffff0000, v19
  v_mul_f32 v178, v168, v178
  v_mul_f32 v179, v168, v179
  v_cvt_pk_bf16_f32 v19, v178, v179
  v_lshlrev_b32 v178, 16, v19
  v_and_b32 v179, 0xffff0000, v19
  v_lshlrev_b32 v20, 16, v167
  v_and_b32 v21, 0xffff0000, v167
  v_add_f32 v178, v178, v20
  v_add_f32 v179, v179, v21
  v_cvt_pk_bf16_f32 v207, v178, v179
  s_nop 1
  v_permlane16_swap_b32 v204, v206
  v_permlane16_swap_b32 v205, v207
  buffer_store_dwordx4 v[204:207], v5, s[44:47], s70 offen
Lep_170:
  s_mov_b32 s77, s62
  s_lshl_b32 s72, s77, 7
  s_lshl_b32 s66, s58, 6
  s_add_u32 s72, s72, s66
  s_add_u32 s72, s72, 99024896
  s_lshl_b32 s73, s77, 16
  s_lshl_b32 s66, s49, 11
  s_add_u32 s73, s73, s66
  s_lshl_b32 s66, s58, 10
  s_add_u32 s73, s73, s66
  s_add_u32 s73, s73, 83886080
  buffer_load_dword v168, v7, s[32:35], s72 offen sc1
  buffer_load_dwordx4 v[164:167], v1, s[32:35], s73 offen sc1
  s_lshl_b32 s67, s77, 7
  s_add_u32 s67, s67, 99045440
  s_cmp_lg_u32 s50, 0
  s_cbranch_scc1 Low_172
  v_mov_b32 v16, 0
Low_171:
  buffer_load_dword v17, v16, s[32:35], s67 offen sc1
  s_waitcnt vmcnt(0)
  v_cmp_le_u32 vcc, 32, v17
  s_cbranch_vccnz Low_172
  s_sleep 2
  s_sub_u32 s69, s69, 1
  s_cbranch_scc0 Low_171
  s_endpgm
Low_172:
  s_barrier
  s_lshl_b32 s70, s77, 18
  s_lshl_b32 s66, s50, 15
  s_add_u32 s70, s70, s66
  s_add_u32 s70, s70, 67108864
  s_add_u32 s71, s70, 131072
  buffer_load_dwordx4 v[172:175], v1, s[32:35], s70 offen offset:0 sc1
  buffer_load_dwordx4 v[176:179], v1, s[32:35], s71 offen offset:0 sc1
  buffer_load_dwordx4 v[180:183], v1, s[32:35], s70 offen offset:1024 sc1
  buffer_load_dwordx4 v[184:187], v1, s[32:35], s71 offen offset:1024 sc1
  buffer_load_dwordx4 v[188:191], v1, s[32:35], s70 offen offset:2048 sc1
  buffer_load_dwordx4 v[192:195], v1, s[32:35], s71 offen offset:2048 sc1
  buffer_load_dwordx4 v[196:199], v1, s[32:35], s70 offen offset:3072 sc1
  buffer_load_dwordx4 v[200:203], v1, s[32:35], s71 offen offset:3072 sc1
  s_add_u32 s70, s70, 4096
  s_add_u32 s71, s71, 4096
  buffer_load_dwordx4 v[204:207], v1, s[32:35], s70 offen offset:0 sc1
  buffer_load_dwordx4 v[208:211], v1, s[32:35], s71 offen offset:0 sc1
  buffer_load_dwordx4 v[212:215], v1, s[32:35], s70 offen offset:1024 sc1
  buffer_load_dwordx4 v[216:219], v1, s[32:35], s71 offen offset:1024 sc1
  buffer_load_dwordx4 v[220:223], v1, s[32:35], s70 offen offset:2048 sc1
  buffer_load_dwordx4 v[224:227], v1, s[32:35], s71 offen offset:2048 sc1
  buffer_load_dwordx4 v[228:231], v1, s[32:35], s70 offen offset:3072 sc1
  buffer_load_dwordx4 v[232:235], v1, s[32:35], s71 offen offset:3072 sc1
  s_add_u32 s70, s70, 4096
  s_add_u32 s71, s71, 4096
  buffer_load_dwordx4 v[236:239], v1, s[32:35], s70 offen offset:0 sc1
  buffer_load_dwordx4 v[240:243], v1, s[32:35], s71 offen offset:0 sc1
  buffer_load_dwordx4 v[244:247], v1, s[32:35], s70 offen offset:1024 sc1
  s_waitcnt vmcnt(18)
  v_mfma_f32_16x16x32_bf16 v[140:143], a[0:3], v[172:175], 0
  buffer_load_dwordx4 v[248:251], v1, s[32:35], s71 offen offset:1024 sc1
  v_mfma_f32_16x16x32_bf16 v[144:147], a[4:7], v[172:175], 0
  s_waitcnt vmcnt(18)
  v_mfma_f32_16x16x32_bf16 v[148:151], a[0:3], v[176:179], 0
  buffer_load_dwordx4 v[172:175], v1, s[32:35], s70 offen offset:2048 sc1
  v_mfma_f32_16x16x32_bf16 v[152:155], a[4:7], v[176:179], 0
  s_waitcnt vmcnt(18)
  v_mfma_f32_16x16x32_bf16 v[140:143], a[8:11], v[180:183], v[140:143]
  buffer_load_dwordx4 v[176:179], v1, s[32:35], s71 offen offset:2048 sc1
  v_mfma_f32_16x16x32_bf16 v[144:147], a[12:15], v[180:183], v[144:147]
  s_waitcnt vmcnt(18)
  v_mfma_f32_16x16x32_bf16 v[148:151], a[8:11], v[184:187], v[148:151]
  buffer_load_dwordx4 v[180:183], v1, s[32:35], s70 offen offset:3072 sc1
  v_mfma_f32_16x16x32_bf16 v[152:155], a[12:15], v[184:187], v[152:155]
  s_waitcnt vmcnt(18)
  v_mfma_f32_16x16x32_bf16 v[140:143], a[16:19], v[188:191], v[140:143]
  buffer_load_dwordx4 v[184:187], v1, s[32:35], s71 offen offset:3072 sc1
  v_mfma_f32_16x16x32_bf16 v[144:147], a[20:23], v[188:191], v[144:147]
  s_waitcnt vmcnt(18)
  v_mfma_f32_16x16x32_bf16 v[148:151], a[16:19], v[192:195], v[148:151]
  s_add_u32 s70, s70, 4096
  s_add_u32 s71, s71, 4096
  buffer_load_dwordx4 v[188:191], v1, s[32:35], s70 offen offset:0 sc1
  v_mfma_f32_16x16x32_bf16 v[152:155], a[20:23], v[192:195], v[152:155]
  s_waitcnt vmcnt(18)
  v_mfma_f32_16x16x32_bf16 v[140:143], a[24:27], v[196:199], v[140:143]
  buffer_load_dwordx4 v[192:195], v1, s[32:35], s71 offen offset:0 sc1
  v_mfma_f32_16x16x32_bf16 v[144:147], a[28:31], v[196:199], v[144:147]
  s_waitcnt vmcnt(18)
  v_mfma_f32_16x16x32_bf16 v[148:151], a[24:27], v[200:203], v[148:151]
  buffer_load_dwordx4 v[196:199], v1, s[32:35], s70 offen offset:1024 sc1
  v_mfma_f32_16x16x32_bf16 v[152:155], a[28:31], v[200:203], v[152:155]
  s_waitcnt vmcnt(18)
  v_mfma_f32_16x16x32_bf16 v[140:143], a[32:35], v[204:207], v[140:143]
  buffer_load_dwordx4 v[200:203], v1, s[32:35], s71 offen offset:1024 sc1
  v_mfma_f32_16x16x32_bf16 v[144:147], a[36:39], v[204:207], v[144:147]
  s_waitcnt vmcnt(18)
  v_mfma_f32_16x16x32_bf16 v[148:151], a[32:35], v[208:211], v[148:151]
  buffer_load_dwordx4 v[204:207], v1, s[32:35], s70 offen offset:2048 sc1
  v_mfma_f32_16x16x32_bf16 v[152:155], a[36:39], v[208:211], v[152:155]
  s_waitcnt vmcnt(18)
  v_mfma_f32_16x16x32_bf16 v[140:143], a[40:43], v[212:215], v[140:143]
  buffer_load_dwordx4 v[208:211], v1, s[32:35], s71 offen offset:2048 sc1
  v_mfma_f32_16x16x32_bf16 v[144:147], a[44:47], v[212:215], v[144:147]
  s_waitcnt vmcnt(18)
  v_mfma_f32_16x16x32_bf16 v[148:151], a[40:43], v[216:219], v[148:151]
  buffer_load_dwordx4 v[212:215], v1, s[32:35], s70 offen offset:3072 sc1
  v_mfma_f32_16x16x32_bf16 v[152:155], a[44:47], v[216:219], v[152:155]
  s_waitcnt vmcnt(18)
  v_mfma_f32_16x16x32_bf16 v[140:143], a[48:51], v[220:223], v[140:143]
  buffer_load_dwordx4 v[216:219], v1, s[32:35], s71 offen offset:3072 sc1
  v_mfma_f32_16x16x32_bf16 v[144:147], a[52:55], v[220:223], v[144:147]
  s_waitcnt vmcnt(18)
  v_mfma_f32_16x16x32_bf16 v[148:151], a[48:51], v[224:227], v[148:151]
  s_add_u32 s70, s70, 4096
  s_add_u32 s71, s71, 4096
  buffer_load_dwordx4 v[220:223], v1, s[32:35], s70 offen offset:0 sc1
  v_mfma_f32_16x16x32_bf16 v[152:155], a[52:55], v[224:227], v[152:155]
  s_waitcnt vmcnt(18)
  v_mfma_f32_16x16x32_bf16 v[140:143], a[56:59], v[228:231], v[140:143]
  buffer_load_dwordx4 v[224:227], v1, s[32:35], s71 offen offset:0 sc1
  v_mfma_f32_16x16x32_bf16 v[144:147], a[60:63], v[228:231], v[144:147]
  s_waitcnt vmcnt(18)
  v_mfma_f32_16x16x32_bf16 v[148:151], a[56:59], v[232:235], v[148:151]
  buffer_load_dwordx4 v[228:231], v1, s[32:35], s70 offen offset:1024 sc1
  v_mfma_f32_16x16x32_bf16 v[152:155], a[60:63], v[232:235], v[152:155]
  s_waitcnt vmcnt(18)
  v_mfma_f32_16x16x32_bf16 v[140:143], a[64:67], v[236:239], v[140:143]
  buffer_load_dwordx4 v[232:235], v1, s[32:35], s71 offen offset:1024 sc1
  v_mfma_f32_16x16x32_bf16 v[144:147], a[68:71], v[236:239], v[144:147]
  s_waitcnt vmcnt(18)
  v_mfma_f32_16x16x32_bf16 v[148:151], a[64:67], v[240:243], v[148:151]
  buffer_load_dwordx4 v[236:239], v1, s[32:35], s70 offen offset:2048 sc1
  v_mfma_f32_16x16x32_bf16 v[152:155], a[68:71], v[240:243], v[152:155]
  s_waitcnt vmcnt(18)
  v_mfma_f32_16x16x32_bf16 v[140:143], a[72:75], v[244:247], v[140:143]
  buffer_load_dwordx4 v[240:243], v1, s[32:35], s71 offen offset:2048 sc1
  v_mfma_f32_16x16x32_bf16 v[144:147], a[76:79], v[244:247], v[144:147]
  s_waitcnt vmcnt(18)
  v_mfma_f32_16x16x32_bf16 v[148:151], a[72:75], v[248:251], v[148:151]
  buffer_load_dwordx4 v[244:247], v1, s[32:35], s70 offen offset:3072 sc1
  v_mfma_f32_16x16x32_bf16 v[152:155], a[76:79], v[248:251], v[152:155]
  s_waitcnt vmcnt(18)
  v_mfma_f32_16x16x32_bf16 v[140:143], a[80:83], v[172:175], v[140:143]
  buffer_load_dwordx4 v[248:251], v1, s[32:35], s71 offen offset:3072 sc1
  v_mfma_f32_16x16x32_bf16 v[144:147], a[84:87], v[172:175], v[144:147]
  s_waitcnt vmcnt(18)
  v_mfma_f32_16x16x32_bf16 v[148:151], a[80:83], v[176:179], v[148:151]
  s_add_u32 s70, s70, 4096
  s_add_u32 s71, s71, 4096
  buffer_load_dwordx4 v[172:175], v1, s[32:35], s70 offen offset:0 sc1
  v_mfma_f32_16x16x32_bf16 v[152:155], a[84:87], v[176:179], v[152:155]
  s_waitcnt vmcnt(18)
  v_mfma_f32_16x16x32_bf16 v[140:143], a[88:91], v[180:183], v[140:143]
  buffer_load_dwordx4 v[176:179], v1, s[32:35], s71 offen offset:0 sc1
  v_mfma_f32_16x16x32_bf16 v[144:147], a[92:95], v[180:183], v[144:147]
  s_waitcnt vmcnt(18)
  v_mfma_f32_16x16x32_bf16 v[148:151], a[88:91], v[184:187], v[148:151]
  buffer_load_dwordx4 v[180:183], v1, s[32:35], s70 offen offset:1024 sc1
  v_mfma_f32_16x16x32_bf16 v[152:155], a[92:95], v[184:187], v[152:155]
  s_waitcnt vmcnt(18)
  v_mfma_f32_16x16x32_bf16 v[140:143], a[96:99], v[188:191], v[140:143]
  buffer_load_dwordx4 v[184:187], v1, s[32:35], s71 offen offset:1024 sc1
  v_mfma_f32_16x16x32_bf16 v[144:147], a[100:103], v[188:191], v[144:147]
  s_waitcnt vmcnt(18)
  v_mfma_f32_16x16x32_bf16 v[148:151], a[96:99], v[192:195], v[148:151]
  buffer_load_dwordx4 v[188:191], v1, s[32:35], s70 offen offset:2048 sc1
  v_mfma_f32_16x16x32_bf16 v[152:155], a[100:103], v[192:195], v[152:155]
  s_waitcnt vmcnt(18)
  v_mfma_f32_16x16x32_bf16 v[140:143], a[104:107], v[196:199], v[140:143]
  buffer_load_dwordx4 v[192:195], v1, s[32:35], s71 offen offset:2048 sc1
  v_mfma_f32_16x16x32_bf16 v[144:147], a[108:111], v[196:199], v[144:147]
  s_waitcnt vmcnt(18)
  v_mfma_f32_16x16x32_bf16 v[148:151], a[104:107], v[200:203], v[148:151]
  buffer_load_dwordx4 v[196:199], v1, s[32:35], s70 offen offset:3072 sc1
  v_mfma_f32_16x16x32_bf16 v[152:155], a[108:111], v[200:203], v[152:155]
  s_waitcnt vmcnt(18)
  v_mfma_f32_16x16x32_bf16 v[140:143], a[112:115], v[204:207], v[140:143]
  buffer_load_dwordx4 v[200:203], v1, s[32:35], s71 offen offset:3072 sc1
  v_mfma_f32_16x16x32_bf16 v[144:147], a[116:119], v[204:207], v[144:147]
  s_waitcnt vmcnt(18)
  v_mfma_f32_16x16x32_bf16 v[148:151], a[112:115], v[208:211], v[148:151]
  s_add_u32 s70, s70, 4096
  s_add_u32 s71, s71, 4096
  buffer_load_dwordx4 v[204:207], v1, s[32:35], s70 offen offset:0 sc1
  v_mfma_f32_16x16x32_bf16 v[152:155], a[116:119], v[208:211], v[152:155]
  s_waitcnt vmcnt(18)
  v_mfma_f32_16x16x32_bf16 v[140:143], a[120:123], v[212:215], v[140:143]
  buffer_load_dwordx4 v[208:211], v1, s[32:35], s71 offen offset:0 sc1
  v_mfma_f32_16x16x32_bf16 v[144:147], a[124:127], v[212:215], v[144:147]
  s_waitcnt vmcnt(18)
  v_mfma_f32_16x16x32_bf16 v[148:151], a[120:123], v[216:219], v[148:151]
  buffer_load_dwordx4 v[212:215], v1, s[32:35], s70 offen offset:1024 sc1
  v_mfma_f32_16x16x32_bf16 v[152:155], a[124:127], v[216:219], v[152:155]
  s_waitcnt vmcnt(18)
  v_mfma_f32_16x16x32_bf16 v[140:143], a[128:131], v[220:223], v[140:143]
  buffer_load_dwordx4 v[216:219], v1, s[32:35], s71 offen offset:1024 sc1
  v_mfma_f32_16x16x32_bf16 v[144:147], a[132:135], v[220:223], v[144:147]
  s_waitcnt vmcnt(18)
  v_mfma_f32_16x16x32_bf16 v[148:151], a[128:131], v[224:227], v[148:151]
  buffer_load_dwordx4 v[220:223], v1, s[32:35], s70 offen offset:2048 sc1
  v_mfma_f32_16x16x32_bf16 v[152:155], a[132:135], v[224:227], v[152:155]
  s_waitcnt vmcnt(18)
  v_mfma_f32_16x16x32_bf16 v[140:143], a[136:139], v[228:231], v[140:143]
  buffer_load_dwordx4 v[224:227], v1, s[32:35], s71 offen offset:2048 sc1
  v_mfma_f32_16x16x32_bf16 v[144:147], a[140:143], v[228:231], v[144:147]
  s_waitcnt vmcnt(18)
  v_mfma_f32_16x16x32_bf16 v[148:151], a[136:139], v[232:235], v[148:151]
  buffer_load_dwordx4 v[228:231], v1, s[32:35], s70 offen offset:3072 sc1
  v_mfma_f32_16x16x32_bf16 v[152:155], a[140:143], v[232:235], v[152:155]
  s_waitcnt vmcnt(18)
  v_mfma_f32_16x16x32_bf16 v[140:143], a[144:147], v[236:239], v[140:143]
  buffer_load_dwordx4 v[232:235], v1, s[32:35], s71 offen offset:3072 sc1
  v_mfma_f32_16x16x32_bf16 v[144:147], a[148:151], v[236:239], v[144:147]
  s_waitcnt vmcnt(18)
  v_mfma_f32_16x16x32_bf16 v[148:151], a[144:147], v[240:243], v[148:151]
  s_add_u32 s70, s70, 4096
  s_add_u32 s71, s71, 4096
  buffer_load_dwordx4 v[236:239], v1, s[32:35], s70 offen offset:0 sc1
  v_mfma_f32_16x16x32_bf16 v[152:155], a[148:151], v[240:243], v[152:155]
  s_waitcnt vmcnt(18)
  v_mfma_f32_16x16x32_bf16 v[140:143], a[152:155], v[244:247], v[140:143]
  buffer_load_dwordx4 v[240:243], v1, s[32:35], s71 offen offset:0 sc1
  v_mfma_f32_16x16x32_bf16 v[144:147], a[156:159], v[244:247], v[144:147]
  s_waitcnt vmcnt(18)
  v_mfma_f32_16x16x32_bf16 v[148:151], a[152:155], v[248:251], v[148:151]
  buffer_load_dwordx4 v[244:247], v1, s[32:35], s70 offen offset:1024 sc1
  v_mfma_f32_16x16x32_bf16 v[152:155], a[156:159], v[248:251], v[152:155]
  s_waitcnt vmcnt(18)
  v_mfma_f32_16x16x32_bf16 v[140:143], a[160:163], v[172:175], v[140:143]
  buffer_load_dwordx4 v[248:251], v1, s[32:35], s71 offen offset:1024 sc1
  v_mfma_f32_16x16x32_bf16 v[144:147], a[164:167], v[172:175], v[144:147]
  s_waitcnt vmcnt(18)
  v_mfma_f32_16x16x32_bf16 v[148:151], a[160:163], v[176:179], v[148:151]
  buffer_load_dwordx4 v[172:175], v1, s[32:35], s70 offen offset:2048 sc1
  v_mfma_f32_16x16x32_bf16 v[152:155], a[164:167], v[176:179], v[152:155]
  s_waitcnt vmcnt(18)
  v_mfma_f32_16x16x32_bf16 v[140:143], a[168:171], v[180:183], v[140:143]
  buffer_load_dwordx4 v[176:179], v1, s[32:35], s71 offen offset:2048 sc1
  v_mfma_f32_16x16x32_bf16 v[144:147], a[172:175], v[180:183], v[144:147]
  s_waitcnt vmcnt(18)
  v_mfma_f32_16x16x32_bf16 v[148:151], a[168:171], v[184:187], v[148:151]
  buffer_load_dwordx4 v[180:183], v1, s[32:35], s70 offen offset:3072 sc1
  v_mfma_f32_16x16x32_bf16 v[152:155], a[172:175], v[184:187], v[152:155]
  s_waitcnt vmcnt(18)
  v_mfma_f32_16x16x32_bf16 v[140:143], a[176:179], v[188:191], v[140:143]
  buffer_load_dwordx4 v[184:187], v1, s[32:35], s71 offen offset:3072 sc1
  v_mfma_f32_16x16x32_bf16 v[144:147], a[180:183], v[188:191], v[144:147]
  s_waitcnt vmcnt(18)
  v_mfma_f32_16x16x32_bf16 v[148:151], a[176:179], v[192:195], v[148:151]
  v_mfma_f32_16x16x32_bf16 v[152:155], a[180:183], v[192:195], v[152:155]
  s_waitcnt vmcnt(17)
  v_mfma_f32_16x16x32_bf16 v[140:143], a[184:187], v[196:199], v[140:143]
  v_mfma_f32_16x16x32_bf16 v[144:147], a[188:191], v[196:199], v[144:147]
  s_waitcnt vmcnt(16)
  v_mfma_f32_16x16x32_bf16 v[148:151], a[184:187], v[200:203], v[148:151]
  v_mfma_f32_16x16x32_bf16 v[152:155], a[188:191], v[200:203], v[152:155]
  s_waitcnt vmcnt(15)
  v_mfma_f32_16x16x32_bf16 v[140:143], a[192:195], v[204:207], v[140:143]
  v_mfma_f32_16x16x32_bf16 v[144:147], a[196:199], v[204:207], v[144:147]
  s_waitcnt vmcnt(14)
  v_mfma_f32_16x16x32_bf16 v[148:151], a[192:195], v[208:211], v[148:151]
  v_mfma_f32_16x16x32_bf16 v[152:155], a[196:199], v[208:211], v[152:155]
  s_waitcnt vmcnt(13)
  v_mfma_f32_16x16x32_bf16 v[140:143], a[200:203], v[212:215], v[140:143]
  v_mfma_f32_16x16x32_bf16 v[144:147], a[204:207], v[212:215], v[144:147]
  s_waitcnt vmcnt(12)
  v_mfma_f32_16x16x32_bf16 v[148:151], a[200:203], v[216:219], v[148:151]
  v_mfma_f32_16x16x32_bf16 v[152:155], a[204:207], v[216:219], v[152:155]
  s_waitcnt vmcnt(11)
  v_mfma_f32_16x16x32_bf16 v[140:143], a[208:211], v[220:223], v[140:143]
  v_mfma_f32_16x16x32_bf16 v[144:147], a[212:215], v[220:223], v[144:147]
  s_waitcnt vmcnt(10)
  v_mfma_f32_16x16x32_bf16 v[148:151], a[208:211], v[224:227], v[148:151]
  v_mfma_f32_16x16x32_bf16 v[152:155], a[212:215], v[224:227], v[152:155]
  s_waitcnt vmcnt(9)
  v_mfma_f32_16x16x32_bf16 v[140:143], a[216:219], v[228:231], v[140:143]
  v_mfma_f32_16x16x32_bf16 v[144:147], a[220:223], v[228:231], v[144:147]
  s_waitcnt vmcnt(8)
  v_mfma_f32_16x16x32_bf16 v[148:151], a[216:219], v[232:235], v[148:151]
  v_mfma_f32_16x16x32_bf16 v[152:155], a[220:223], v[232:235], v[152:155]
  s_waitcnt vmcnt(7)
  v_mfma_f32_16x16x32_bf16 v[140:143], a[224:227], v[236:239], v[140:143]
  v_mfma_f32_16x16x32_bf16 v[144:147], a[228:231], v[236:239], v[144:147]
  s_waitcnt vmcnt(6)
  v_mfma_f32_16x16x32_bf16 v[148:151], a[224:227], v[240:243], v[148:151]
  v_mfma_f32_16x16x32_bf16 v[152:155], a[228:231], v[240:243], v[152:155]
  s_waitcnt vmcnt(5)
  v_mfma_f32_16x16x32_bf16 v[140:143], a[232:235], v[244:247], v[140:143]
  v_mfma_f32_16x16x32_bf16 v[144:147], a[236:239], v[244:247], v[144:147]
  s_waitcnt vmcnt(4)
  v_mfma_f32_16x16x32_bf16 v[148:151], a[232:235], v[248:251], v[148:151]
  v_mfma_f32_16x16x32_bf16 v[152:155], a[236:239], v[248:251], v[152:155]
  s_waitcnt vmcnt(3)
  v_mfma_f32_16x16x32_bf16 v[140:143], a[240:243], v[172:175], v[140:143]
  v_mfma_f32_16x16x32_bf16 v[144:147], a[244:247], v[172:175], v[144:147]
  s_waitcnt vmcnt(2)
  v_mfma_f32_16x16x32_bf16 v[148:151], a[240:243], v[176:179], v[148:151]
  v_mfma_f32_16x16x32_bf16 v[152:155], a[244:247], v[176:179], v[152:155]
  s_waitcnt vmcnt(1)
  v_mfma_f32_16x16x32_bf16 v[140:143], a[248:251], v[180:183], v[140:143]
  v_mfma_f32_16x16x32_bf16 v[144:147], a[252:255], v[180:183], v[144:147]
  s_waitcnt vmcnt(0)
  v_mfma_f32_16x16x32_bf16 v[148:151], a[248:251], v[184:187], v[148:151]
  v_mfma_f32_16x16x32_bf16 v[152:155], a[252:255], v[184:187], v[152:155]
  s_lshl_b32 s66, s50, 12
  v_add_u32 v16, s66, v1
  s_lshl_b32 s66, s50, 11
  v_add_u32 v17, s66, v1
  s_nop 3
  ds_write_b128 v16, v[140:143] offset:0
  ds_write_b128 v16, v[144:147] offset:1024
  ds_write_b128 v16, v[148:151] offset:2048
  ds_write_b128 v16, v[152:155] offset:3072
  s_waitcnt lgkmcnt(0)
  s_barrier
  s_cmp_ge_u32 s50, 2
  s_cbranch_scc1 Lep_174
  ds_read_b128 v[172:175], v17 offset:0
  ds_read_b128 v[176:179], v17 offset:1024
  ds_read_b128 v[180:183], v17 offset:4096
  ds_read_b128 v[184:187], v17 offset:5120
  ds_read_b128 v[188:191], v17 offset:8192
  ds_read_b128 v[192:195], v17 offset:9216
  ds_read_b128 v[196:199], v17 offset:12288
  ds_read_b128 v[200:203], v17 offset:13312
  v_sub_f32 v18, 1.0, v168
  v_cvt_pk_bf16_f32 v18, v18, v18
  v_lshlrev_b32 v18, 16, v18
  s_lshl_b32 s70, s77, 16
  s_lshl_b32 s66, s58, 15
  s_add_u32 s70, s70, s66
  s_lshl_b32 s66, s49, 6
  s_add_u32 s70, s70, s66
  v_lshlrev_b32 v204, 16, v164
  v_and_b32 v205, 0xffff0000, v164
  v_mul_f32 v204, v18, v204
  v_mul_f32 v205, v18, v205
  v_cvt_pk_bf16_f32 v164, v204, v205
  v_lshlrev_b32 v206, 16, v165
  v_and_b32 v207, 0xffff0000, v165
  v_mul_f32 v206, v18, v206
  v_mul_f32 v207, v18, v207
  v_cvt_pk_bf16_f32 v165, v206, v207
  v_lshlrev_b32 v208, 16, v166
  v_and_b32 v209, 0xffff0000, v166
  v_mul_f32 v208, v18, v208
  v_mul_f32 v209, v18, v209
  v_cvt_pk_bf16_f32 v166, v208, v209
  v_lshlrev_b32 v210, 16, v167
  v_and_b32 v211, 0xffff0000, v167
  v_mul_f32 v210, v18, v210
  v_mul_f32 v211, v18, v211
  v_cvt_pk_bf16_f32 v167, v210, v211
  s_waitcnt lgkmcnt(0)
  v_pk_add_f32 v[172:173], v[172:173], v[180:181]
  v_pk_add_f32 v[188:189], v[188:189], v[196:197]
  v_pk_add_f32 v[174:175], v[174:175], v[182:183]
  v_pk_add_f32 v[190:191], v[190:191], v[198:199]
  v_pk_add_f32 v[176:177], v[176:177], v[184:185]
  v_pk_add_f32 v[192:193], v[192:193], v[200:201]
  v_pk_add_f32 v[178:179], v[178:179], v[186:187]
  v_pk_add_f32 v[194:195], v[194:195], v[202:203]
  v_pk_add_f32 v[172:173], v[172:173], v[188:189]
  v_cvt_pk_bf16_f32 v19, v172, v173
  v_lshlrev_b32 v172, 16, v19
  v_and_b32 v173, 0xffff0000, v19
  v_mul_f32 v172, v168, v172
  v_mul_f32 v173, v168, v173
  v_cvt_pk_bf16_f32 v19, v172, v173
  v_lshlrev_b32 v172, 16, v19
  v_and_b32 v173, 0xffff0000, v19
  v_lshlrev_b32 v20, 16, v164
  v_and_b32 v21, 0xffff0000, v164
  v_add_f32 v172, v172, v20
  v_add_f32 v173, v173, v21
  v_cvt_pk_bf16_f32 v204, v172, v173
  v_pk_add_f32 v[174:175], v[174:175], v[190:191]
  v_cvt_pk_bf16_f32 v19, v174, v175
  v_lshlrev_b32 v174, 16, v19
  v_and_b32 v175, 0xffff0000, v19
  v_mul_f32 v174, v168, v174
  v_mul_f32 v175, v168, v175
  v_cvt_pk_bf16_f32 v19, v174, v175
  v_lshlrev_b32 v174, 16, v19
  v_and_b32 v175, 0xffff0000, v19
  v_lshlrev_b32 v20, 16, v165
  v_and_b32 v21, 0xffff0000, v165
  v_add_f32 v174, v174, v20
  v_add_f32 v175, v175, v21
  v_cvt_pk_bf16_f32 v205, v174, v175
  v_pk_add_f32 v[176:177], v[176:177], v[192:193]
  v_cvt_pk_bf16_f32 v19, v176, v177
  v_lshlrev_b32 v176, 16, v19
  v_and_b32 v177, 0xffff0000, v19
  v_mul_f32 v176, v168, v176
  v_mul_f32 v177, v168, v177
  v_cvt_pk_bf16_f32 v19, v176, v177
  v_lshlrev_b32 v176, 16, v19
  v_and_b32 v177, 0xffff0000, v19
  v_lshlrev_b32 v20, 16, v166
  v_and_b32 v21, 0xffff0000, v166
  v_add_f32 v176, v176, v20
  v_add_f32 v177, v177, v21
  v_cvt_pk_bf16_f32 v206, v176, v177
  v_pk_add_f32 v[178:179], v[178:179], v[194:195]
  v_cvt_pk_bf16_f32 v19, v178, v179
  v_lshlrev_b32 v178, 16, v19
  v_and_b32 v179, 0xffff0000, v19
  v_mul_f32 v178, v168, v178
  v_mul_f32 v179, v168, v179
  v_cvt_pk_bf16_f32 v19, v178, v179
  v_lshlrev_b32 v178, 16, v19
  v_and_b32 v179, 0xffff0000, v19
  v_lshlrev_b32 v20, 16, v167
  v_and_b32 v21, 0xffff0000, v167
  v_add_f32 v178, v178, v20
  v_add_f32 v179, v179, v21
  v_cvt_pk_bf16_f32 v207, v178, v179
  s_nop 1
  v_permlane16_swap_b32 v204, v206
  v_permlane16_swap_b32 v205, v207
  buffer_store_dwordx4 v[204:207], v5, s[44:47], s70 offen
Lep_174:
  s_mov_b32 s60, s48
  s_and_b32 s58, s60, 1
  s_lshl_b32 s66, s58, 4
  v_add_u32 v17, s66, v9
  v_cmp_le_i32 s[78:79], 0, v17
  v_cmp_le_i32 s[80:81], 1, v17
  v_cmp_le_i32 s[82:83], 2, v17
  v_cmp_le_i32 s[84:85], 3, v17
  v_cmp_le_i32 s[86:87], 16, v17
  v_cmp_le_i32 s[88:89], 17, v17
  v_cmp_le_i32 s[90:91], 18, v17
  v_cmp_le_i32 s[92:93], 19, v17
Lchase:
  s_lshr_b32 s77, s60, 1
  s_add_u32 s77, s77, 54
  s_lshl_b32 s70, s77, 18
  s_lshl_b32 s66, s49, 13
  s_add_u32 s70, s70, s66
  s_add_u32 s71, s70, 4096
  s_lshl_b32 s66, s58, 12
  s_add_u32 s72, s70, s66
  s_add_u32 s72, s72, 33554432
  s_lshl_b32 s66, s50, 11
  s_add_u32 s73, s70, s66
  s_add_u32 s73, s73, 16777216
  buffer_load_dwordx4 v[32:35], v1, s[32:35], s72 offen offset:0 sc1
  buffer_load_dwordx4 v[36:39], v1, s[32:35], s72 offen offset:1024 sc1
  buffer_load_dwordx4 v[40:43], v1, s[32:35], s72 offen offset:2048 sc1
  buffer_load_dwordx4 v[44:47], v1, s[32:35], s72 offen offset:3072 sc1
  buffer_load_dwordx4 v[48:51], v1, s[32:35], s70 offen offset:0 sc1
  buffer_load_dwordx4 v[52:55], v1, s[32:35], s70 offen offset:1024 sc1
  buffer_load_dwordx4 v[56:59], v1, s[32:35], s70 offen offset:2048 sc1
  buffer_load_dwordx4 v[60:63], v1, s[32:35], s70 offen offset:3072 sc1
  buffer_load_dwordx4 v[64:67], v1, s[32:35], s71 offen offset:0 sc1
  buffer_load_dwordx4 v[68:71], v1, s[32:35], s71 offen offset:1024 sc1
  buffer_load_dwordx4 v[72:75], v1, s[32:35], s71 offen offset:2048 sc1
  buffer_load_dwordx4 v[76:79], v1, s[32:35], s71 offen offset:3072 sc1
  buffer_load_dwordx4 v[96:99], v1, s[32:35], s73 offen offset:0 sc1
  buffer_load_dwordx4 v[100:103], v1, s[32:35], s73 offen offset:1024 sc1
  s_lshl_b32 s72, s77, 7
  s_lshl_b32 s66, s58, 6
  s_add_u32 s72, s72, s66
  s_add_u32 s72, s72, 99024896
  s_lshl_b32 s73, s77, 16
  s_lshl_b32 s66, s49, 11
  s_add_u32 s73, s73, s66
  s_lshl_b32 s66, s58, 10
  s_add_u32 s73, s73, s66
  s_add_u32 s73, s73, 83886080
  buffer_load_dword v168, v7, s[32:35], s72 offen sc1
  buffer_load_dwordx4 v[164:167], v1, s[32:35], s73 offen sc1
  s_lshl_b32 s66, s49, 8
  s_add_u32 s66, s66, 142606336
  s_add_u32 s66, s66, s61
Lpw_175:
  buffer_load_dword v169, v4, s[32:35], s66 offen sc1
  s_waitcnt vmcnt(0)
  v_cmp_ge_u32 vcc, s77, v169
  s_cbranch_vccz Lpw_176
  s_sleep 2
  s_sub_u32 s69, s69, 1
  s_cbranch_scc0 Lpw_175
  s_endpgm
Lpw_176:
  s_lshl_b32 s70, s77, 18
  s_lshr_b32 s66, s49, 1
  s_lshl_b32 s66, s66, 14
  s_add_u32 s70, s70, s66
  s_and_b32 s66, s49, 1
  s_lshl_b32 s66, s66, 12
  s_add_u32 s70, s70, s66
  s_add_u32 s70, s70, 125829120
  s_lshr_b32 s66, s70, 8
  s_and_b32 s66, s66, 0x2000
  s_xor_b32 s66, s66, s61
  s_add_u32 s70, s70, s66
  s_lshl_b32 s66, s59, 11
  s_add_u32 s71, s70, s66
  s_and_b32 s66, s50, 1
  s_lshl_b32 s66, s66, 9
  s_add_u32 s71, s71, s66
  buffer_load_dwordx4 v[80:83], v2, s[32:35], s70 offen offset:0 sc1
  buffer_load_dwordx4 v[84:87], v2, s[32:35], s70 offen offset:512 sc1
  buffer_load_dwordx4 v[88:91], v2, s[32:35], s70 offen offset:2048 sc1
  buffer_load_dwordx4 v[92:95], v2, s[32:35], s70 offen offset:2560 sc1
  buffer_load_dwordx2 v[112:113], v3, s[32:35], s71 offen offset:1024 sc1
  buffer_load_dwordx2 v[114:115], v3, s[32:35], s71 offen offset:1280 sc1
  v_mfma_f32_16x16x32_bf16 v[120:123], v[48:51], v[32:35], 0
  v_mfma_f32_16x16x32_bf16 v[124:127], v[64:67], v[32:35], 0
  v_mfma_f32_16x16x32_bf16 v[120:123], v[52:55], v[36:39], v[120:123]
  v_mfma_f32_16x16x32_bf16 v[124:127], v[68:71], v[36:39], v[124:127]
  v_mfma_f32_16x16x32_bf16 v[120:123], v[56:59], v[40:43], v[120:123]
  v_mfma_f32_16x16x32_bf16 v[124:127], v[72:75], v[40:43], v[124:127]
  v_mfma_f32_16x16x32_bf16 v[120:123], v[60:63], v[44:47], v[120:123]
  v_mfma_f32_16x16x32_bf16 v[124:127], v[76:79], v[44:47], v[124:127]
  s_waitcnt vmcnt(5)
  v_mfma_f32_16x16x32_bf16 v[128:131], v[80:83], v[32:35], 0
  s_waitcnt vmcnt(4)
  v_mfma_f32_16x16x32_bf16 v[128:131], v[84:87], v[36:39], v[128:131]
  s_waitcnt vmcnt(3)
  v_mfma_f32_16x16x32_bf16 v[128:131], v[88:91], v[40:43], v[128:131]
  s_waitcnt vmcnt(2)
  v_mfma_f32_16x16x32_bf16 v[128:131], v[92:95], v[44:47], v[128:131]
  v_mov_b32 v16, 0xff800000
  v_cndmask_b32 v120, v16, v120, s[78:79]
  v_cndmask_b32 v121, v16, v121, s[80:81]
  v_cndmask_b32 v122, v16, v122, s[82:83]
  v_cndmask_b32 v123, v16, v123, s[84:85]
  v_cndmask_b32 v124, v16, v124, s[86:87]
  v_cndmask_b32 v125, v16, v125, s[88:89]
  v_cndmask_b32 v126, v16, v126, s[90:91]
  v_cndmask_b32 v127, v16, v127, s[92:93]
  s_mov_b32 exec_lo, 0
  v_mov_b32 v128, v16
  v_mov_b32 v129, v16
  v_mov_b32 v130, v16
  v_mov_b32 v131, v16
  s_mov_b32 exec_lo, -1
  v_max3_f32 v16, v120, v121, v122
  v_max3_f32 v17, v123, v124, v125
  v_max3_f32 v16, v16, v126, v127
  v_max3_f32 v17, v17, v128, v129
  v_max3_f32 v16, v16, v130, v131
  v_max_f32 v16, v16, v17
  v_mov_b32 v17, v16
  s_nop 1
  v_permlane32_swap_b32 v16, v17
  v_max_f32 v16, v16, v17
  v_mov_b32 v17, v16
  s_nop 1
  v_permlane16_swap_b32 v16, v17
  v_max_f32 v16, v16, v17
  v_mul_f32 v16, s94, v16
  v_fma_f32 v120, v120, s94, -v16
  v_fma_f32 v121, v121, s94, -v16
  v_fma_f32 v122, v122, s94, -v16
  v_fma_f32 v123, v123, s94, -v16
  v_fma_f32 v124, v124, s94, -v16
  v_fma_f32 v125, v125, s94, -v16
  v_fma_f32 v126, v126, s94, -v16
  v_fma_f32 v127, v127, s94, -v16
  v_fma_f32 v128, v128, s94, -v16
  v_fma_f32 v129, v129, s94, -v16
  v_fma_f32 v130, v130, s94, -v16
  v_fma_f32 v131, v131, s94, -v16
  v_exp_f32 v120, v120
  v_exp_f32 v121, v121
  v_exp_f32 v122, v122
  v_exp_f32 v123, v123
  v_exp_f32 v124, v124
  v_exp_f32 v125, v125
  v_exp_f32 v126, v126
  v_exp_f32 v127, v127
  v_exp_f32 v128, v128
  v_exp_f32 v129, v129
  v_exp_f32 v130, v130
  v_exp_f32 v131, v131
  s_nop 0
  v_cvt_pk_bf16_f32 v132, v120, v121
  v_cvt_pk_bf16_f32 v133, v122, v123
  v_cvt_pk_bf16_f32 v134, v124, v125
  v_cvt_pk_bf16_f32 v135, v126, v127
  v_cvt_pk_bf16_f32 v136, v128, v129
  v_cvt_pk_bf16_f32 v137, v130, v131
  s_waitcnt vmcnt(0)
  s_nop 0
  v_mfma_f32_16x16x32_bf16 v[156:159], v[160:163], v[132:135], 0
  v_mfma_f32_16x16x32_bf16 v[140:143], v[96:99], v[132:135], 0
  v_mfma_f32_16x16x32_bf16 v[144:147], v[100:103], v[132:135], 0
  s_nop 3
  v_mfma_f32_16x16x16_bf16 v[156:159], v[160:161], v[136:137], v[156:159]
  v_mfma_f32_16x16x16_bf16 v[140:143], v[112:113], v[136:137], v[140:143]
  v_mfma_f32_16x16x16_bf16 v[144:147], v[114:115], v[136:137], v[144:147]
  s_lshl_b32 s70, s77, 18
  s_lshl_b32 s66, s58, 17
  s_add_u32 s70, s70, s66
  s_lshl_b32 s66, s49, 12
  s_add_u32 s70, s70, s66
  s_lshl_b32 s66, s50, 10
  s_add_u32 s70, s70, s66
  s_add_u32 s70, s70, 67108864
  v_rcp_f32 v16, v156
  s_nop 0
  v_pk_mul_f32 v[140:141], v[140:141], v[16:17] op_sel_hi:[1,0]
  v_pk_mul_f32 v[142:143], v[142:143], v[16:17] op_sel_hi:[1,0]
  v_pk_mul_f32 v[144:145], v[144:145], v[16:17] op_sel_hi:[1,0]
  v_pk_mul_f32 v[146:147], v[146:147], v[16:17] op_sel_hi:[1,0]
  v_cvt_pk_bf16_f32 v120, v140, v141
  v_cvt_pk_bf16_f32 v121, v142, v143
  v_cvt_pk_bf16_f32 v122, v144, v145
  v_cvt_pk_bf16_f32 v123, v146, v147
  v_min_u32 v120, -2, v120
  s_cmp_eq_u32 s1, 8
  s_cbranch_scc1 Lst_177
  buffer_store_dwordx4 v[120:123], v1, s[32:35], s70 offen offset:0
  s_branch Lst_178
Lst_177:
  buffer_store_dwordx4 v[120:123], v1, s[32:35], s70 offen offset:0 sc1
Lst_178:
  s_barrier
Lredo_179:
  s_lshl_b32 s70, s77, 18
  s_add_u32 s70, s70, 67108864
  s_lshl_b32 s66, s58, 17
  s_add_u32 s70, s70, s66
  buffer_load_dword v16, v8, s[32:35], s70 offen sc1
  s_waitcnt vmcnt(0)
  v_cmp_eq_u32 vcc, -1, v16
  s_cbranch_vccz Lpr_180
  s_sub_u32 s69, s69, 1
  s_cbranch_scc0 Lredo_179
  s_endpgm
Lpr_180:
  v_mov_b32 v18, 0
  s_lshl_b32 s70, s77, 18
  s_lshl_b32 s66, s50, 15
  s_add_u32 s70, s70, s66
  s_add_u32 s70, s70, 67108864
  s_add_u32 s71, s70, 131072
  s_lshl_b32 s66, s58, 17
  s_add_u32 s70, s70, s66
  buffer_load_dwordx4 v[172:175], v1, s[32:35], s70 offen offset:0 sc1
  buffer_load_dwordx4 v[176:179], v1, s[32:35], s70 offen offset:1024 sc1
  buffer_load_dwordx4 v[180:183], v1, s[32:35], s70 offen offset:2048 sc1
  buffer_load_dwordx4 v[184:187], v1, s[32:35], s70 offen offset:3072 sc1
  s_add_u32 s70, s70, 4096
  s_add_u32 s71, s71, 4096
  buffer_load_dwordx4 v[188:191], v1, s[32:35], s70 offen offset:0 sc1
  buffer_load_dwordx4 v[192:195], v1, s[32:35], s70 offen offset:1024 sc1
  buffer_load_dwordx4 v[196:199], v1, s[32:35], s70 offen offset:2048 sc1
  buffer_load_dwordx4 v[200:203], v1, s[32:35], s70 offen offset:3072 sc1
  s_add_u32 s70, s70, 4096
  s_add_u32 s71, s71, 4096
  buffer_load_dwordx4 v[204:207], v1, s[32:35], s70 offen offset:0 sc1
  buffer_load_dwordx4 v[208:211], v1, s[32:35], s70 offen offset:1024 sc1
  buffer_load_dwordx4 v[212:215], v1, s[32:35], s70 offen offset:2048 sc1
  buffer_load_dwordx4 v[216:219], v1, s[32:35], s70 offen offset:3072 sc1
  s_add_u32 s70, s70, 4096
  s_add_u32 s71, s71, 4096
  buffer_load_dwordx4 v[220:223], v1, s[32:35], s70 offen offset:0 sc1
  buffer_load_dwordx4 v[224:227], v1, s[32:35], s70 offen offset:1024 sc1
  buffer_load_dwordx4 v[228:231], v1, s[32:35], s70 offen offset:2048 sc1
  buffer_load_dwordx4 v[232:235], v1, s[32:35], s70 offen offset:3072 sc1
  s_add_u32 s70, s70, 4096
  s_add_u32 s71, s71, 4096
  buffer_load_dwordx4 v[236:239], v1, s[32:35], s70 offen offset:0 sc1
  buffer_load_dwordx4 v[240:243], v1, s[32:35], s70 offen offset:1024 sc1
  buffer_load_dwordx4 v[244:247], v1, s[32:35], s70 offen offset:2048 sc1
  s_waitcnt vmcnt(18)
  v_mfma_f32_16x16x32_bf16 v[140:143], a[0:3], v[172:175], 0
  buffer_load_dwordx4 v[248:251], v1, s[32:35], s70 offen offset:3072 sc1
  v_mfma_f32_16x16x32_bf16 v[144:147], a[4:7], v[172:175], 0
  v_max_u32 v18, v18, v172
  s_waitcnt vmcnt(18)
  v_mfma_f32_16x16x32_bf16 v[140:143], a[8:11], v[176:179], v[140:143]
  s_add_u32 s70, s70, 4096
  s_add_u32 s71, s71, 4096
  buffer_load_dwordx4 v[172:175], v1, s[32:35], s70 offen offset:0 sc1
  v_mfma_f32_16x16x32_bf16 v[144:147], a[12:15], v[176:179], v[144:147]
  v_max_u32 v18, v18, v176
  s_waitcnt vmcnt(18)
  v_mfma_f32_16x16x32_bf16 v[140:143], a[16:19], v[180:183], v[140:143]
  buffer_load_dwordx4 v[176:179], v1, s[32:35], s70 offen offset:1024 sc1
  v_mfma_f32_16x16x32_bf16 v[144:147], a[20:23], v[180:183], v[144:147]
  v_max_u32 v18, v18, v180
  s_waitcnt vmcnt(18)
  v_mfma_f32_16x16x32_bf16 v[140:143], a[24:27], v[184:187], v[140:143]
  buffer_load_dwordx4 v[180:183], v1, s[32:35], s70 offen offset:2048 sc1
  v_mfma_f32_16x16x32_bf16 v[144:147], a[28:31], v[184:187], v[144:147]
  v_max_u32 v18, v18, v184
  s_waitcnt vmcnt(18)
  v_mfma_f32_16x16x32_bf16 v[140:143], a[32:35], v[188:191], v[140:143]
  buffer_load_dwordx4 v[184:187], v1, s[32:35], s70 offen offset:3072 sc1
  v_mfma_f32_16x16x32_bf16 v[144:147], a[36:39], v[188:191], v[144:147]
  v_max_u32 v18, v18, v188
  s_waitcnt vmcnt(18)
  v_mfma_f32_16x16x32_bf16 v[140:143], a[40:43], v[192:195], v[140:143]
  s_add_u32 s70, s70, 4096
  s_add_u32 s71, s71, 4096
  buffer_load_dwordx4 v[188:191], v1, s[32:35], s70 offen offset:0 sc1
  v_mfma_f32_16x16x32_bf16 v[144:147], a[44:47], v[192:195], v[144:147]
  v_max_u32 v18, v18, v192
  s_waitcnt vmcnt(18)
  v_mfma_f32_16x16x32_bf16 v[140:143], a[48:51], v[196:199], v[140:143]
  buffer_load_dwordx4 v[192:195], v1, s[32:35], s70 offen offset:1024 sc1
  v_mfma_f32_16x16x32_bf16 v[144:147], a[52:55], v[196:199], v[144:147]
  v_max_u32 v18, v18, v196
  s_waitcnt vmcnt(18)
  v_mfma_f32_16x16x32_bf16 v[140:143], a[56:59], v[200:203], v[140:143]
  buffer_load_dwordx4 v[196:199], v1, s[32:35], s70 offen offset:2048 sc1
  v_mfma_f32_16x16x32_bf16 v[144:147], a[60:63], v[200:203], v[144:147]
  v_max_u32 v18, v18, v200
  s_waitcnt vmcnt(18)
  v_mfma_f32_16x16x32_bf16 v[140:143], a[64:67], v[204:207], v[140:143]
  buffer_load_dwordx4 v[200:203], v1, s[32:35], s70 offen offset:3072 sc1
  v_mfma_f32_16x16x32_bf16 v[144:147], a[68:71], v[204:207], v[144:147]
  v_max_u32 v18, v18, v204
  s_waitcnt vmcnt(18)
  v_mfma_f32_16x16x32_bf16 v[140:143], a[72:75], v[208:211], v[140:143]
  s_add_u32 s70, s70, 4096
  s_add_u32 s71, s71, 4096
  buffer_load_dwordx4 v[204:207], v1, s[32:35], s70 offen offset:0 sc1
  v_mfma_f32_16x16x32_bf16 v[144:147], a[76:79], v[208:211], v[144:147]
  v_max_u32 v18, v18, v208
  s_waitcnt vmcnt(18)
  v_mfma_f32_16x16x32_bf16 v[140:143], a[80:83], v[212:215], v[140:143]
  buffer_load_dwordx4 v[208:211], v1, s[32:35], s70 offen offset:1024 sc1
  v_mfma_f32_16x16x32_bf16 v[144:147], a[84:87], v[212:215], v[144:147]
  v_max_u32 v18, v18, v212
  s_waitcnt vmcnt(18)
  v_mfma_f32_16x16x32_bf16 v[140:143], a[88:91], v[216:219], v[140:143]
  buffer_load_dwordx4 v[212:215], v1, s[32:35], s70 offen offset:2048 sc1
  v_mfma_f32_16x16x32_bf16 v[144:147], a[92:95], v[216:219], v[144:147]
  v_max_u32 v18, v18, v216
  s_waitcnt vmcnt(18)
  v_mfma_f32_16x16x32_bf16 v[140:143], a[96:99], v[220:223], v[140:143]
  buffer_load_dwordx4 v[216:219], v1, s[32:35], s70 offen offset:3072 sc1
  v_mfma_f32_16x16x32_bf16 v[144:147], a[100:103], v[220:223], v[144:147]
  v_max_u32 v18, v18, v220
  s_waitcnt vmcnt(18)
  v_mfma_f32_16x16x32_bf16 v[140:143], a[104:107], v[224:227], v[140:143]
  v_mfma_f32_16x16x32_bf16 v[144:147], a[108:111], v[224:227], v[144:147]
  v_max_u32 v18, v18, v224
  s_waitcnt vmcnt(17)
  v_mfma_f32_16x16x32_bf16 v[140:143], a[112:115], v[228:231], v[140:143]
  v_mfma_f32_16x16x32_bf16 v[144:147], a[116:119], v[228:231], v[144:147]
  v_max_u32 v18, v18, v228
  s_waitcnt vmcnt(16)
  v_mfma_f32_16x16x32_bf16 v[140:143], a[120:123], v[232:235], v[140:143]
  v_mfma_f32_16x16x32_bf16 v[144:147], a[124:127], v[232:235], v[144:147]
  v_max_u32 v18, v18, v232
  s_waitcnt vmcnt(15)
  v_mfma_f32_16x16x32_bf16 v[140:143], a[128:131], v[236:239], v[140:143]
  v_mfma_f32_16x16x32_bf16 v[144:147], a[132:135], v[236:239], v[144:147]
  v_max_u32 v18, v18, v236
  s_waitcnt vmcnt(14)
  v_mfma_f32_16x16x32_bf16 v[140:143], a[136:139], v[240:243], v[140:143]
  v_mfma_f32_16x16x32_bf16 v[144:147], a[140:143], v[240:243], v[144:147]
  v_max_u32 v18, v18, v240
  s_waitcnt vmcnt(13)
  v_mfma_f32_16x16x32_bf16 v[140:143], a[144:147], v[244:247], v[140:143]
  v_mfma_f32_16x16x32_bf16 v[144:147], a[148:151], v[244:247], v[144:147]
  v_max_u32 v18, v18, v244
  s_waitcnt vmcnt(12)
  v_mfma_f32_16x16x32_bf16 v[140:143], a[152:155], v[248:251], v[140:143]
  v_mfma_f32_16x16x32_bf16 v[144:147], a[156:159], v[248:251], v[144:147]
  v_max_u32 v18, v18, v248
  s_waitcnt vmcnt(11)
  v_mfma_f32_16x16x32_bf16 v[140:143], a[160:163], v[172:175], v[140:143]
  v_mfma_f32_16x16x32_bf16 v[144:147], a[164:167], v[172:175], v[144:147]
  v_max_u32 v18, v18, v172
  s_waitcnt vmcnt(10)
  v_mfma_f32_16x16x32_bf16 v[140:143], a[168:171], v[176:179], v[140:143]
  v_mfma_f32_16x16x32_bf16 v[144:147], a[172:175], v[176:179], v[144:147]
  v_max_u32 v18, v18, v176
  s_waitcnt vmcnt(9)
  v_mfma_f32_16x16x32_bf16 v[140:143], a[176:179], v[180:183], v[140:143]
  v_mfma_f32_16x16x32_bf16 v[144:147], a[180:183], v[180:183], v[144:147]
  v_max_u32 v18, v18, v180
  s_waitcnt vmcnt(8)
  v_mfma_f32_16x16x32_bf16 v[140:143], a[184:187], v[184:187], v[140:143]
  v_mfma_f32_16x16x32_bf16 v[144:147], a[188:191], v[184:187], v[144:147]
  v_max_u32 v18, v18, v184
  s_waitcnt vmcnt(7)
  v_mfma_f32_16x16x32_bf16 v[140:143], a[192:195], v[188:191], v[140:143]
  v_mfma_f32_16x16x32_bf16 v[144:147], a[196:199], v[188:191], v[144:147]
  v_max_u32 v18, v18, v188
  s_waitcnt vmcnt(6)
  v_mfma_f32_16x16x32_bf16 v[140:143], a[200:203], v[192:195], v[140:143]
  v_mfma_f32_16x16x32_bf16 v[144:147], a[204:207], v[192:195], v[144:147]
  v_max_u32 v18, v18, v192
  s_waitcnt vmcnt(5)
  v_mfma_f32_16x16x32_bf16 v[140:143], a[208:211], v[196:199], v[140:143]
  v_mfma_f32_16x16x32_bf16 v[144:147], a[212:215], v[196:199], v[144:147]
  v_max_u32 v18, v18, v196
  s_waitcnt vmcnt(4)
  v_mfma_f32_16x16x32_bf16 v[140:143], a[216:219], v[200:203], v[140:143]
  v_mfma_f32_16x16x32_bf16 v[144:147], a[220:223], v[200:203], v[144:147]
  v_max_u32 v18, v18, v200
  s_waitcnt vmcnt(3)
  v_mfma_f32_16x16x32_bf16 v[140:143], a[224:227], v[204:207], v[140:143]
  v_mfma_f32_16x16x32_bf16 v[144:147], a[228:231], v[204:207], v[144:147]
  v_max_u32 v18, v18, v204
  s_waitcnt vmcnt(2)
  v_mfma_f32_16x16x32_bf16 v[140:143], a[232:235], v[208:211], v[140:143]
  v_mfma_f32_16x16x32_bf16 v[144:147], a[236:239], v[208:211], v[144:147]
  v_max_u32 v18, v18, v208
  s_waitcnt vmcnt(1)
  v_mfma_f32_16x16x32_bf16 v[140:143], a[240:243], v[212:215], v[140:143]
  v_mfma_f32_16x16x32_bf16 v[144:147], a[244:247], v[212:215], v[144:147]
  v_max_u32 v18, v18, v212
  s_waitcnt vmcnt(0)
  v_mfma_f32_16x16x32_bf16 v[140:143], a[248:251], v[216:219], v[140:143]
  v_mfma_f32_16x16x32_bf16 v[144:147], a[252:255], v[216:219], v[144:147]
  v_max_u32 v18, v18, v216
  v_cmp_eq_u32 vcc, -1, v18
  s_cbranch_vccnz Lredo_179
  s_lshl_b32 s66, s50, 12
  v_add_u32 v16, s66, v1
  s_lshl_b32 s66, s50, 11
  v_add_u32 v17, s66, v1
  s_nop 3
  ds_write_b128 v16, v[140:143] offset:0
  ds_write_b128 v16, v[144:147] offset:1024
  s_waitcnt lgkmcnt(0)
  s_barrier
  s_cmp_ge_u32 s50, 1
  s_cbranch_scc1 Lep_181
  ds_read_b128 v[172:175], v17 offset:0
  ds_read_b128 v[176:179], v17 offset:1024
  ds_read_b128 v[180:183], v17 offset:4096
  ds_read_b128 v[184:187], v17 offset:5120
  ds_read_b128 v[188:191], v17 offset:8192
  ds_read_b128 v[192:195], v17 offset:9216
  ds_read_b128 v[196:199], v17 offset:12288
  ds_read_b128 v[200:203], v17 offset:13312
  v_sub_f32 v18, 1.0, v168
  v_cvt_pk_bf16_f32 v18, v18, v18
  v_lshlrev_b32 v18, 16, v18
  s_lshl_b32 s70, s77, 16
  s_lshl_b32 s66, s58, 15
  s_add_u32 s70, s70, s66
  s_lshl_b32 s66, s49, 6
  s_add_u32 s70, s70, s66
  v_lshlrev_b32 v204, 16, v164
  v_and_b32 v205, 0xffff0000, v164
  v_mul_f32 v204, v18, v204
  v_mul_f32 v205, v18, v205
  v_cvt_pk_bf16_f32 v164, v204, v205
  v_lshlrev_b32 v206, 16, v165
  v_and_b32 v207, 0xffff0000, v165
  v_mul_f32 v206, v18, v206
  v_mul_f32 v207, v18, v207
  v_cvt_pk_bf16_f32 v165, v206, v207
  v_lshlrev_b32 v208, 16, v166
  v_and_b32 v209, 0xffff0000, v166
  v_mul_f32 v208, v18, v208
  v_mul_f32 v209, v18, v209
  v_cvt_pk_bf16_f32 v166, v208, v209
  v_lshlrev_b32 v210, 16, v167
  v_and_b32 v211, 0xffff0000, v167
  v_mul_f32 v210, v18, v210
  v_mul_f32 v211, v18, v211
  v_cvt_pk_bf16_f32 v167, v210, v211
  s_waitcnt lgkmcnt(0)
  v_pk_add_f32 v[172:173], v[172:173], v[180:181]
  v_pk_add_f32 v[188:189], v[188:189], v[196:197]
  v_pk_add_f32 v[174:175], v[174:175], v[182:183]
  v_pk_add_f32 v[190:191], v[190:191], v[198:199]
  v_pk_add_f32 v[176:177], v[176:177], v[184:185]
  v_pk_add_f32 v[192:193], v[192:193], v[200:201]
  v_pk_add_f32 v[178:179], v[178:179], v[186:187]
  v_pk_add_f32 v[194:195], v[194:195], v[202:203]
  v_pk_add_f32 v[172:173], v[172:173], v[188:189]
  v_cvt_pk_bf16_f32 v19, v172, v173
  v_lshlrev_b32 v172, 16, v19
  v_and_b32 v173, 0xffff0000, v19
  v_mul_f32 v172, v168, v172
  v_mul_f32 v173, v168, v173
  v_cvt_pk_bf16_f32 v19, v172, v173
  v_lshlrev_b32 v172, 16, v19
  v_and_b32 v173, 0xffff0000, v19
  v_lshlrev_b32 v20, 16, v164
  v_and_b32 v21, 0xffff0000, v164
  v_add_f32 v172, v172, v20
  v_add_f32 v173, v173, v21
  v_cvt_pk_bf16_f32 v204, v172, v173
  v_pk_add_f32 v[174:175], v[174:175], v[190:191]
  v_cvt_pk_bf16_f32 v19, v174, v175
  v_lshlrev_b32 v174, 16, v19
  v_and_b32 v175, 0xffff0000, v19
  v_mul_f32 v174, v168, v174
  v_mul_f32 v175, v168, v175
  v_cvt_pk_bf16_f32 v19, v174, v175
  v_lshlrev_b32 v174, 16, v19
  v_and_b32 v175, 0xffff0000, v19
  v_lshlrev_b32 v20, 16, v165
  v_and_b32 v21, 0xffff0000, v165
  v_add_f32 v174, v174, v20
  v_add_f32 v175, v175, v21
  v_cvt_pk_bf16_f32 v205, v174, v175
  v_pk_add_f32 v[176:177], v[176:177], v[192:193]
  v_cvt_pk_bf16_f32 v19, v176, v177
  v_lshlrev_b32 v176, 16, v19
  v_and_b32 v177, 0xffff0000, v19
  v_mul_f32 v176, v168, v176
  v_mul_f32 v177, v168, v177
  v_cvt_pk_bf16_f32 v19, v176, v177
  v_lshlrev_b32 v176, 16, v19
  v_and_b32 v177, 0xffff0000, v19
  v_lshlrev_b32 v20, 16, v166
  v_and_b32 v21, 0xffff0000, v166
  v_add_f32 v176, v176, v20
  v_add_f32 v177, v177, v21
  v_cvt_pk_bf16_f32 v206, v176, v177
  v_pk_add_f32 v[178:179], v[178:179], v[194:195]
  v_cvt_pk_bf16_f32 v19, v178, v179
  v_lshlrev_b32 v178, 16, v19
  v_and_b32 v179, 0xffff0000, v19
  v_mul_f32 v178, v168, v178
  v_mul_f32 v179, v168, v179
  v_cvt_pk_bf16_f32 v19, v178, v179
  v_lshlrev_b32 v178, 16, v19
  v_and_b32 v179, 0xffff0000, v19
  v_lshlrev_b32 v20, 16, v167
  v_and_b32 v21, 0xffff0000, v167
  v_add_f32 v178, v178, v20
  v_add_f32 v179, v179, v21
  v_cvt_pk_bf16_f32 v207, v178, v179
  s_nop 1
  v_permlane16_swap_b32 v204, v206
  v_permlane16_swap_b32 v205, v207
  buffer_store_dwordx4 v[204:207], v5, s[44:47], s70 offen
Lep_181:
  s_add_u32 s60, s60, 6
  s_cmp_lt_u32 s60, 20
  s_cbranch_scc1 Lchase
  s_waitcnt vmcnt(0)
  s_endpgm
  .p2align 6
  .type Ltasks,@object
Ltasks:
  .long 16777217, 4, 6148, 5, 7, 6, 0, 0, 0, 0, 0, 0, 0, 0, 0, 0
  .long 16777233, 20, 6164, 21, 7, 6, 0, 0, 0, 0, 0, 0, 0, 0, 0, 0
  .long 17, 36, 6180, 37, 7, 6, 0, 0, 0, 0, 0, 0, 0, 0, 0, 0
  .long 16777218, 52, 6196, 53, 7, 6, 0, 0, 0, 0, 0, 0, 0, 0, 0, 0
  .long 16777234, 260, 6212, 261, 7, 6, 0, 0, 0, 0, 0, 0, 0, 0, 0, 0
  .long 18, 276, 6228, 277, 7, 6, 0, 0, 0, 0, 0, 0, 0, 0, 0, 0
  .long 16777473, 292, 6244, 293, 7, 6, 0, 0, 0, 0, 0, 0, 0, 0, 0, 0
  .long 16777489, 308, 6260, 309, 7, 6, 0, 0, 0, 0, 0, 0, 0, 0, 0, 0
  .long 273, 516, 6404, 517, 7, 6, 0, 0, 0, 0, 0, 0, 0, 0, 0, 0
  .long 16777474, 532, 6420, 533, 7, 6, 0, 0, 0, 0, 0, 0, 0, 0, 0, 0
  .long 16777490, 548, 6436, 549, 7, 6, 0, 0, 0, 0, 0, 0, 0, 0, 0, 0
  .long 274, 564, 6452, 565, 7, 6, 0, 0, 0, 0, 0, 0, 0, 0, 0, 0
  .long 16777729, 772, 6468, 773, 7, 6, 0, 0, 0, 0, 0, 0, 0, 0, 0, 0
  .long 16777745, 788, 6484, 789, 7, 6, 0, 0, 0, 0, 0, 0, 0, 0, 0, 0
  .long 529, 804, 6500, 805, 7, 6, 0, 0, 0, 0, 0, 0, 0, 0, 0, 0
  .long 16777730, 820, 6516, 821, 7, 6, 0, 0, 0, 0, 0, 0, 0, 0, 0, 0
  .long 16777746, 1028, 6660, 1029, 7, 6, 0, 0, 0, 0, 0, 0, 0, 0, 0, 0
  .long 530, 1044, 6676, 1045, 7, 6, 0, 0, 0, 0, 0, 0, 0, 0, 0, 0
  .long 16777985, 1060, 6692, 1061, 7, 6, 0, 0, 0, 0, 0, 0, 0, 0, 0, 0
  .long 16778001, 1076, 6708, 1077, 7, 6, 0, 0, 0, 0, 0, 0, 0, 0, 0, 0
  .long 785, 1284, 6724, 1285, 7, 6, 0, 0, 0, 0, 0, 0, 0, 0, 0, 0
  .long 16777986, 1300, 6740, 1301, 7, 6, 0, 0, 0, 0, 0, 0, 0, 0, 0, 0
  .long 16778002, 1316, 6756, 1317, 7, 6, 0, 0, 0, 0, 0, 0, 0, 0, 0, 0
  .long 786, 1332, 6772, 1333, 7, 6, 0, 0, 0, 0, 0, 0, 0, 0, 0, 0
  .long 16778241, 1540, 6916, 1541, 7, 6, 0, 0, 0, 0, 0, 0, 0, 0, 0, 0
  .long 16778257, 1556, 6932, 1557, 7, 6, 0, 0, 0, 0, 0, 0, 0, 0, 0, 0
  .long 1041, 1572, 6948, 1573, 7, 6, 0, 0, 0, 0, 0, 0, 0, 0, 0, 0
  .long 16778242, 1588, 6964, 1589, 7, 6, 0, 0, 0, 0, 0, 0, 0, 0, 0, 0
  .long 16778258, 1796, 6980, 1797, 7, 6, 0, 0, 0, 0, 0, 0, 0, 0, 0, 0
  .long 1042, 1812, 6996, 1813, 7, 6, 0, 0, 0, 0, 0, 0, 0, 0, 0, 0
  .long 16778497, 1828, 7012, 1829, 7, 6, 0, 0, 0, 0, 0, 0, 0, 0, 0, 0
  .long 16778513, 1844, 7028, 1845, 7, 6, 0, 0, 0, 0, 0, 0, 0, 0, 0, 0
  .long 1297, 68, 3, 69, 7, 6, 0, 0, 0, 0, 0, 0, 0, 0, 0, 0
  .long 16778498, 84, 19, 85, 7, 6, 0, 0, 0, 0, 0, 0, 0, 0, 0, 0
  .long 16778514, 100, 35, 101, 7, 6, 0, 0, 0, 0, 0, 0, 0, 0, 0, 0
  .long 1298, 116, 51, 117, 7, 6, 0, 0, 0, 0, 0, 0, 0, 0, 0, 0
  .long 16778753, 324, 259, 325, 7, 6, 0, 0, 0, 0, 0, 0, 0, 0, 0, 0
  .long 16778769, 340, 275, 341, 7, 6, 0, 0, 0, 0, 0, 0, 0, 0, 0, 0
  .long 1553, 356, 291, 357, 7, 6, 0, 0, 0, 0, 0, 0, 0, 0, 0, 0
  .long 16778754, 372, 307, 373, 7, 6, 0, 0, 0, 0, 0, 0, 0, 0, 0, 0
  .long 16778770, 580, 515, 581, 7, 6, 0, 0, 0, 0, 0, 0, 0, 0, 0, 0
  .long 1554, 596, 531, 597, 7, 6, 0, 0, 0, 0, 0, 0, 0, 0, 0, 0
  .long 16779009, 612, 547, 613, 7, 6, 0, 0, 0, 0, 0, 0, 0, 0, 0, 0
  .long 16779025, 628, 563, 629, 7, 6, 0, 0, 0, 0, 0, 0, 0, 0, 0, 0
  .long 1809, 836, 771, 837, 7, 6, 0, 0, 0, 0, 0, 0, 0, 0, 0, 0
  .long 16779010, 852, 787, 853, 7, 6, 0, 0, 0, 0, 0, 0, 0, 0, 0, 0
  .long 16779026, 868, 803, 869, 7, 6, 0, 0, 0, 0, 0, 0, 0, 0, 0, 0
  .long 1810, 884, 819, 885, 7, 6, 0, 0, 0, 0, 0, 0, 0, 0, 0, 0
  .long 16779265, 1092, 1027, 1093, 7, 6, 0, 0, 0, 0, 0, 0, 0, 0, 0, 0
  .long 16779281, 1108, 1043, 1109, 7, 6, 0, 0, 0, 0, 0, 0, 0, 0, 0, 0
  .long 2065, 1124, 1059, 1125, 7, 6, 0, 0, 0, 0, 0, 0, 0, 0, 0, 0
  .long 16779266, 1140, 1075, 1141, 7, 6, 0, 0, 0, 0, 0, 0, 0, 0, 0, 0
  .long 16779282, 1348, 1283, 1349, 7, 6, 0, 0, 0, 0, 0, 0, 0, 0, 0, 0
  .long 2066, 1364, 1299, 1365, 7, 6, 0, 0, 0, 0, 0, 0, 0, 0, 0, 0
  .long 16779521, 1380, 1315, 1381, 7, 6, 0, 0, 0, 0, 0, 0, 0, 0, 0, 0
  .long 16779537, 1396, 1331, 1397, 7, 6, 0, 0, 0, 0, 0, 0, 0, 0, 0, 0
  .long 2321, 1604, 1539, 1605, 7, 6, 0, 0, 0, 0, 0, 0, 0, 0, 0, 0
  .long 16779522, 1620, 1555, 1621, 7, 6, 0, 0, 0, 0, 0, 0, 0, 0, 0, 0
  .long 16779538, 1636, 1571, 1637, 7, 6, 0, 0, 0, 0, 0, 0, 0, 0, 0, 0
  .long 2322, 1652, 1587, 1653, 7, 6, 0, 0, 0, 0, 0, 0, 0, 0, 0, 0
  .long 16779777, 1860, 1795, 1861, 7, 6, 0, 0, 0, 0, 0, 0, 0, 0, 0, 0
  .long 16779793, 1876, 1811, 1877, 7, 6, 0, 0, 0, 0, 0, 0, 0, 0, 0, 0
  .long 2577, 1892, 1827, 1893, 7, 6, 0, 0, 0, 0, 0, 0, 0, 0, 0, 0
  .long 16779778, 1908, 1843, 1909, 7, 6, 0, 0, 0, 0, 0, 0, 0, 0, 0, 0
  .long 16779794, 2052, 33, 65, 4161, 2051, 7, 6, 0, 0, 0, 0, 0, 0, 0, 0
  .long 2578, 2068, 49, 81, 4177, 2067, 7, 6, 0, 0, 0, 0, 0, 0, 0, 0
  .long 16780033, 2084, 34, 97, 4193, 2083, 7, 6, 0, 0, 0, 0, 0, 0, 0, 0
  .long 16780049, 2100, 50, 113, 4209, 2099, 7, 6, 0, 0, 0, 0, 0, 0, 0, 0
  .long 2833, 2308, 289, 66, 4162, 2307, 7, 6, 0, 0, 0, 0, 0, 0, 0, 0
  .long 16780034, 2324, 305, 82, 4178, 2323, 7, 6, 0, 0, 0, 0, 0, 0, 0, 0
  .long 16780050, 2340, 290, 98, 4194, 2339, 7, 6, 0, 0, 0, 0, 0, 0, 0, 0
  .long 2834, 2356, 306, 114, 4210, 2355, 7, 6, 0, 0, 0, 0, 0, 0, 0, 0
  .long 16780289, 2564, 545, 321, 4417, 2563, 7, 6, 0, 0, 0, 0, 0, 0, 0, 0
  .long 16780305, 2580, 561, 337, 4433, 2579, 7, 6, 0, 0, 0, 0, 0, 0, 0, 0
  .long 3089, 2596, 546, 353, 4449, 2595, 7, 6, 0, 0, 0, 0, 0, 0, 0, 0
  .long 16780290, 2612, 562, 369, 4465, 2611, 7, 6, 0, 0, 0, 0, 0, 0, 0, 0
  .long 16780306, 2820, 801, 322, 4418, 2819, 7, 6, 0, 0, 0, 0, 0, 0, 0, 0
  .long 3090, 2836, 817, 338, 4434, 2835, 7, 6, 0, 0, 0, 0, 0, 0, 0, 0
  .long 16780545, 2852, 802, 354, 4450, 2851, 7, 6, 0, 0, 0, 0, 0, 0, 0, 0
  .long 16780561, 2868, 818, 370, 4466, 2867, 7, 6, 0, 0, 0, 0, 0, 0, 0, 0
  .long 3345, 3076, 1057, 577, 4673, 3075, 7, 6, 0, 0, 0, 0, 0, 0, 0, 0
  .long 16780546, 3092, 1073, 593, 4689, 3091, 7, 6, 0, 0, 0, 0, 0, 0, 0, 0
  .long 16780562, 3108, 1058, 609, 4705, 3107, 7, 6, 0, 0, 0, 0, 0, 0, 0, 0
  .long 3346, 3124, 1074, 625, 4721, 3123, 7, 6, 0, 0, 0, 0, 0, 0, 0, 0
  .long 16780801, 3332, 1313, 578, 4674, 3331, 7, 6, 0, 0, 0, 0, 0, 0, 0, 0
  .long 16780817, 3348, 1329, 594, 4690, 3347, 7, 6, 0, 0, 0, 0, 0, 0, 0, 0
  .long 3601, 3364, 1314, 610, 4706, 3363, 7, 6, 0, 0, 0, 0, 0, 0, 0, 0
  .long 16780802, 3380, 1330, 626, 4722, 3379, 7, 6, 0, 0, 0, 0, 0, 0, 0, 0
  .long 16780818, 3588, 1569, 833, 4929, 3587, 7, 6, 0, 0, 0, 0, 0, 0, 0, 0
  .long 3602, 3604, 1585, 849, 4945, 3603, 7, 6, 0, 0, 0, 0, 0, 0, 0, 0
  .long 16781057, 3620, 1570, 865, 4961, 3619, 7, 6, 0, 0, 0, 0, 0, 0, 0, 0
  .long 16781073, 3636, 1586, 881, 4977, 3635, 7, 6, 0, 0, 0, 0, 0, 0, 0, 0
  .long 3857, 3844, 1825, 834, 4930, 3843, 7, 6, 0, 0, 0, 0, 0, 0, 0, 0
  .long 16781058, 3860, 1841, 850, 4946, 3859, 7, 6, 0, 0, 0, 0, 0, 0, 0, 0
  .long 16781074, 3876, 1826, 866, 4962, 3875, 7, 6, 0, 0, 0, 0, 0, 0, 0, 0
  .long 3858, 3892, 1842, 882, 4978, 3891, 7, 6, 0, 0, 0, 0, 0, 0, 0, 0
  .long 16781313, 2116, 2081, 6, 1089, 5185, 4099, 7, 2115, 0, 0, 0, 0, 0, 0, 0
  .long 16781329, 2132, 2097, 6, 1105, 5201, 4115, 7, 2131, 0, 0, 0, 0, 0, 0, 0
  .long 4113, 2148, 2082, 6, 1121, 5217, 4131, 7, 2147, 0, 0, 0, 0, 0, 0, 0
  .long 16781314, 2164, 2098, 6, 1137, 5233, 4147, 7, 2163, 0, 0, 0, 0, 0, 0, 0
  .long 16781330, 2372, 2337, 6, 1090, 5186, 4355, 7, 2371, 0, 0, 0, 0, 0, 0, 0
  .long 4114, 2388, 2353, 6, 1106, 5202, 4371, 7, 2387, 0, 0, 0, 0, 0, 0, 0
  .long 16781569, 2404, 2338, 6, 1122, 5218, 4387, 7, 2403, 0, 0, 0, 0, 0, 0, 0
  .long 16781585, 2420, 2354, 6, 1138, 5234, 4403, 7, 2419, 0, 0, 0, 0, 0, 0, 0
  .long 4369, 2628, 2593, 6, 1345, 5441, 4611, 7, 2627, 0, 0, 0, 0, 0, 0, 0
  .long 16781570, 2644, 2609, 6, 1361, 5457, 4627, 7, 2643, 0, 0, 0, 0, 0, 0, 0
  .long 16781586, 2660, 2594, 6, 1377, 5473, 4643, 7, 2659, 0, 0, 0, 0, 0, 0, 0
  .long 4370, 2676, 2610, 6, 1393, 5489, 4659, 7, 2675, 0, 0, 0, 0, 0, 0, 0
  .long 16781825, 2884, 2849, 6, 1346, 5442, 4867, 7, 2883, 0, 0, 0, 0, 0, 0, 0
  .long 16781841, 2900, 2865, 6, 1362, 5458, 4883, 7, 2899, 0, 0, 0, 0, 0, 0, 0
  .long 4625, 2916, 2850, 6, 1378, 5474, 4899, 7, 2915, 0, 0, 0, 0, 0, 0, 0
  .long 16781826, 2932, 2866, 6, 1394, 5490, 4915, 7, 2931, 0, 0, 0, 0, 0, 0, 0
  .long 16781842, 3140, 3105, 6, 1601, 5697, 5123, 7, 3139, 0, 0, 0, 0, 0, 0, 0
  .long 4626, 3156, 3121, 6, 1617, 5713, 5139, 7, 3155, 0, 0, 0, 0, 0, 0, 0
  .long 16782081, 3172, 3106, 6, 1633, 5729, 5155, 7, 3171, 0, 0, 0, 0, 0, 0, 0
  .long 16782097, 3188, 3122, 6, 1649, 5745, 5171, 7, 3187, 0, 0, 0, 0, 0, 0, 0
  .long 4881, 3396, 3361, 6, 1602, 5698, 5379, 7, 3395, 0, 0, 0, 0, 0, 0, 0
  .long 16782082, 3412, 3377, 6, 1618, 5714, 5395, 7, 3411, 0, 0, 0, 0, 0, 0, 0
  .long 16782098, 3428, 3362, 6, 1634, 5730, 5411, 7, 3427, 0, 0, 0, 0, 0, 0, 0
  .long 4882, 3444, 3378, 6, 1650, 5746, 5427, 7, 3443, 0, 0, 0, 0, 0, 0, 0
  .long 16782337, 3652, 3617, 6, 1857, 5953, 5635, 7, 3651, 0, 0, 0, 0, 0, 0, 0
  .long 16782353, 3668, 3633, 6, 1873, 5969, 5651, 7, 3667, 0, 0, 0, 0, 0, 0, 0
  .long 5137, 3684, 3618, 6, 1889, 5985, 5667, 7, 3683, 0, 0, 0, 0, 0, 0, 0
  .long 16782338, 3700, 3634, 6, 1905, 6001, 5683, 7, 3699, 0, 0, 0, 0, 0, 0, 0
  .long 16782354, 3908, 3873, 6, 1858, 5954, 5891, 7, 3907, 0, 0, 0, 0, 0, 0, 0
  .long 5138, 3924, 3889, 6, 1874, 5970, 5907, 7, 3923, 0, 0, 0, 0, 0, 0, 0
  .long 16782593, 3940, 3874, 6, 1890, 5986, 5923, 7, 3939, 0, 0, 0, 0, 0, 0, 0
  .long 16782609, 3956, 3890, 6, 1906, 6002, 5939, 7, 3955, 0, 0, 0, 0, 0, 0, 0
  .long 5393, 4100, 4129, 2113, 6, 6209, 6147, 7, 4163, 0, 0, 0, 0, 0, 0, 0
  .long 16782594, 4116, 4145, 2129, 6, 6225, 6163, 7, 4179, 0, 0, 0, 0, 0, 0, 0
  .long 16782610, 4132, 4130, 2145, 6, 6241, 6179, 7, 4195, 0, 0, 0, 0, 0, 0, 0
  .long 5394, 4148, 4146, 2161, 6, 6257, 6195, 7, 4211, 0, 0, 0, 0, 0, 0, 0
  .long 16782849, 4356, 4385, 2114, 6, 6210, 6403, 7, 4419, 0, 0, 0, 0, 0, 0, 0
  .long 16782865, 4372, 4401, 2130, 6, 6226, 6419, 7, 4435, 0, 0, 0, 0, 0, 0, 0
  .long 5649, 4388, 4386, 2146, 6, 6242, 6435, 7, 4451, 0, 0, 0, 0, 0, 0, 0
  .long 16782850, 4404, 4402, 2162, 6, 6258, 6451, 7, 4467, 0, 0, 0, 0, 0, 0, 0
  .long 16782866, 4612, 4641, 2369, 6, 6465, 6659, 7, 4675, 0, 0, 0, 0, 0, 0, 0
  .long 5650, 4628, 4657, 2385, 6, 6481, 6675, 7, 4691, 0, 0, 0, 0, 0, 0, 0
  .long 16783105, 4644, 4642, 2401, 6, 6497, 6691, 7, 4707, 0, 0, 0, 0, 0, 0, 0
  .long 16783121, 4660, 4658, 2417, 6, 6513, 6707, 7, 4723, 0, 0, 0, 0, 0, 0, 0
  .long 5905, 4868, 4897, 2370, 6, 6466, 6915, 7, 4931, 0, 0, 0, 0, 0, 0, 0
  .long 16783106, 4884, 4913, 2386, 6, 6482, 6931, 7, 4947, 0, 0, 0, 0, 0, 0, 0
  .long 16783122, 4900, 4898, 2402, 6, 6498, 6947, 7, 4963, 0, 0, 0, 0, 0, 0, 0
  .long 5906, 4916, 4914, 2418, 6, 6514, 6963, 7, 4979, 0, 0, 0, 0, 0, 0, 0
  .long 16783361, 5124, 5153, 2625, 6, 6721, 7171, 7, 5187, 0, 0, 0, 0, 0, 0, 0
  .long 16783377, 5140, 5169, 2641, 6, 6737, 7187, 7, 5203, 0, 0, 0, 0, 0, 0, 0
  .long 6161, 5156, 5154, 2657, 6, 6753, 7203, 7, 5219, 0, 0, 0, 0, 0, 0, 0
  .long 16783362, 5172, 5170, 2673, 6, 6769, 7219, 7, 5235, 0, 0, 0, 0, 0, 0, 0
  .long 16783378, 5380, 5409, 2626, 6, 6722, 7427, 7, 5443, 0, 0, 0, 0, 0, 0, 0
  .long 6162, 5396, 5425, 2642, 6, 6738, 7443, 7, 5459, 0, 0, 0, 0, 0, 0, 0
  .long 16783617, 5412, 5410, 2658, 6, 6754, 7459, 7, 5475, 0, 0, 0, 0, 0, 0, 0
  .long 16783633, 5428, 5426, 2674, 6, 6770, 7475, 7, 5491, 0, 0, 0, 0, 0, 0, 0
  .long 6417, 5636, 5665, 2881, 6, 6977, 7683, 7, 5699, 0, 0, 0, 0, 0, 0, 0
  .long 16783618, 5652, 5681, 2897, 6, 6993, 7699, 7, 5715, 0, 0, 0, 0, 0, 0, 0
  .long 16783634, 5668, 5666, 2913, 6, 7009, 7715, 7, 5731, 0, 0, 0, 0, 0, 0, 0
  .long 6418, 5684, 5682, 2929, 6, 7025, 7731, 7, 5747, 0, 0, 0, 0, 0, 0, 0
  .long 16783873, 5892, 5921, 2882, 6, 6978, 7939, 7, 5955, 0, 0, 0, 0, 0, 0, 0
  .long 16783889, 5908, 5937, 2898, 6, 6994, 7955, 7, 5971, 0, 0, 0, 0, 0, 0, 0
  .long 6673, 5924, 5922, 2914, 6, 7010, 7971, 7, 5987, 0, 0, 0, 0, 0, 0, 0
  .long 16783874, 5940, 5938, 2930, 6, 7026, 7987, 7, 6003, 0, 0, 0, 0, 0, 0, 0
  .long 16783890, 4164, 6177, 3137, 7233, 6, 67, 7, 6211, 0, 0, 0, 0, 0, 0, 0
  .long 6674, 4180, 6193, 3153, 7249, 6, 83, 7, 6227, 0, 0, 0, 0, 0, 0, 0
  .long 16784129, 4196, 6178, 3169, 7265, 6, 99, 7, 6243, 0, 0, 0, 0, 0, 0, 0
  .long 16784145, 4212, 6194, 3185, 7281, 6, 115, 7, 6259, 0, 0, 0, 0, 0, 0, 0
  .long 6929, 4420, 6433, 3138, 7234, 6, 323, 7, 6467, 0, 0, 0, 0, 0, 0, 0
  .long 16784130, 4436, 6449, 3154, 7250, 6, 339, 7, 6483, 0, 0, 0, 0, 0, 0, 0
  .long 16784146, 4452, 6434, 3170, 7266, 6, 355, 7, 6499, 0, 0, 0, 0, 0, 0, 0
  .long 6930, 4468, 6450, 3186, 7282, 6, 371, 7, 6515, 0, 0, 0, 0, 0, 0, 0
  .long 16784385, 4676, 6689, 3393, 7489, 6, 579, 7, 6723, 0, 0, 0, 0, 0, 0, 0
  .long 16784401, 4692, 6705, 3409, 7505, 6, 595, 7, 6739, 0, 0, 0, 0, 0, 0, 0
  .long 7185, 4708, 6690, 3425, 7521, 6, 611, 7, 6755, 0, 0, 0, 0, 0, 0, 0
  .long 16784386, 4724, 6706, 3441, 7537, 6, 627, 7, 6771, 0, 0, 0, 0, 0, 0, 0
  .long 16784402, 4932, 6945, 3394, 7490, 6, 835, 7, 6979, 0, 0, 0, 0, 0, 0, 0
  .long 7186, 4948, 6961, 3410, 7506, 6, 851, 7, 6995, 0, 0, 0, 0, 0, 0, 0
  .long 16784641, 4964, 6946, 3426, 7522, 6, 867, 7, 7011, 0, 0, 0, 0, 0, 0, 0
  .long 16784657, 4980, 6962, 3442, 7538, 6, 883, 7, 7027, 0, 0, 0, 0, 0, 0, 0
  .long 7441, 5188, 7201, 3649, 7745, 6, 1091, 7, 7235, 0, 0, 0, 0, 0, 0, 0
  .long 16784642, 5204, 7217, 3665, 7761, 6, 1107, 7, 7251, 0, 0, 0, 0, 0, 0, 0
  .long 16784658, 5220, 7202, 3681, 7777, 6, 1123, 7, 7267, 0, 0, 0, 0, 0, 0, 0
  .long 7442, 5236, 7218, 3697, 7793, 6, 1139, 7, 7283, 0, 0, 0, 0, 0, 0, 0
  .long 16784897, 5444, 7457, 3650, 7746, 6, 1347, 7, 7491, 0, 0, 0, 0, 0, 0, 0
  .long 16784913, 5460, 7473, 3666, 7762, 6, 1363, 7, 7507, 0, 0, 0, 0, 0, 0, 0
  .long 7697, 5476, 7458, 3682, 7778, 6, 1379, 7, 7523, 0, 0, 0, 0, 0, 0, 0
  .long 16784898, 5492, 7474, 3698, 7794, 6, 1395, 7, 7539, 0, 0, 0, 0, 0, 0, 0
  .long 16784914, 5700, 7713, 3905, 8001, 6, 1603, 7, 7747, 0, 0, 0, 0, 0, 0, 0
  .long 7698, 5716, 7729, 3921, 8017, 6, 1619, 7, 7763, 0, 0, 0, 0, 0, 0, 0
  .long 16785153, 5732, 7714, 3937, 8033, 6, 1635, 7, 7779, 0, 0, 0, 0, 0, 0, 0
  .long 16785169, 5748, 7730, 3953, 8049, 6, 1651, 7, 7795, 0, 0, 0, 0, 0, 0, 0
  .long 7953, 5956, 7969, 3906, 8002, 6, 1859, 7, 8003, 0, 0, 0, 0, 0, 0, 0
  .long 16785154, 5972, 7985, 3922, 8018, 6, 1875, 7, 8019, 0, 0, 0, 0, 0, 0, 0
  .long 16785170, 5988, 7970, 3938, 8034, 6, 1891, 7, 8035, 0, 0, 0, 0, 0, 0, 0
  .long 7954, 6004, 7986, 3954, 8050, 6, 1907, 7, 8051, 0, 0, 0, 0, 0, 0, 0
  .size Ltasks, 12288
.section .rodata,"a"
.p2align 6
.amdhsa_kernel gated_mix__memory_aug_recurrent_mem_tr__dense_activation_relu__prompt_kernel
  .amdhsa_next_free_vgpr 512
  .amdhsa_next_free_sgpr 102
  .amdhsa_accum_offset 256
  .amdhsa_group_segment_fixed_size 0
  .amdhsa_kernarg_size 112
  .amdhsa_user_sgpr_count 2
  .amdhsa_user_sgpr_kernarg_segment_ptr 1
  .amdhsa_system_sgpr_workgroup_id_x 1
  .amdhsa_float_denorm_mode_32 3
.end_amdhsa_kernel
```
